```python
import torch

def _softmax(x, axis=-1):
    return torch.softmax(x, dim=axis)
def _gelu(x):
    return torch.nn.functional.gelu(x, approximate="tanh")
def _silu(x):
    return torch.nn.functional.silu(x)
def _sigmoid(x):
    return torch.sigmoid(x)
def _layernorm(x, axis=-1, eps=1e-5):
    m = x.mean(dim=axis, keepdim=True)
    v = x.var(dim=axis, keepdim=True, unbiased=False)
    return (x - m) / torch.sqrt(v + eps)
def _scatter_add(tgt, idx, src, axis=0):
    return tgt.clone().index_add_(axis, idx, src)
def _segment_sum(src, seg, n):
    out = torch.zeros((n,) + src.shape[1:], dtype=src.dtype)
    return out.index_add_(0, seg, src)
def _pad(x, pw):
    flat = tuple(v for pair in reversed(pw) for v in pair)
    return torch.nn.functional.pad(x, flat)

kernel_name = 'gated_mix__spectral_gfnet__glu_gated_geglu__prompt'

def setup_inputs():

    _w = (lambda a: (lambda t: t.to(torch.bfloat16) if t.is_floating_point() else t)(torch.as_tensor(a)))
    def _A_setup():
        B, S, D = 1, 2048, 576
        Df = D // 2 + 1
        return {
            "x": _w((lambda *s: torch.randn(*s, dtype=torch.bfloat16) * 0.05)(B, S, D)),
            "w_r": _w((lambda *s: torch.randn(*s, dtype=torch.bfloat16) * 0.05)(S, Df) * 0.02),
            "w_i": _w((lambda *s: torch.randn(*s, dtype=torch.bfloat16) * 0.05)(S, Df) * 0.02),
        }
    _A_in = _A_setup()

    def _B_setup():
        B, S, Dm, Df = 1, 2048, 576, 4608
        return {
            "x": _w((lambda *s: torch.randn(*s, dtype=torch.bfloat16) * 0.05)(B, S, Dm)),
            "w_gate": _w((lambda *s: torch.randn(*s, dtype=torch.bfloat16) * 0.2)(Dm, Df) * (Dm ** -0.5)),
            "w_up": _w((lambda *s: torch.randn(*s, dtype=torch.bfloat16) * 0.2)(Dm, Df) * (Dm ** -0.5)),
            "w_down": _w((lambda *s: torch.randn(*s, dtype=torch.bfloat16) * 0.2)(Df, Dm) * (Df ** -0.5)),
        }
    _B_in = _B_setup()

    return {
        "A_x": _A_in["x"],
        "A_w_r": _A_in["w_r"],
        "A_w_i": _A_in["w_i"],
        "B_x": _B_in["x"],
        "B_w_gate": _B_in["w_gate"],
        "B_w_up": _B_in["w_up"],
        "B_w_down": _B_in["w_down"],
        "gate_w": _w((lambda *s: torch.randn(*s, dtype=torch.bfloat16) * 0.05)(576) * 16.0),
    }

def reference(A_x, A_w_r, A_w_i, B_x, B_w_gate, B_w_up, B_w_down, gate_w):
    def _A_ref(x, w_r, w_i):
        B, S, D = x.shape
        X = (lambda x, axes=(-2,-1): torch.fft.rfft2(x.float(), dim=axes))(x, axes=(-2, -1))
        W = w_r + 1j * w_i
        X = X * W
        y = (lambda x, s, axes=(-2,-1): torch.fft.irfft2(x, s=s, dim=axes).to(torch.bfloat16))(X, (S, D), axes=(-2, -1))
        return y

    def _B_ref(x, w_gate, w_up, w_down):
        g = torch.einsum("bsd,df->bsf", x, w_gate)
        u = torch.einsum("bsd,df->bsf", x, w_up)
        h = _gelu(g) * u
        return torch.einsum("bsf,fd->bsd", h, w_down)

    x = A_x
    g = _sigmoid((x * gate_w).sum(-1, keepdims=True))
    a = _A_ref(x, A_w_r, A_w_i)
    b = _B_ref(x, B_w_gate, B_w_up, B_w_down)
    return g * a + (1 - g) * b
```

```asm
; @launch grid=(256,1,1) block=(256,1,1) lds=163840
.amdgcn_target "amdgcn-amd-amdhsa--gfx950"
.text
.globl gated_mix__spectral_gfnet__glu_gated_geglu__prompt_kernel
.p2align 8
.type gated_mix__spectral_gfnet__glu_gated_geglu__prompt_kernel,@function
gated_mix__spectral_gfnet__glu_gated_geglu__prompt_kernel:
 s_cmp_ge_u32 s2, 256
 s_cbranch_scc1 L_done
 s_load_dwordx16 s[64:79], s[0:1], 0
 s_load_dwordx2 s[80:81], s[0:1], 64
 s_load_dwordx2 s[82:83], s[0:1], 80
 s_getpc_b64 s[44:45]
L_pc:
 s_lshr_b32 s46, s2, 3
 s_lshl_b32 s46, s46, 11
 v_lshrrev_b32 v248, 6, v0
 v_and_b32 v249, 3, v0
 v_lshl_add_u32 v248, v248, 2, v249
 v_lshl_add_u32 v248, v248, 7, s46
 v_min_u32 v248, L_done - L_pc, v248
 v_mov_b32 v249, s45
 v_add_co_u32 v248, vcc, s44, v248
 s_nop 1
 v_addc_co_u32 v249, vcc, 0, v249, vcc
 global_load_dword v247, v[248:249], off
 v_lshrrev_b32 v10, 6, v0
 v_and_b32 v0, 63, v0
 s_nop 0
 v_readfirstlane_b32 s20, v10
 s_and_b32 s28, s2, 7
 s_lshr_b32 s29, s2, 3
 s_and_b32 s22, s28, 3
 s_lshr_b32 s21, s28, 2
 s_lshl_b32 s21, s21, 2
 s_and_b32 s46, s29, 3
 s_add_u32 s21, s21, s46
 s_lshl_b32 s22, s22, 3
 s_lshr_b32 s46, s29, 2
 s_add_u32 s22, s22, s46
 s_waitcnt lgkmcnt(0)
 s_mov_b32 s8, s64
 s_mov_b32 s9, s65
 s_mov_b32 s10, 2359296
 s_mov_b32 s11, 0x20000
 s_mov_b32 s12, s82
 s_mov_b32 s13, s83
 s_mov_b32 s14, 268435456
 s_mov_b32 s15, 0x20000
 s_cmp_ge_u32 s20, 2
 s_cselect_b32 s84, s68, s66
 s_cselect_b32 s85, s69, s67
 s_mov_b32 s86, 1183744
 s_mov_b32 s87, 0x20000
 s_cselect_b32 s4, s74, s72
 s_cselect_b32 s5, s75, s73
 s_mov_b32 s6, 5308416
 s_mov_b32 s7, 0x20000
 s_mov_b32 s16, s76
 s_mov_b32 s17, s77
 s_mov_b32 s18, 5308416
 s_mov_b32 s19, 0x20000
 s_mov_b32 s64, s78
 s_mov_b32 s65, s79
 s_mov_b32 s66, 1152
 s_mov_b32 s67, 0x20000
 v_lshlrev_b32 v1, 4, v0
 s_mov_b32 s68, s72
 s_mov_b32 s69, s73
 s_mov_b32 s70, 5308416
 s_mov_b32 s71, 0x20000
 s_mov_b32 s72, s74
 s_mov_b32 s73, s75
 s_mov_b32 s74, 5308416
 s_mov_b32 s75, 0x20000
 s_lshl_b32 s3, s21, 5
 s_add_u32 s3, s3, s22
 s_and_b32 s40, s22, 7
 s_mul_i32 s40, s40, 294912
 s_mul_i32 s41, s21, 36864
 s_add_u32 s77, s40, s41
 v_lshlrev_b32 v253, 7, v0
 s_lshl_b32 s41, s20, 13
 s_add_u32 s41, s41, s77
 s_mov_b32 exec_lo, 0xffffffff
 s_mov_b32 exec_hi, 0xfff
 buffer_load_dword v254, v253, s[8:11], s41 offen
 s_mov_b64 exec, -1
 v_lshlrev_b32 v96, 4, v0
 v_add_u32 v97, 1024, v96
 v_mov_b32 v89, 0x7ffffff0
 v_cmp_gt_u32 vcc, 8, v0
 s_nop 1
 v_cndmask_b32 v97, v89, v97, vcc
 s_lshl_b32 s46, s20, 9
 s_add_u32 s46, s46, s3
 s_mul_i32 s46, s46, 1152
 s_mul_i32 s47, s20, 3200
 s_add_u32 s47, s47, 36864
 s_add_u32 s45, s46, 0
 s_add_u32 m0, s47, 0
 s_nop 0
 buffer_load_dwordx4 v96, s[8:11], s45 offen lds
 s_add_u32 s45, s46, 0
 s_add_u32 m0, s47, 1024
 s_mov_b32 exec_hi, 0xf
 buffer_load_dwordx4 v97, s[8:11], s45 offen lds
 s_mov_b64 exec, -1
 s_add_u32 s45, s46, 294912
 s_add_u32 m0, s47, 1600
 s_nop 0
 buffer_load_dwordx4 v96, s[8:11], s45 offen lds
 s_add_u32 s45, s46, 294912
 s_add_u32 m0, s47, 2624
 s_mov_b32 exec_hi, 0xf
 buffer_load_dwordx4 v97, s[8:11], s45 offen lds
 s_mov_b64 exec, -1
 s_mov_b32 s46, 42648192
 v_mov_b32 v95, 0
 buffer_load_dword v94, v95, s[12:15], s46 offen sc1
 v_and_b32 v10, 15, v0
 v_lshrrev_b32 v11, 4, v0
 v_lshrrev_b32 v12, 3, v0
 v_bfe_u32 v13, v0, 4, 1
 s_and_b32 s40, s20, 1
 s_lshl_b32 s40, s40, 1
 v_or_b32 v13, s40, v13
 v_bfe_u32 v14, v0, 1, 2
 v_xor_b32 v13, v13, v14
 v_mul_u32_u24 v12, 9216, v12
 v_lshl_add_u32 v12, v13, 5, v12
 v_and_b32 v14, 1, v0
 v_lshl_add_u32 v4, v14, 4, v12
 v_lshrrev_b32 v12, 1, v0
 v_and_b32 v13, 0x13, v12
 v_and_b32 v14, 4, v12
 v_lshl_or_b32 v13, v14, 1, v13
 v_and_b32 v14, 8, v12
 v_lshrrev_b32 v14, 1, v14
 v_or_b32 v13, v13, v14
 v_mul_u32_u24 v13, 9216, v13
 v_and_b32 v14, 1, v0
 v_lshl_add_u32 v5, v14, 4, v13
 v_lshrrev_b32 v12, 2, v10
 v_and_b32 v13, 3, v0
 v_lshl_add_u32 v14, v11, 3, v12
 v_lshlrev_b32 v14, 7, v14
 v_lshl_add_u32 v14, v13, 3, v14
 v_lshrrev_b32 v15, 1, v12
 v_and_b32 v13, 1, v11
 v_lshl_or_b32 v15, v13, 1, v15
 v_lshl_add_u32 v6, v15, 5, v14
 v_xor_b32 v7, 32, v6
 v_mov_b32 v9, 0xc0135761
 s_mov_b32 s30, 0xbdd2d3e8
 s_lshr_b32 s40, s22, 3
 s_and_b32 s41, s22, 7
 s_lshr_b32 s42, s41, 2
 s_lshl_b32 s43, s41, 1
 s_add_u32 s43, s43, s42
 s_mul_i32 s44, s40, 2304
 s_lshl_b32 s45, s43, 7
 s_add_u32 s45, s45, s44
 s_mul_i32 s46, s20, 663552
 s_add_u32 s23, s45, s46
 s_and_b32 s46, s21, 3
 s_lshl_b32 s46, s46, 1
 s_and_b32 s47, s20, 1
 s_add_u32 s46, s46, s47
 s_lshl_b32 s59, s46, 3
 s_mul_i32 s46, s46, 294912
 s_add_u32 s62, s45, s46
 s_add_u32 s58, s45, 2359296
 s_mul_i32 s45, s42, 9
 s_add_u32 s45, s45, 8
 s_lshl_b32 s45, s45, 7
 s_add_u32 s45, s45, s44
 s_and_b32 s46, s41, 3
 s_lshl_b32 s46, s46, 5
 s_add_u32 s45, s45, s46
 s_mul_i32 s46, s47, 294912
 s_add_u32 s24, s45, s46
 s_mul_i32 s25, s20, 9216
 s_lshr_b32 s46, s20, 1
 s_mul_i32 s46, s46, 18432
 s_lshl_b32 s47, s47, 10
 s_add_u32 s82, s46, s47
 s_lshl_b32 s46, s21, 4
 s_lshl_b32 s47, s20, 2
 s_add_u32 s46, s46, s47
 s_mul_i32 s44, s40, 36
 s_lshl_b32 s45, s43, 1
 s_add_u32 s44, s44, s45
 s_mul_i32 s45, s46, 144
 s_add_u32 s44, s44, s45
 s_lshl_b32 s26, s44, 10
 s_add_u32 s26, s26, 0
 s_lshr_b32 s43, s22, 1
 s_lshl_b32 s44, s46, 4
 s_add_u32 s44, s44, s43
 s_lshl_b32 s44, s44, 1
 s_and_b32 s45, s22, 1
 s_add_u32 s44, s44, s45
 s_lshl_b32 s27, s44, 9
 s_add_u32 s27, s27, 18874368
 s_and_b32 s40, s21, 3
 s_mul_i32 s41, s40, 589824
 s_add_u32 s63, s24, s41
 s_lshl_b32 s41, s40, 4
 s_mov_b64 s[78:79], 0xffff
 s_lshl_b64 s[78:79], s[78:79], s41
 s_lshl_b32 s40, s21, 5
 s_lshr_b32 s41, s20, 1
 s_lshl_b32 s41, s41, 4
 s_add_u32 s40, s40, s41
 s_and_b32 s41, s20, 1
 s_lshl_b32 s41, s41, 10
 s_add_u32 s40, s40, s41
 s_mul_i32 s38, s40, 1152
 s_mul_i32 s39, s20, 18432
 s_add_u32 s39, s39, 73728
 v_lshrrev_b32 v83, 3, v0
 v_and_b32 v84, 7, v0
 v_xor_b32 v84, v84, v83
 v_mul_u32_u24 v83, 1152, v83
 v_lshl_add_u32 v80, v84, 4, v83
 v_and_b32 v83, 15, v0
 v_lshrrev_b32 v84, 4, v0
 v_and_b32 v85, 7, v83
 v_xor_b32 v85, v85, v84
 v_lshlrev_b32 v85, 4, v85
 v_lshl_add_u32 v85, v83, 7, v85
 v_add_u32 v81, s39, v85
 v_xor_b32 v82, 64, v81
 s_and_b32 s46, s2, 7
 s_lshr_b32 s47, s2, 3
 s_and_b32 s50, s46, 3
 s_lshr_b32 s46, s46, 2
 s_lshl_b32 s46, s46, 3
 s_and_b32 s48, s47, 7
 s_add_u32 s48, s48, s46
 s_lshr_b32 s49, s47, 3
 s_lshl_b32 s46, s20, 2
 s_mul_i32 s47, s50, 36
 s_add_u32 s46, s46, s47
 s_mul_i32 s46, s46, 36864
 s_mul_i32 s57, s49, 288
 s_add_u32 s51, s46, s57
 s_lshr_b32 s46, s20, 1
 s_mul_i32 s46, s46, 18
 s_add_u32 s46, s46, 16
 s_add_u32 s46, s46, s47
 s_and_b32 s47, s20, 1
 s_add_u32 s46, s46, s47
 s_mul_i32 s46, s46, 36864
 s_add_u32 s52, s46, s57
 s_mul_i32 s53, s20, 9216
 s_lshl_b32 s46, s48, 3
 s_lshl_b32 s47, s20, 1
 s_add_u32 s46, s46, s47
 s_mul_i32 s47, s46, 144
 s_mul_i32 s57, s50, 36
 s_add_u32 s47, s47, s57
 s_lshl_b32 s54, s47, 10
 s_add_u32 s54, s54, 0
 s_lshl_b32 s47, s46, 4
 s_lshl_b32 s57, s50, 2
 s_add_u32 s47, s47, s57
 s_lshl_b32 s55, s47, 10
 s_add_u32 s55, s55, 18874368
 s_lshl_b32 s46, s50, 2
 s_add_u32 s46, s46, s49
 s_mul_i32 s46, s46, 589824
 s_lshl_b32 s47, s48, 7
 s_lshl_b32 s57, s20, 5
 s_add_u32 s47, s47, s57
 s_mul_i32 s47, s47, 288
 s_add_u32 s46, s46, s47
 s_add_u32 s56, s46, 20971520
 s_lshl_b32 s46, s48, 7
 s_lshl_b32 s47, s20, 5
 s_add_u32 s46, s46, s47
 s_lshl_b32 s47, s49, 11
 s_add_u32 s46, s46, s47
 s_mul_i32 s45, s50, 1049728
 s_lshl_b32 s47, s46, 7
 s_add_u32 s47, s47, s45
 s_add_u32 s56, s47, 20971520
 s_lshl_b32 s47, s46, 5
 s_add_u32 s47, s47, s45
 s_add_u32 s83, s47, 29374208
 s_lshl_b32 s44, s21, 2
 s_lshr_b32 s45, s22, 3
 s_add_u32 s44, s44, s45
 s_lshl_b32 s44, s44, 7
 s_and_b32 s45, s22, 7
 s_lshl_b32 s45, s45, 2
 s_add_u32 s44, s44, s45
 s_add_u32 s31, s44, 42599040
 s_lshr_b32 s44, s48, 1
 s_lshl_b32 s44, s44, 2
 s_add_u32 s44, s44, s50
 s_lshl_b32 s44, s44, 7
 s_add_u32 s32, s44, 42599040
 s_lshl_b32 s44, s48, 11
 s_lshl_b32 s45, s49, 9
 s_add_u32 s44, s44, s45
 s_lshl_b32 s45, s50, 7
 s_add_u32 s44, s44, s45
 s_add_u32 s34, s44, 42615424
 s_lshr_b32 s44, s3, 4
 s_lshl_b32 s44, s44, 11
 s_add_u32 s35, s44, 42615424
 s_mov_b32 s88, s50
 s_mov_b32 s89, s49
 s_lshr_b32 s44, s49, 1
 s_mul_i32 s44, s44, 9
 s_and_b32 s45, s49, 1
 s_mul_i32 s45, s45, 5
 s_add_u32 s44, s44, s45
 s_lshl_b32 s44, s44, 10
 s_add_u32 s76, s44, s54
 s_lshl_b32 s44, s49, 12
 s_add_u32 s76, s44, s54
 v_add_u32 v83, 0, v0
 v_mul_u32_u24 v84, 3641, v83
 v_lshrrev_b32 v84, 16, v84
 v_mul_u32_u24 v85, 18, v84
 v_sub_u32 v85, v83, v85
 v_mul_u32_u24 v86, 1152, v84
 v_lshl_add_u32 v2, v85, 4, v86
 v_add_u32 v83, 64, v0
 v_mul_u32_u24 v84, 3641, v83
 v_lshrrev_b32 v84, 16, v84
 v_mul_u32_u24 v85, 18, v84
 v_sub_u32 v85, v83, v85
 v_mul_u32_u24 v86, 1152, v84
 v_lshl_add_u32 v3, v85, 4, v86
 v_add_u32 v83, 128, v0
 v_mul_u32_u24 v84, 3641, v83
 v_lshrrev_b32 v84, 16, v84
 v_mul_u32_u24 v85, 18, v84
 v_sub_u32 v85, v83, v85
 v_mul_u32_u24 v86, 1152, v84
 v_lshl_add_u32 v10, v85, 4, v86
 v_add_u32 v83, 192, v0
 v_mul_u32_u24 v84, 3641, v83
 v_lshrrev_b32 v84, 16, v84
 v_mul_u32_u24 v85, 18, v84
 v_sub_u32 v85, v83, v85
 v_mul_u32_u24 v86, 1152, v84
 v_lshl_add_u32 v11, v85, 4, v86
 v_add_u32 v83, 256, v0
 v_mul_u32_u24 v84, 3641, v83
 v_lshrrev_b32 v84, 16, v84
 v_mul_u32_u24 v85, 18, v84
 v_sub_u32 v85, v83, v85
 v_mul_u32_u24 v86, 1152, v84
 v_lshl_add_u32 v12, v85, 4, v86
 v_add_u32 v83, 320, v0
 v_mul_u32_u24 v84, 3641, v83
 v_lshrrev_b32 v84, 16, v84
 v_mul_u32_u24 v85, 18, v84
 v_sub_u32 v85, v83, v85
 v_mul_u32_u24 v86, 1152, v84
 v_lshl_add_u32 v13, v85, 4, v86
 v_add_u32 v83, 384, v0
 v_mul_u32_u24 v84, 3641, v83
 v_lshrrev_b32 v84, 16, v84
 v_mul_u32_u24 v85, 18, v84
 v_sub_u32 v85, v83, v85
 v_mul_u32_u24 v86, 1152, v84
 v_lshl_add_u32 v14, v85, 4, v86
 v_add_u32 v83, 448, v0
 v_mul_u32_u24 v84, 3641, v83
 v_lshrrev_b32 v84, 16, v84
 v_mul_u32_u24 v85, 18, v84
 v_sub_u32 v85, v83, v85
 v_mul_u32_u24 v86, 1152, v84
 v_lshl_add_u32 v15, v85, 4, v86
 v_and_b32 v192, 15, v0
 v_lshrrev_b32 v193, 4, v0
 v_cvt_f32_u32 v194, v192
 v_cvt_f32_u32 v195, v193
 v_mul_f32 v160, 0xbd2aaaab, v194
 v_mul_f32 v161, 0x41000000, v195
 v_mul_f32 v144, v160, v161
 v_add_f32 v145, v144, v160
 v_add_f32 v146, v145, v160
 v_add_f32 v147, v146, v160
 v_add_f32 v148, v147, v160
 v_add_f32 v149, v148, v160
 v_add_f32 v150, v149, v160
 v_add_f32 v151, v150, v160
 v_sin_f32 v152, v144
 v_sin_f32 v153, v145
 v_sin_f32 v154, v146
 v_sin_f32 v155, v147
 v_sin_f32 v156, v148
 v_sin_f32 v157, v149
 v_sin_f32 v158, v150
 v_sin_f32 v159, v151
 v_cos_f32 v144, v144
 v_cos_f32 v145, v145
 v_cos_f32 v146, v146
 v_cos_f32 v147, v147
 v_cos_f32 v148, v148
 v_cos_f32 v149, v149
 v_cos_f32 v150, v150
 v_cos_f32 v151, v151
 v_cmp_eq_u32 vcc, 3, v193
 v_cvt_pk_bf16_f32 v16, v144, v145
 v_cvt_pk_bf16_f32 v20, v152, v153
 v_cvt_pk_bf16_f32 v17, v146, v147
 v_cvt_pk_bf16_f32 v21, v154, v155
 v_cvt_pk_bf16_f32 v18, v148, v149
 v_cvt_pk_bf16_f32 v22, v156, v157
 v_cvt_pk_bf16_f32 v19, v150, v151
 v_cvt_pk_bf16_f32 v23, v158, v159
 v_cndmask_b32_e64 v16, v16, 0, vcc
 v_cndmask_b32_e64 v20, v20, 0, vcc
 v_cndmask_b32_e64 v17, v17, 0, vcc
 v_cndmask_b32_e64 v21, v21, 0, vcc
 v_cndmask_b32_e64 v18, v18, 0, vcc
 v_cndmask_b32_e64 v22, v22, 0, vcc
 v_cndmask_b32_e64 v19, v19, 0, vcc
 v_cndmask_b32_e64 v23, v23, 0, vcc
 v_mul_f32 v160, 0xbae38e39, v194
 v_mul_f32 v161, 4.0, v195
 v_mul_f32 v144, v160, v161
 v_add_f32 v145, v144, v160
 v_add_f32 v146, v145, v160
 v_add_f32 v147, v146, v160
 v_mul_f32 v161, 0x41800000, v160
 v_add_f32 v148, v144, v161
 v_add_f32 v149, v145, v161
 v_add_f32 v150, v146, v161
 v_add_f32 v151, v147, v161
 v_sin_f32 v32, v144
 v_sin_f32 v33, v145
 v_sin_f32 v34, v146
 v_sin_f32 v35, v147
 v_sin_f32 v36, v148
 v_sin_f32 v37, v149
 v_sin_f32 v38, v150
 v_sin_f32 v39, v151
 v_cos_f32 v24, v144
 v_cos_f32 v25, v145
 v_cos_f32 v26, v146
 v_cos_f32 v27, v147
 v_cos_f32 v28, v148
 v_cos_f32 v29, v149
 v_cos_f32 v30, v150
 v_cos_f32 v31, v151
 v_lshrrev_b32 v160, 1, v192
 v_cvt_f32_u32 v160, v160
 v_and_b32 v161, 1, v192
 v_cvt_f32_u32 v161, v161
 v_mul_f32 v161, 0x3e800000, v161
 v_mul_f32 v162, 4.0, v195
 v_cmp_lt_u32 vcc, 1, v193
 v_add_f32 v163, 0x00000000, v160
 v_mul_f32 v163, 0x3d2aaaab, v163
 v_fma_f32 v144, v163, v162, v161
 v_add_f32 v145, v144, v163
 v_add_f32 v146, v145, v163
 v_add_f32 v147, v146, v163
 v_mul_f32 v164, 0x41800000, v163
 v_add_f32 v148, v144, v164
 v_add_f32 v149, v145, v164
 v_add_f32 v150, v146, v164
 v_add_f32 v151, v147, v164
 v_add_f32 v152, 0xbe800000, v144
 v_add_f32 v153, 0xbe800000, v145
 v_add_f32 v154, 0xbe800000, v146
 v_add_f32 v155, 0xbe800000, v147
 v_add_f32 v156, 0xbe800000, v148
 v_add_f32 v157, 0xbe800000, v149
 v_add_f32 v158, 0xbe800000, v150
 v_add_f32 v159, 0xbe800000, v151
 v_cos_f32 v144, v144
 v_cos_f32 v145, v145
 v_cos_f32 v146, v146
 v_cos_f32 v147, v147
 v_cos_f32 v148, v148
 v_cos_f32 v149, v149
 v_cos_f32 v150, v150
 v_cos_f32 v151, v151
 v_cvt_pk_bf16_f32 v40, v144, v145
 v_cvt_pk_bf16_f32 v41, v146, v147
 v_cvt_pk_bf16_f32 v42, v148, v149
 v_cvt_pk_bf16_f32 v43, v150, v151
 v_cos_f32 v152, v152
 v_cos_f32 v153, v153
 v_cos_f32 v154, v154
 v_cos_f32 v155, v155
 v_cos_f32 v156, v156
 v_cos_f32 v157, v157
 v_cos_f32 v158, v158
 v_cos_f32 v159, v159
 v_cvt_pk_bf16_f32 v52, v152, v153
 v_cvt_pk_bf16_f32 v53, v154, v155
 v_cvt_pk_bf16_f32 v54, v156, v157
 v_cvt_pk_bf16_f32 v55, v158, v159
 v_cndmask_b32_e64 v42, v42, 0, vcc
 v_cndmask_b32_e64 v54, v54, 0, vcc
 v_cndmask_b32_e64 v43, v43, 0, vcc
 v_cndmask_b32_e64 v55, v55, 0, vcc
 v_add_f32 v163, 0x41000000, v160
 v_mul_f32 v163, 0x3d2aaaab, v163
 v_fma_f32 v144, v163, v162, v161
 v_add_f32 v145, v144, v163
 v_add_f32 v146, v145, v163
 v_add_f32 v147, v146, v163
 v_mul_f32 v164, 0x41800000, v163
 v_add_f32 v148, v144, v164
 v_add_f32 v149, v145, v164
 v_add_f32 v150, v146, v164
 v_add_f32 v151, v147, v164
 v_add_f32 v152, 0xbe800000, v144
 v_add_f32 v153, 0xbe800000, v145
 v_add_f32 v154, 0xbe800000, v146
 v_add_f32 v155, 0xbe800000, v147
 v_add_f32 v156, 0xbe800000, v148
 v_add_f32 v157, 0xbe800000, v149
 v_add_f32 v158, 0xbe800000, v150
 v_add_f32 v159, 0xbe800000, v151
 v_cos_f32 v144, v144
 v_cos_f32 v145, v145
 v_cos_f32 v146, v146
 v_cos_f32 v147, v147
 v_cos_f32 v148, v148
 v_cos_f32 v149, v149
 v_cos_f32 v150, v150
 v_cos_f32 v151, v151
 v_cvt_pk_bf16_f32 v44, v144, v145
 v_cvt_pk_bf16_f32 v45, v146, v147
 v_cvt_pk_bf16_f32 v46, v148, v149
 v_cvt_pk_bf16_f32 v47, v150, v151
 v_cos_f32 v152, v152
 v_cos_f32 v153, v153
 v_cos_f32 v154, v154
 v_cos_f32 v155, v155
 v_cos_f32 v156, v156
 v_cos_f32 v157, v157
 v_cos_f32 v158, v158
 v_cos_f32 v159, v159
 v_cvt_pk_bf16_f32 v56, v152, v153
 v_cvt_pk_bf16_f32 v57, v154, v155
 v_cvt_pk_bf16_f32 v58, v156, v157
 v_cvt_pk_bf16_f32 v59, v158, v159
 v_cndmask_b32_e64 v46, v46, 0, vcc
 v_cndmask_b32_e64 v58, v58, 0, vcc
 v_cndmask_b32_e64 v47, v47, 0, vcc
 v_cndmask_b32_e64 v59, v59, 0, vcc
 v_add_f32 v163, 0x41800000, v160
 v_mul_f32 v163, 0x3d2aaaab, v163
 v_fma_f32 v144, v163, v162, v161
 v_add_f32 v145, v144, v163
 v_add_f32 v146, v145, v163
 v_add_f32 v147, v146, v163
 v_mul_f32 v164, 0x41800000, v163
 v_add_f32 v148, v144, v164
 v_add_f32 v149, v145, v164
 v_add_f32 v150, v146, v164
 v_add_f32 v151, v147, v164
 v_add_f32 v152, 0xbe800000, v144
 v_add_f32 v153, 0xbe800000, v145
 v_add_f32 v154, 0xbe800000, v146
 v_add_f32 v155, 0xbe800000, v147
 v_add_f32 v156, 0xbe800000, v148
 v_add_f32 v157, 0xbe800000, v149
 v_add_f32 v158, 0xbe800000, v150
 v_add_f32 v159, 0xbe800000, v151
 v_cos_f32 v144, v144
 v_cos_f32 v145, v145
 v_cos_f32 v146, v146
 v_cos_f32 v147, v147
 v_cos_f32 v148, v148
 v_cos_f32 v149, v149
 v_cos_f32 v150, v150
 v_cos_f32 v151, v151
 v_cvt_pk_bf16_f32 v48, v144, v145
 v_cvt_pk_bf16_f32 v49, v146, v147
 v_cvt_pk_bf16_f32 v50, v148, v149
 v_cvt_pk_bf16_f32 v51, v150, v151
 v_cos_f32 v152, v152
 v_cos_f32 v153, v153
 v_cos_f32 v154, v154
 v_cos_f32 v155, v155
 v_cos_f32 v156, v156
 v_cos_f32 v157, v157
 v_cos_f32 v158, v158
 v_cos_f32 v159, v159
 v_cvt_pk_bf16_f32 v60, v152, v153
 v_cvt_pk_bf16_f32 v61, v154, v155
 v_cvt_pk_bf16_f32 v62, v156, v157
 v_cvt_pk_bf16_f32 v63, v158, v159
 v_cndmask_b32_e64 v50, v50, 0, vcc
 v_cndmask_b32_e64 v62, v62, 0, vcc
 v_cndmask_b32_e64 v51, v51, 0, vcc
 v_cndmask_b32_e64 v63, v63, 0, vcc
 s_lshl_b32 s41, s20, 13
 s_add_u32 s41, s41, s77
 s_mov_b32 exec_lo, 0x0
 s_mov_b32 exec_hi, 0xfffff000
 s_waitcnt vmcnt(5)
 buffer_load_dword v254, v253, s[8:11], s41 offen
 s_mov_b64 exec, -1
 s_add_u32 s40, s77, 32768
 s_cmp_eq_u32 s20, 0
 s_cselect_b32 s42, 32, 0
 v_cmp_gt_u32 vcc, s42, v0
 v_mov_b32 v84, 0x7ffffff0
 s_nop 0
 v_cndmask_b32 v84, v84, v253, vcc
 buffer_load_dword v255, v84, s[8:11], s40 offen
 s_mul_i32 s46, s3, 4624
 s_and_b32 s47, s20, 1
 s_mul_i32 s47, s47, 3072
 s_add_u32 s46, s46, s47
 s_mul_i32 s47, s20, 3072
 s_add_u32 s47, s47, 59904
 s_add_u32 s45, s46, 0
 s_add_u32 m0, s47, 0
 s_nop 0
 buffer_load_dwordx4 v96, s[84:87], s45 offen lds
 s_add_u32 s45, s46, 1024
 s_add_u32 m0, s47, 1024
 s_nop 0
 buffer_load_dwordx4 v96, s[84:87], s45 offen lds
 s_add_u32 s45, s46, 2048
 s_add_u32 m0, s47, 2048
 s_nop 0
 buffer_load_dwordx4 v96, s[84:87], s45 offen lds
 s_add_u32 s29, s62, 0
 buffer_load_dword v8, v5, s[4:7], s29 offen
 s_add_u32 s29, s58, 0
 s_mov_b64 s[46:47], 0xff
 s_lshl_b64 s[46:47], s[46:47], s59
 s_mov_b64 exec, s[46:47]
 buffer_load_dword v8, v5, s[4:7], s29 offen
 s_mov_b64 exec, -1
 v_lshrrev_b32 v160, 1, v192
 v_cvt_f32_u32 v160, v160
 v_and_b32 v161, 1, v192
 v_cvt_f32_u32 v161, v161
 v_cvt_f32_u32 v162, s3
 v_mul_f32 v161, 0x3e800000, v161
 v_mul_f32 v162, 0x3b800000, v162
 v_fma_f32 v162, 4.0, v195, v162
 v_mul_f32 v163, 0x3e000000, v160
 v_fma_f32 v144, v162, v163, v161
 v_add_f32 v146, v144, v163
 v_add_f32 v148, v146, v163
 v_add_f32 v150, v148, v163
 v_add_f32 v145, 0xbe800000, v144
 v_add_f32 v147, 0xbe800000, v146
 v_add_f32 v149, 0xbe800000, v148
 v_add_f32 v151, 0xbe800000, v150
 v_cos_f32 v144, v144
 v_cos_f32 v145, v145
 v_cos_f32 v146, v146
 v_cos_f32 v147, v147
 v_cos_f32 v148, v148
 v_cos_f32 v149, v149
 v_cos_f32 v150, v150
 v_cos_f32 v151, v151
 v_cvt_pk_bf16_f32 v64, v144, v145
 v_cvt_pk_bf16_f32 v65, v146, v147
 v_cvt_pk_bf16_f32 v66, v148, v149
 v_cvt_pk_bf16_f32 v67, v150, v151
 v_cmp_lt_u32 vcc, 1, v193
 s_nop 1
 v_cndmask_b32_e64 v64, v64, 0, vcc
 v_cndmask_b32_e64 v65, v65, 0, vcc
 v_cndmask_b32_e64 v66, v66, 0, vcc
 v_cndmask_b32_e64 v67, v67, 0, vcc
 v_lshrrev_b32 v144, 2, v192
 v_lshl_add_u32 v144, v193, 3, v144
 v_mul_u32_u24 v144, 48, v144
 v_and_b32 v145, 3, v0
 v_lshl_add_u32 v144, v145, 3, v144
 s_mul_i32 s46, s20, 3200
 s_add_u32 s46, s46, 36864
 v_add_u32 v68, s46, v144
 s_lshl_b32 s46, s20, 3
 s_add_u32 s46, s46, 49664
 v_lshl_add_u32 v144, v193, 1, 0
 v_mul_u32_u24 v144, 24, v144
 v_add_u32 v144, v144, v192
 v_sub_u32 v145, 576, v144
 v_cmp_lt_u32 vcc, 288, v144
 s_nop 1
 v_cndmask_b32 v146, v144, v145, vcc
 v_cmp_lt_u32 s[46:47], 12, v192
 v_add_u32 v147, -1, v192
 v_cmp_lt_u32 s[48:49], 10, v147
 s_nop 0
 s_and_b64 s[48:49], s[48:49], vcc
 s_or_b64 s[48:49], s[48:49], s[46:47]
 v_mov_b32 v147, 300
 v_cndmask_b32_e64 v146, v146, v147, s[48:49]
 s_lshl_b32 s46, s20, 3
 s_add_u32 s46, s46, 49664
 v_lshlrev_b32 v146, 5, v146
 v_add_u32 v69, s46, v146
 v_lshl_add_u32 v144, v193, 1, 1
 v_mul_u32_u24 v144, 24, v144
 v_add_u32 v144, v144, v192
 v_sub_u32 v145, 576, v144
 v_cmp_lt_u32 vcc, 288, v144
 s_nop 1
 v_cndmask_b32 v146, v144, v145, vcc
 v_cmp_lt_u32 s[46:47], 12, v192
 v_add_u32 v147, -1, v192
 v_cmp_lt_u32 s[48:49], 10, v147
 s_nop 0
 s_and_b64 s[48:49], s[48:49], vcc
 s_or_b64 s[48:49], s[48:49], s[46:47]
 v_mov_b32 v147, 300
 v_cndmask_b32_e64 v146, v146, v147, s[48:49]
 s_lshl_b32 s46, s20, 3
 s_add_u32 s46, s46, 49664
 v_lshlrev_b32 v146, 5, v146
 v_add_u32 v70, s46, v146
 v_lshl_add_u32 v144, v193, 1, 8
 v_mul_u32_u24 v144, 24, v144
 v_add_u32 v144, v144, v192
 v_sub_u32 v145, 576, v144
 v_cmp_lt_u32 vcc, 288, v144
 s_nop 1
 v_cndmask_b32 v146, v144, v145, vcc
 v_mov_b32 v147, 0x80000000
 v_cndmask_b32_e64 v75, 0, v147, vcc
 v_cmp_lt_u32 s[46:47], 12, v192
 v_add_u32 v147, -1, v192
 v_cmp_lt_u32 s[48:49], 10, v147
 s_nop 0
 s_and_b64 s[48:49], s[48:49], vcc
 s_or_b64 s[48:49], s[48:49], s[46:47]
 v_mov_b32 v147, 300
 v_cndmask_b32_e64 v146, v146, v147, s[48:49]
 s_lshl_b32 s46, s20, 3
 s_add_u32 s46, s46, 49664
 v_lshlrev_b32 v146, 5, v146
 v_add_u32 v71, s46, v146
 v_lshl_add_u32 v144, v193, 1, 9
 v_mul_u32_u24 v144, 24, v144
 v_add_u32 v144, v144, v192
 v_sub_u32 v145, 576, v144
 v_cmp_lt_u32 vcc, 288, v144
 s_nop 1
 v_cndmask_b32 v146, v144, v145, vcc
 v_mov_b32 v147, 0x80000000
 v_cndmask_b32_e64 v76, 0, v147, vcc
 v_cmp_lt_u32 s[46:47], 12, v192
 v_add_u32 v147, -1, v192
 v_cmp_lt_u32 s[48:49], 10, v147
 s_nop 0
 s_and_b64 s[48:49], s[48:49], vcc
 s_or_b64 s[48:49], s[48:49], s[46:47]
 v_mov_b32 v147, 300
 v_cndmask_b32_e64 v146, v146, v147, s[48:49]
 s_lshl_b32 s46, s20, 3
 s_add_u32 s46, s46, 49664
 v_lshlrev_b32 v146, 5, v146
 v_add_u32 v72, s46, v146
 v_lshl_add_u32 v144, v193, 1, 16
 v_mul_u32_u24 v144, 24, v144
 v_add_u32 v144, v144, v192
 v_sub_u32 v145, 576, v144
 v_cmp_lt_u32 vcc, 288, v144
 s_nop 1
 v_cndmask_b32 v146, v144, v145, vcc
 v_cmp_lt_u32 s[46:47], 12, v192
 v_add_u32 v147, -1, v192
 v_cmp_lt_u32 s[48:49], 10, v147
 s_nop 0
 s_and_b64 s[48:49], s[48:49], vcc
 s_or_b64 s[48:49], s[48:49], s[46:47]
 v_mov_b32 v147, 300
 v_cndmask_b32_e64 v146, v146, v147, s[48:49]
 s_lshl_b32 s46, s20, 3
 s_add_u32 s46, s46, 49664
 v_lshlrev_b32 v146, 5, v146
 v_add_u32 v73, s46, v146
 v_lshl_add_u32 v144, v193, 1, 17
 v_mul_u32_u24 v144, 24, v144
 v_add_u32 v144, v144, v192
 v_sub_u32 v145, 576, v144
 v_cmp_lt_u32 vcc, 288, v144
 s_nop 1
 v_cndmask_b32 v146, v144, v145, vcc
 v_cmp_lt_u32 s[46:47], 12, v192
 v_add_u32 v147, -1, v192
 v_cmp_lt_u32 s[48:49], 10, v147
 s_nop 0
 s_and_b64 s[48:49], s[48:49], vcc
 s_or_b64 s[48:49], s[48:49], s[46:47]
 v_mov_b32 v147, 300
 v_cndmask_b32_e64 v146, v146, v147, s[48:49]
 s_lshl_b32 s46, s20, 3
 s_add_u32 s46, s46, 49664
 v_lshlrev_b32 v146, 5, v146
 v_add_u32 v74, s46, v146
 s_lshl_b32 s46, s20, 9
 s_add_u32 s46, s46, 49664
 v_and_b32 v144, 1, v193
 v_lshlrev_b32 v144, 4, v144
 v_lshl_add_u32 v144, v192, 5, v144
 v_add_u32 v77, s46, v144
 v_lshlrev_b32 v144, 2, v0
 s_mul_i32 s46, s20, 3200
 s_add_u32 s46, s46, 36864
 v_add_u32 v98, s46, v144
 v_mul_u32_u24 v147, 6400, v193
 s_lshl_b32 s46, s20, 4
 s_add_u32 s46, s46, 0
 v_add_u32 v144, s46, v192
 v_mul_u32_u24 v145, 5462, v144
 v_lshrrev_b32 v145, 16, v145
 v_mul_u32_u24 v146, 12, v145
 v_sub_u32 v146, v144, v146
 v_lshlrev_b32 v145, 7, v145
 v_lshl_add_u32 v146, v146, 3, v145
 v_add_u32 v146, v146, v147
 v_add_u32 v205, 36864, v146
 s_lshl_b32 s46, s20, 4
 s_add_u32 s46, s46, 64
 v_add_u32 v144, s46, v192
 v_mul_u32_u24 v145, 5462, v144
 v_lshrrev_b32 v145, 16, v145
 v_mul_u32_u24 v146, 12, v145
 v_sub_u32 v146, v144, v146
 v_lshlrev_b32 v145, 7, v145
 v_lshl_add_u32 v146, v146, 3, v145
 v_add_u32 v146, v146, v147
 v_add_u32 v206, 36864, v146
 s_lshl_b32 s46, s20, 4
 s_add_u32 s46, s46, 128
 v_add_u32 v144, s46, v192
 v_mul_u32_u24 v145, 5462, v144
 v_lshrrev_b32 v145, 16, v145
 v_mul_u32_u24 v146, 12, v145
 v_sub_u32 v146, v144, v146
 v_lshlrev_b32 v145, 7, v145
 v_lshl_add_u32 v146, v146, 3, v145
 v_add_u32 v146, v146, v147
 v_add_u32 v207, 36864, v146
 s_lshl_b32 s46, s20, 4
 s_add_u32 s46, s46, 192
 v_add_u32 v144, s46, v192
 v_mul_u32_u24 v145, 5462, v144
 v_lshrrev_b32 v145, 16, v145
 v_mul_u32_u24 v146, 12, v145
 v_sub_u32 v146, v144, v146
 v_lshlrev_b32 v145, 7, v145
 v_lshl_add_u32 v146, v146, 3, v145
 v_add_u32 v146, v146, v147
 v_add_u32 v208, 36864, v146
 s_lshl_b32 s46, s20, 4
 s_add_u32 s46, s46, 256
 v_add_u32 v144, s46, v192
 v_mul_u32_u24 v145, 5462, v144
 v_lshrrev_b32 v145, 16, v145
 v_mul_u32_u24 v146, 12, v145
 v_sub_u32 v146, v144, v146
 v_lshlrev_b32 v145, 7, v145
 v_lshl_add_u32 v146, v146, 3, v145
 v_add_u32 v146, v146, v147
 v_add_u32 v209, 36864, v146
 v_mov_b32 v145, 62464
 v_cmp_gt_u32 vcc, 300, v144
 s_nop 1
 v_cndmask_b32 v209, v145, v209, vcc
 v_mul_u32_u24 v144, 1156, v193
 v_lshl_add_u32 v144, v192, 1, v144
 s_lshl_b32 s46, s20, 5
 s_add_u32 s46, s46, 59904
 v_add_u32 v204, s46, v144
 s_waitcnt vmcnt(7)
 v_readfirstlane_b32 s60, v94
 s_nop 0
 s_mul_i32 s60, s60, 0x19660d
 s_add_u32 s60, s60, 0x3c6ef35f
 ds_read_b64_tr_b16 v[104:105], v68 offset:0
 ds_read_b64_tr_b16 v[106:107], v68 offset:192
 ds_read_b64_tr_b16 v[108:109], v68 offset:32
 ds_read_b64_tr_b16 v[110:111], v68 offset:224
 ds_read_b64_tr_b16 v[112:113], v68 offset:1600
 ds_read_b64_tr_b16 v[114:115], v68 offset:1792
 ds_read_b64_tr_b16 v[116:117], v68 offset:1632
 ds_read_b64_tr_b16 v[118:119], v68 offset:1824
 s_waitcnt lgkmcnt(6)
 v_mfma_f32_16x16x32_bf16 v[144:147], v[104:107], v[16:19], 0
 v_mfma_f32_16x16x32_bf16 v[152:155], v[104:107], v[20:23], 0
 s_waitcnt lgkmcnt(4)
 v_mfma_f32_16x16x32_bf16 v[148:151], v[108:111], v[16:19], 0
 v_mfma_f32_16x16x32_bf16 v[156:159], v[108:111], v[20:23], 0
 s_waitcnt lgkmcnt(2)
 v_mfma_f32_16x16x32_bf16 v[160:163], v[112:115], v[16:19], 0
 v_mfma_f32_16x16x32_bf16 v[168:171], v[112:115], v[20:23], 0
 s_waitcnt lgkmcnt(0)
 v_mfma_f32_16x16x32_bf16 v[164:167], v[116:119], v[16:19], 0
 v_mfma_f32_16x16x32_bf16 v[172:175], v[116:119], v[20:23], 0
 v_mul_f32 v194, v152, v32
 v_mul_f32 v152, v152, v24
 v_fma_f32 v152, v144, v32, v152
 v_fma_f32 v144, v144, v24, -v194
 v_mul_f32 v194, v153, v33
 v_mul_f32 v153, v153, v25
 v_fma_f32 v153, v145, v33, v153
 v_fma_f32 v145, v145, v25, -v194
 v_mul_f32 v194, v154, v34
 v_mul_f32 v154, v154, v26
 v_fma_f32 v154, v146, v34, v154
 v_fma_f32 v146, v146, v26, -v194
 v_mul_f32 v194, v155, v35
 v_mul_f32 v155, v155, v27
 v_fma_f32 v155, v147, v35, v155
 v_fma_f32 v147, v147, v27, -v194
 v_mul_f32 v194, v156, v36
 v_mul_f32 v156, v156, v28
 v_fma_f32 v156, v148, v36, v156
 v_fma_f32 v148, v148, v28, -v194
 v_mul_f32 v194, v157, v37
 v_mul_f32 v157, v157, v29
 v_fma_f32 v157, v149, v37, v157
 v_fma_f32 v149, v149, v29, -v194
 s_add_u32 s28, s23, 0
 s_add_u32 m0, s25, 0
 s_nop 0
 buffer_load_dwordx4 v4, s[68:71], s28 offen lds
 v_mul_f32 v194, v158, v38
 v_mul_f32 v158, v158, v30
 v_fma_f32 v158, v150, v38, v158
 v_fma_f32 v150, v150, v30, -v194
 v_mul_f32 v194, v159, v39
 v_mul_f32 v159, v159, v31
 v_fma_f32 v159, v151, v39, v159
 v_fma_f32 v151, v151, v31, -v194
 v_cvt_pk_bf16_f32 v176, v144, v145
 v_cvt_pk_bf16_f32 v177, v146, v147
 v_cvt_pk_bf16_f32 v178, v148, v149
 v_cvt_pk_bf16_f32 v179, v150, v151
 s_add_u32 s28, s23, 147456
 s_add_u32 m0, s25, 2048
 s_nop 0
 buffer_load_dwordx4 v4, s[68:71], s28 offen lds
 v_cvt_pk_bf16_f32 v180, v152, v153
 v_cvt_pk_bf16_f32 v181, v154, v155
 v_cvt_pk_bf16_f32 v182, v156, v157
 v_cvt_pk_bf16_f32 v183, v158, v159
 v_mul_f32 v194, v168, v32
 v_mul_f32 v168, v168, v24
 v_fma_f32 v168, v160, v32, v168
 v_fma_f32 v160, v160, v24, -v194
 v_mul_f32 v194, v169, v33
 v_mul_f32 v169, v169, v25
 v_fma_f32 v169, v161, v33, v169
 v_fma_f32 v161, v161, v25, -v194
 s_add_u32 s28, s23, 294912
 s_add_u32 m0, s25, 4096
 s_nop 0
 buffer_load_dwordx4 v4, s[68:71], s28 offen lds
 v_mul_f32 v194, v170, v34
 v_mul_f32 v170, v170, v26
 v_fma_f32 v170, v162, v34, v170
 v_fma_f32 v162, v162, v26, -v194
 v_mul_f32 v194, v171, v35
 v_mul_f32 v171, v171, v27
 v_fma_f32 v171, v163, v35, v171
 v_fma_f32 v163, v163, v27, -v194
 v_mul_f32 v194, v172, v36
 v_mul_f32 v172, v172, v28
 v_fma_f32 v172, v164, v36, v172
 v_fma_f32 v164, v164, v28, -v194
 s_add_u32 s28, s23, 442368
 s_add_u32 m0, s25, 6144
 s_nop 0
 buffer_load_dwordx4 v4, s[68:71], s28 offen lds
 v_mul_f32 v194, v173, v37
 v_mul_f32 v173, v173, v29
 v_fma_f32 v173, v165, v37, v173
 v_fma_f32 v165, v165, v29, -v194
 v_mul_f32 v194, v174, v38
 v_mul_f32 v174, v174, v30
 v_fma_f32 v174, v166, v38, v174
 v_fma_f32 v166, v166, v30, -v194
 v_mul_f32 v194, v175, v39
 v_mul_f32 v175, v175, v31
 v_fma_f32 v175, v167, v39, v175
 v_fma_f32 v167, v167, v31, -v194
 s_add_u32 s28, s23, 589824
 s_add_u32 m0, s25, 8192
 s_nop 0
 buffer_load_dwordx4 v4, s[68:71], s28 offen lds
 v_cvt_pk_bf16_f32 v184, v160, v161
 v_cvt_pk_bf16_f32 v185, v162, v163
 v_cvt_pk_bf16_f32 v186, v164, v165
 v_cvt_pk_bf16_f32 v187, v166, v167
 v_cvt_pk_bf16_f32 v188, v168, v169
 v_cvt_pk_bf16_f32 v189, v170, v171
 v_cvt_pk_bf16_f32 v190, v172, v173
 v_cvt_pk_bf16_f32 v191, v174, v175
 v_mfma_f32_16x16x32_bf16 v[144:147], v[40:43], v[176:179], 0
 v_mfma_f32_16x16x32_bf16 v[144:147], v[52:55], v[180:183], v[144:147]
 v_mfma_f32_16x16x32_bf16 v[148:151], v[44:47], v[176:179], 0
 v_mfma_f32_16x16x32_bf16 v[148:151], v[56:59], v[180:183], v[148:151]
 v_xor_b32 v4, 64, v4
 s_add_u32 s28, s23, 73728
 s_add_u32 m0, s25, 1024
 s_nop 0
 buffer_load_dwordx4 v4, s[68:71], s28 offen lds
 v_mfma_f32_16x16x32_bf16 v[152:155], v[48:51], v[176:179], 0
 v_mfma_f32_16x16x32_bf16 v[152:155], v[60:63], v[180:183], v[152:155]
 v_mfma_f32_16x16x32_bf16 v[160:163], v[40:43], v[184:187], 0
 v_mfma_f32_16x16x32_bf16 v[160:163], v[52:55], v[188:191], v[160:163]
 v_mfma_f32_16x16x32_bf16 v[164:167], v[44:47], v[184:187], 0
 v_mfma_f32_16x16x32_bf16 v[164:167], v[56:59], v[188:191], v[164:167]
 v_mfma_f32_16x16x32_bf16 v[168:171], v[48:51], v[184:187], 0
 v_mfma_f32_16x16x32_bf16 v[168:171], v[60:63], v[188:191], v[168:171]
 v_cvt_pk_bf16_f32 v176, v144, v145
 ds_write_b32 v69, v176 offset:0
 v_cvt_pk_bf16_f32 v177, v146, v147
 ds_write_b32 v70, v177 offset:0
 s_add_u32 s28, s23, 221184
 s_add_u32 m0, s25, 3072
 s_nop 0
 buffer_load_dwordx4 v4, s[68:71], s28 offen lds
 v_cvt_pk_bf16_f32 v178, v148, v149
 v_xor_b32 v178, v75, v178
 ds_write_b32 v71, v178 offset:0
 v_cvt_pk_bf16_f32 v179, v150, v151
 v_xor_b32 v179, v76, v179
 ds_write_b32 v72, v179 offset:0
 v_cvt_pk_bf16_f32 v180, v152, v153
 v_xor_b32 v180, 0x80000000, v180
 ds_write_b32 v73, v180 offset:0
 v_cvt_pk_bf16_f32 v181, v154, v155
 v_xor_b32 v181, 0x80000000, v181
 ds_write_b32 v74, v181 offset:0
 s_add_u32 s28, s23, 368640
 s_add_u32 m0, s25, 5120
 s_nop 0
 buffer_load_dwordx4 v4, s[68:71], s28 offen lds
 v_cvt_pk_bf16_f32 v176, v160, v161
 ds_write_b32 v69, v176 offset:4
 v_cvt_pk_bf16_f32 v177, v162, v163
 ds_write_b32 v70, v177 offset:4
 v_cvt_pk_bf16_f32 v178, v164, v165
 v_xor_b32 v178, v75, v178
 ds_write_b32 v71, v178 offset:4
 v_cvt_pk_bf16_f32 v179, v166, v167
 v_xor_b32 v179, v76, v179
 ds_write_b32 v72, v179 offset:4
 v_cvt_pk_bf16_f32 v180, v168, v169
 v_xor_b32 v180, 0x80000000, v180
 s_add_u32 s28, s23, 516096
 s_add_u32 m0, s25, 7168
 s_nop 0
 buffer_load_dwordx4 v4, s[68:71], s28 offen lds
 v_xor_b32 v4, 64, v4
 ds_write_b32 v73, v180 offset:4
 v_cvt_pk_bf16_f32 v181, v170, v171
 v_xor_b32 v181, 0x80000000, v181
 ds_write_b32 v74, v181 offset:4
 s_waitcnt lgkmcnt(0)
 s_waitcnt vmcnt(11)
 s_barrier
 ds_read_b128 v[120:123], v77 offset:0
 ds_read_b128 v[124:127], v77 offset:2048
 ds_read_b128 v[128:131], v77 offset:4096
 ds_read_b128 v[132:135], v77 offset:6144
 ds_read_b128 v[136:139], v77 offset:8192
 ds_read_u16 v164, v204 offset:0
 ds_read_u16 v165, v204 offset:6144
 ds_read_u16 v166, v204 offset:578
 ds_read_u16 v167, v204 offset:6722
 ds_read_u16 v168, v204 offset:128
 ds_read_u16 v169, v204 offset:6272
 ds_read_u16 v170, v204 offset:706
 ds_read_u16 v171, v204 offset:6850
 ds_read_u16 v172, v204 offset:256
 ds_read_u16 v173, v204 offset:6400
 ds_read_u16 v174, v204 offset:834
 ds_read_u16 v175, v204 offset:6978
 ds_read_u16 v192, v204 offset:384
 ds_read_u16 v193, v204 offset:6528
 ds_read_u16 v194, v204 offset:962
 ds_read_u16 v195, v204 offset:7106
 ds_read_u16 v196, v204 offset:512
 ds_read_u16 v197, v204 offset:6656
 ds_read_u16 v198, v204 offset:1090
 ds_read_u16 v199, v204 offset:7234
 s_waitcnt lgkmcnt(15)
 v_mfma_f32_16x16x32_bf16 v[144:147], v[64:67], v[120:123], 0
 v_mfma_f32_16x16x32_bf16 v[148:151], v[64:67], v[124:127], 0
 v_mfma_f32_16x16x32_bf16 v[152:155], v[64:67], v[128:131], 0
 v_mfma_f32_16x16x32_bf16 v[156:159], v[64:67], v[132:135], 0
 v_mfma_f32_16x16x32_bf16 v[160:163], v[64:67], v[136:139], 0
 s_nop 3
 v_cvt_pk_bf16_f32 v104, v144, v145
 v_lshl_or_b32 v105, v165, 16, v164
 s_add_u32 s28, s38, 0
 s_add_u32 m0, s39, 0
 s_nop 0
 buffer_load_dwordx4 v80, s[8:11], s28 offen lds
 v_cvt_pk_bf16_f32 v106, v146, v147
 v_lshl_or_b32 v107, v167, 16, v166
 v_cvt_pk_bf16_f32 v108, v148, v149
 s_waitcnt lgkmcnt(14)
 v_lshl_or_b32 v109, v169, 16, v168
 v_cvt_pk_bf16_f32 v110, v150, v151
 s_waitcnt lgkmcnt(12)
 v_lshl_or_b32 v111, v171, 16, v170
 v_cvt_pk_bf16_f32 v112, v152, v153
 s_add_u32 s28, s38, 9216
 s_add_u32 m0, s39, 1024
 s_nop 0
 buffer_load_dwordx4 v80, s[8:11], s28 offen lds
 s_waitcnt lgkmcnt(10)
 v_lshl_or_b32 v113, v173, 16, v172
 v_cvt_pk_bf16_f32 v114, v154, v155
 s_waitcnt lgkmcnt(8)
 v_lshl_or_b32 v115, v175, 16, v174
 v_cvt_pk_bf16_f32 v116, v156, v157
 s_waitcnt lgkmcnt(6)
 v_lshl_or_b32 v117, v193, 16, v192
 v_cvt_pk_bf16_f32 v118, v158, v159
 s_waitcnt lgkmcnt(4)
 v_lshl_or_b32 v119, v195, 16, v194
 s_add_u32 s28, s38, 128
 s_add_u32 m0, s39, 2048
 s_nop 0
 buffer_load_dwordx4 v80, s[8:11], s28 offen lds
 v_cvt_pk_bf16_f32 v176, v160, v161
 s_waitcnt lgkmcnt(2)
 v_lshl_or_b32 v177, v197, 16, v196
 v_cvt_pk_bf16_f32 v178, v162, v163
 s_waitcnt lgkmcnt(0)
 v_lshl_or_b32 v179, v199, 16, v198
 s_barrier
 ds_write_b64 v205, v[104:105] offset:0
 ds_write_b64 v205, v[106:107] offset:3200
 s_add_u32 s28, s38, 9344
 s_add_u32 m0, s39, 3072
 s_nop 0
 buffer_load_dwordx4 v80, s[8:11], s28 offen lds
 ds_write_b64 v206, v[108:109] offset:0
 ds_write_b64 v206, v[110:111] offset:3200
 ds_write_b64 v207, v[112:113] offset:0
 ds_write_b64 v207, v[114:115] offset:3200
 ds_write_b64 v208, v[116:117] offset:0
 ds_write_b64 v208, v[118:119] offset:3200
 ds_write_b64 v209, v[176:177] offset:0
 s_add_u32 s28, s38, 256
 s_add_u32 m0, s39, 4096
 s_nop 0
 buffer_load_dwordx4 v80, s[8:11], s28 offen lds
 ds_write_b64 v209, v[178:179] offset:3200
 v_lshrrev_b32 v192, 3, v0
 v_and_b32 v193, 7, v0
 v_lshlrev_b32 v193, 4, v193
 v_lshl_add_u32 v192, v192, 15, v193
 s_mul_i32 s46, s20, 7168
 s_add_u32 s46, s46, 36864
 s_add_u32 s28, s38, 9472
 s_add_u32 m0, s39, 5120
 s_nop 0
 buffer_load_dwordx4 v80, s[8:11], s28 offen lds
 v_lshlrev_b32 v193, 4, v0
 v_add_u32 v193, s46, v193
 s_and_b32 s46, s3, 15
 s_lshl_b32 s46, s46, 4
 s_lshr_b32 s47, s3, 4
 s_add_u32 s46, s46, s47
 s_lshl_b32 s46, s46, 7
 s_add_u32 s28, s38, 384
 s_add_u32 m0, s39, 6144
 s_nop 0
 buffer_load_dwordx4 v80, s[8:11], s28 offen lds
 s_mul_i32 s47, s20, 1835008
 s_add_u32 s46, s46, s47
 s_add_u32 s46, s46, 33575552
 s_waitcnt lgkmcnt(0)
 s_barrier
 ds_read_b128 v[144:147], v193 offset:0
 ds_read_b128 v[148:151], v193 offset:1024
 s_add_u32 s28, s38, 9600
 s_add_u32 m0, s39, 7168
 s_nop 0
 buffer_load_dwordx4 v80, s[8:11], s28 offen lds
 ds_read_b128 v[152:155], v193 offset:2048
 ds_read_b128 v[156:159], v193 offset:3072
 ds_read_b128 v[160:163], v193 offset:4096
 ds_read_b128 v[164:167], v193 offset:5120
 ds_read_b128 v[168:171], v193 offset:6144
 s_add_u32 s47, s46, 0
 s_waitcnt lgkmcnt(6)
 buffer_store_dwordx4 v[144:147], v192, s[12:15], s47 offen sc1
 s_add_u32 s28, s38, 512
 s_add_u32 m0, s39, 8192
 s_nop 0
 buffer_load_dwordx4 v80, s[8:11], s28 offen lds
 s_add_u32 s47, s46, 262144
 s_waitcnt lgkmcnt(5)
 buffer_store_dwordx4 v[148:151], v192, s[12:15], s47 offen sc1
 s_add_u32 s47, s46, 524288
 s_waitcnt lgkmcnt(4)
 buffer_store_dwordx4 v[152:155], v192, s[12:15], s47 offen sc1
 s_add_u32 s47, s46, 786432
 s_waitcnt lgkmcnt(3)
 buffer_store_dwordx4 v[156:159], v192, s[12:15], s47 offen sc1
 s_add_u32 s47, s46, 1048576
 s_add_u32 s28, s38, 9728
 s_add_u32 m0, s39, 9216
 s_nop 0
 buffer_load_dwordx4 v80, s[8:11], s28 offen lds
 s_cmp_eq_u32 s20, 3
 s_cselect_b32 s47, 0x7ff00000, s47
 s_waitcnt lgkmcnt(2)
 buffer_store_dwordx4 v[160:163], v192, s[12:15], s47 offen sc1
 s_add_u32 s47, s46, 1310720
 s_cmp_eq_u32 s20, 3
 s_cselect_b32 s47, 0x7ff00000, s47
 s_waitcnt lgkmcnt(1)
 buffer_store_dwordx4 v[164:167], v192, s[12:15], s47 offen sc1
 s_add_u32 s28, s38, 640
 s_add_u32 m0, s39, 10240
 s_nop 0
 buffer_load_dwordx4 v80, s[8:11], s28 offen lds
 s_add_u32 s47, s46, 1572864
 s_cmp_eq_u32 s20, 3
 s_cselect_b32 s47, 0x7ff00000, s47
 s_waitcnt lgkmcnt(0)
 buffer_store_dwordx4 v[168:171], v192, s[12:15], s47 offen sc1
 s_add_u32 s28, s38, 9856
 s_add_u32 m0, s39, 11264
 s_nop 0
 buffer_load_dwordx4 v80, s[8:11], s28 offen lds
 s_add_u32 s28, s38, 768
 s_add_u32 m0, s39, 12288
 s_nop 0
 buffer_load_dwordx4 v80, s[8:11], s28 offen lds
 s_add_u32 s28, s38, 9984
 s_add_u32 m0, s39, 13312
 s_nop 0
 buffer_load_dwordx4 v80, s[8:11], s28 offen lds
 s_add_u32 s28, s38, 896
 s_add_u32 m0, s39, 14336
 s_nop 0
 buffer_load_dwordx4 v80, s[8:11], s28 offen lds
 s_add_u32 s28, s38, 10112
 s_add_u32 m0, s39, 15360
 s_nop 0
 buffer_load_dwordx4 v80, s[8:11], s28 offen lds
 s_add_u32 s28, s38, 1024
 s_add_u32 m0, s39, 16384
 s_nop 0
 buffer_load_dwordx4 v80, s[8:11], s28 offen lds
 s_add_u32 s28, s38, 10240
 s_add_u32 m0, s39, 17408
 s_nop 0
 buffer_load_dwordx4 v80, s[8:11], s28 offen lds
 s_barrier
 s_waitcnt vmcnt(23)
 ds_read_b128 a[0:3], v81 offset:0
 ds_read_b128 a[16:19], v82 offset:0
 v_lshlrev_b32 v172, 4, v0
 s_add_u32 s28, s38, 294912
 s_add_u32 m0, s39, 0
 s_waitcnt vmcnt(21)
 ds_read_b128 a[32:35], v81 offset:2048
 ds_read_b128 a[48:51], v82 offset:2048
 v_add_u32 v172, 147456, v172
 s_waitcnt lgkmcnt(2)
 buffer_load_dwordx4 v80, s[8:11], s28 offen lds
 s_add_u32 s28, s38, 304128
 s_add_u32 m0, s39, 1024
 ds_write_b128 v172, v[16:19] offset:5120
 buffer_load_dwordx4 v80, s[8:11], s28 offen lds
 ds_write_b128 v172, v[20:23] offset:7168
 s_add_u32 s28, s38, 295040
 s_add_u32 m0, s39, 2048
 s_waitcnt vmcnt(21)
 ds_read_b128 a[64:67], v81 offset:4096
 ds_read_b128 a[80:83], v82 offset:4096
 v_and_b32 v104, 15, v0
 s_waitcnt lgkmcnt(4)
 buffer_load_dwordx4 v80, s[8:11], s28 offen lds
 s_add_u32 s28, s38, 304256
 s_add_u32 m0, s39, 3072
 v_lshrrev_b32 v105, 4, v0
 buffer_load_dwordx4 v80, s[8:11], s28 offen lds
 v_cvt_f32_u32 v106, v104
 s_add_u32 s28, s38, 295168
 s_add_u32 m0, s39, 4096
 s_waitcnt vmcnt(21)
 ds_read_b128 a[96:99], v81 offset:6144
 ds_read_b128 a[112:115], v82 offset:6144
 v_cvt_f32_u32 v107, v105
 s_waitcnt lgkmcnt(2)
 buffer_load_dwordx4 v80, s[8:11], s28 offen lds
 s_add_u32 s28, s38, 304384
 s_add_u32 m0, s39, 5120
 v_mul_f32 v124, 0x3d800000, v106
 buffer_load_dwordx4 v80, s[8:11], s28 offen lds
 v_mul_f32 v125, 4.0, v107
 s_add_u32 s28, s38, 295296
 s_add_u32 m0, s39, 6144
 s_waitcnt vmcnt(17)
 ds_read_b128 a[128:131], v81 offset:8192
 ds_read_b128 a[144:147], v82 offset:8192
 v_mul_f32 v108, v124, v125
 s_waitcnt lgkmcnt(2)
 buffer_load_dwordx4 v80, s[8:11], s28 offen lds
 s_add_u32 s28, s38, 304512
 s_add_u32 m0, s39, 7168
 v_add_f32 v109, v108, v124
 buffer_load_dwordx4 v80, s[8:11], s28 offen lds
 v_add_f32 v110, v109, v124
 s_add_u32 s28, s38, 295424
 s_add_u32 m0, s39, 8192
 s_waitcnt vmcnt(14)
 ds_read_b128 a[160:163], v81 offset:10240
 ds_read_b128 a[176:179], v82 offset:10240
 v_add_f32 v111, v110, v124
 s_waitcnt lgkmcnt(2)
 buffer_load_dwordx4 v80, s[8:11], s28 offen lds
 s_add_u32 s28, s38, 304640
 s_add_u32 m0, s39, 9216
 v_sin_f32 v112, v108
 buffer_load_dwordx4 v80, s[8:11], s28 offen lds
 v_sin_f32 v113, v109
 s_add_u32 s28, s38, 295552
 s_add_u32 m0, s39, 10240
 s_waitcnt vmcnt(14)
 ds_read_b128 a[192:195], v81 offset:12288
 ds_read_b128 a[208:211], v82 offset:12288
 v_sin_f32 v114, v110
 s_waitcnt lgkmcnt(2)
 buffer_load_dwordx4 v80, s[8:11], s28 offen lds
 s_add_u32 s28, s38, 304768
 s_add_u32 m0, s39, 11264
 v_sin_f32 v115, v111
 buffer_load_dwordx4 v80, s[8:11], s28 offen lds
 v_cos_f32 v108, v108
 s_add_u32 s28, s38, 295680
 s_add_u32 m0, s39, 12288
 s_waitcnt vmcnt(14)
 ds_read_b128 a[224:227], v81 offset:14336
 ds_read_b128 a[240:243], v82 offset:14336
 v_cos_f32 v109, v109
 s_waitcnt lgkmcnt(2)
 buffer_load_dwordx4 v80, s[8:11], s28 offen lds
 s_add_u32 s28, s38, 304896
 s_add_u32 m0, s39, 13312
 v_cos_f32 v110, v110
 buffer_load_dwordx4 v80, s[8:11], s28 offen lds
 v_cos_f32 v111, v111
 s_add_u32 s28, s38, 295808
 s_add_u32 m0, s39, 14336
 s_waitcnt vmcnt(14)
 ds_read_b128 v[224:227], v81 offset:16384
 ds_read_b128 v[240:243], v82 offset:16384
 v_cvt_pk_bf16_f32 v128, v108, v112
 s_waitcnt lgkmcnt(2)
 buffer_load_dwordx4 v80, s[8:11], s28 offen lds
 s_add_u32 s28, s38, 305024
 s_add_u32 m0, s39, 15360
 v_cvt_pk_bf16_f32 v132, -v112, v108
 buffer_load_dwordx4 v80, s[8:11], s28 offen lds
 v_cvt_pk_bf16_f32 v129, v109, v113
 s_add_u32 s28, s38, 295936
 s_add_u32 m0, s39, 16384
 s_waitcnt vmcnt(14)
 ds_read_b128 a[4:7], v81 offset:0
 ds_read_b128 a[20:23], v82 offset:0
 v_cvt_pk_bf16_f32 v133, -v113, v109
 s_waitcnt lgkmcnt(2)
 buffer_load_dwordx4 v80, s[8:11], s28 offen lds
 s_add_u32 s28, s38, 305152
 s_add_u32 m0, s39, 17408
 v_cvt_pk_bf16_f32 v130, v110, v114
 buffer_load_dwordx4 v80, s[8:11], s28 offen lds
 v_cvt_pk_bf16_f32 v134, -v114, v110
 s_add_u32 s28, s38, 589824
 s_add_u32 m0, s39, 0
 s_waitcnt vmcnt(14)
 ds_read_b128 a[36:39], v81 offset:2048
 ds_read_b128 a[52:55], v82 offset:2048
 v_cvt_pk_bf16_f32 v131, v111, v115
 s_waitcnt lgkmcnt(2)
 buffer_load_dwordx4 v80, s[8:11], s28 offen lds
 s_add_u32 s28, s38, 599040
 s_add_u32 m0, s39, 1024
 v_cvt_pk_bf16_f32 v135, -v115, v111
 buffer_load_dwordx4 v80, s[8:11], s28 offen lds
 v_mul_f32 v124, 0xbb800000, v106
 s_add_u32 s28, s38, 589952
 s_add_u32 m0, s39, 2048
 s_waitcnt vmcnt(14)
 ds_read_b128 a[68:71], v81 offset:4096
 ds_read_b128 a[84:87], v82 offset:4096
 v_mul_f32 v116, v124, v125
 s_waitcnt lgkmcnt(2)
 buffer_load_dwordx4 v80, s[8:11], s28 offen lds
 s_add_u32 s28, s38, 599168
 s_add_u32 m0, s39, 3072
 v_add_f32 v117, v116, v124
 buffer_load_dwordx4 v80, s[8:11], s28 offen lds
 v_add_f32 v118, v117, v124
 s_add_u32 s28, s38, 590080
 s_add_u32 m0, s39, 4096
 s_waitcnt vmcnt(14)
 ds_read_b128 a[100:103], v81 offset:6144
 ds_read_b128 a[116:119], v82 offset:6144
 v_add_f32 v119, v118, v124
 s_waitcnt lgkmcnt(2)
 buffer_load_dwordx4 v80, s[8:11], s28 offen lds
 s_add_u32 s28, s38, 599296
 s_add_u32 m0, s39, 5120
 v_sin_f32 v140, v116
 buffer_load_dwordx4 v80, s[8:11], s28 offen lds
 v_sin_f32 v141, v117
 s_add_u32 s28, s38, 590208
 s_add_u32 m0, s39, 6144
 s_waitcnt vmcnt(14)
 ds_read_b128 a[132:135], v81 offset:8192
 ds_read_b128 a[148:151], v82 offset:8192
 v_sin_f32 v142, v118
 s_waitcnt lgkmcnt(2)
 buffer_load_dwordx4 v80, s[8:11], s28 offen lds
 s_add_u32 s28, s38, 599424
 s_add_u32 m0, s39, 7168
 v_sin_f32 v143, v119
 buffer_load_dwordx4 v80, s[8:11], s28 offen lds
 v_cos_f32 v136, v116
 s_add_u32 s28, s38, 590336
 s_add_u32 m0, s39, 8192
 s_waitcnt vmcnt(14)
 ds_read_b128 a[164:167], v81 offset:10240
 ds_read_b128 a[180:183], v82 offset:10240
 v_cos_f32 v137, v117
 s_waitcnt lgkmcnt(2)
 buffer_load_dwordx4 v80, s[8:11], s28 offen lds
 s_add_u32 s28, s38, 599552
 s_add_u32 m0, s39, 9216
 v_cos_f32 v138, v118
 buffer_load_dwordx4 v80, s[8:11], s28 offen lds
 v_cos_f32 v139, v119
 s_add_u32 s28, s38, 590464
 s_add_u32 m0, s39, 10240
 s_waitcnt vmcnt(14)
 ds_read_b128 a[196:199], v81 offset:12288
 ds_read_b128 a[212:215], v82 offset:12288
 ds_write_b128 v172, v[128:131] offset:0
 s_waitcnt lgkmcnt(3)
 buffer_load_dwordx4 v80, s[8:11], s28 offen lds
 s_add_u32 s28, s38, 599680
 s_add_u32 m0, s39, 11264
 ds_write_b128 v172, v[132:135] offset:1024
 buffer_load_dwordx4 v80, s[8:11], s28 offen lds
 ds_write_b128 v172, v[136:139] offset:2048
 s_add_u32 s28, s38, 590592
 s_add_u32 m0, s39, 12288
 s_waitcnt vmcnt(14)
 ds_read_b128 a[228:231], v81 offset:14336
 ds_read_b128 a[244:247], v82 offset:14336
 ds_write_b128 v172, v[140:143] offset:3072
 s_waitcnt lgkmcnt(6)
 buffer_load_dwordx4 v80, s[8:11], s28 offen lds
 s_add_u32 s28, s38, 599808
 s_add_u32 m0, s39, 13312
 s_nop 0
 buffer_load_dwordx4 v80, s[8:11], s28 offen lds
 s_add_u32 s28, s38, 590720
 s_add_u32 m0, s39, 14336
 s_waitcnt vmcnt(14)
 ds_read_b128 v[228:231], v81 offset:16384
 ds_read_b128 v[244:247], v82 offset:16384
 s_waitcnt lgkmcnt(3)
 buffer_load_dwordx4 v80, s[8:11], s28 offen lds
 s_add_u32 s28, s38, 599936
 s_add_u32 m0, s39, 15360
 s_nop 0
 buffer_load_dwordx4 v80, s[8:11], s28 offen lds
 s_add_u32 s28, s38, 590848
 s_add_u32 m0, s39, 16384
 s_waitcnt vmcnt(14)
 ds_read_b128 a[8:11], v81 offset:0
 ds_read_b128 a[24:27], v82 offset:0
 s_waitcnt lgkmcnt(2)
 buffer_load_dwordx4 v80, s[8:11], s28 offen lds
 s_add_u32 s28, s38, 600064
 s_add_u32 m0, s39, 17408
 s_nop 0
 buffer_load_dwordx4 v80, s[8:11], s28 offen lds
 s_add_u32 s28, s38, 884736
 s_add_u32 m0, s39, 0
 s_waitcnt vmcnt(14)
 ds_read_b128 a[40:43], v81 offset:2048
 ds_read_b128 a[56:59], v82 offset:2048
 s_waitcnt lgkmcnt(2)
 buffer_load_dwordx4 v80, s[8:11], s28 offen lds
 s_add_u32 s28, s38, 893952
 s_add_u32 m0, s39, 1024
 s_nop 0
 buffer_load_dwordx4 v80, s[8:11], s28 offen lds
 s_add_u32 s28, s38, 884864
 s_add_u32 m0, s39, 2048
 s_waitcnt vmcnt(14)
 ds_read_b128 a[72:75], v81 offset:4096
 ds_read_b128 a[88:91], v82 offset:4096
 s_waitcnt lgkmcnt(2)
 buffer_load_dwordx4 v80, s[8:11], s28 offen lds
 s_add_u32 s28, s38, 894080
 s_add_u32 m0, s39, 3072
 s_nop 0
 buffer_load_dwordx4 v80, s[8:11], s28 offen lds
 s_add_u32 s28, s38, 884992
 s_add_u32 m0, s39, 4096
 s_waitcnt vmcnt(14)
 ds_read_b128 a[104:107], v81 offset:6144
 ds_read_b128 a[120:123], v82 offset:6144
 s_waitcnt lgkmcnt(2)
 buffer_load_dwordx4 v80, s[8:11], s28 offen lds
 s_add_u32 s28, s38, 894208
 s_add_u32 m0, s39, 5120
 s_nop 0
 buffer_load_dwordx4 v80, s[8:11], s28 offen lds
 s_add_u32 s28, s38, 885120
 s_add_u32 m0, s39, 6144
 s_waitcnt vmcnt(14)
 ds_read_b128 a[136:139], v81 offset:8192
 ds_read_b128 a[152:155], v82 offset:8192
 s_waitcnt lgkmcnt(2)
 buffer_load_dwordx4 v80, s[8:11], s28 offen lds
 s_add_u32 s28, s38, 894336
 s_add_u32 m0, s39, 7168
 s_nop 0
 buffer_load_dwordx4 v80, s[8:11], s28 offen lds
 s_add_u32 s28, s38, 885248
 s_add_u32 m0, s39, 8192
 s_waitcnt vmcnt(14)
 ds_read_b128 a[168:171], v81 offset:10240
 ds_read_b128 a[184:187], v82 offset:10240
 s_waitcnt lgkmcnt(2)
 buffer_load_dwordx4 v80, s[8:11], s28 offen lds
 s_add_u32 s28, s38, 894464
 s_add_u32 m0, s39, 9216
 s_nop 0
 buffer_load_dwordx4 v80, s[8:11], s28 offen lds
 s_add_u32 s28, s38, 885376
 s_add_u32 m0, s39, 10240
 s_waitcnt vmcnt(14)
 ds_read_b128 a[200:203], v81 offset:12288
 ds_read_b128 a[216:219], v82 offset:12288
 s_waitcnt lgkmcnt(2)
 buffer_load_dwordx4 v80, s[8:11], s28 offen lds
 s_add_u32 s28, s38, 894592
 s_add_u32 m0, s39, 11264
 s_nop 0
 buffer_load_dwordx4 v80, s[8:11], s28 offen lds
 s_add_u32 s28, s38, 885504
 s_add_u32 m0, s39, 12288
 s_waitcnt vmcnt(14)
 ds_read_b128 a[232:235], v81 offset:14336
 ds_read_b128 a[248:251], v82 offset:14336
 s_waitcnt lgkmcnt(2)
 buffer_load_dwordx4 v80, s[8:11], s28 offen lds
 s_add_u32 s28, s38, 894720
 s_add_u32 m0, s39, 13312
 s_nop 0
 buffer_load_dwordx4 v80, s[8:11], s28 offen lds
 s_add_u32 s28, s38, 885632
 s_add_u32 m0, s39, 14336
 s_waitcnt vmcnt(14)
 ds_read_b128 v[232:235], v81 offset:16384
 ds_read_b128 v[248:251], v82 offset:16384
 s_waitcnt lgkmcnt(2)
 buffer_load_dwordx4 v80, s[8:11], s28 offen lds
 s_add_u32 s28, s38, 894848
 s_add_u32 m0, s39, 15360
 s_nop 0
 buffer_load_dwordx4 v80, s[8:11], s28 offen lds
 s_add_u32 s28, s38, 885760
 s_add_u32 m0, s39, 16384
 s_waitcnt vmcnt(14)
 ds_read_b128 a[12:15], v81 offset:0
 ds_read_b128 a[28:31], v82 offset:0
 s_waitcnt lgkmcnt(2)
 buffer_load_dwordx4 v80, s[8:11], s28 offen lds
 s_add_u32 s28, s38, 894976
 s_add_u32 m0, s39, 17408
 s_nop 0
 buffer_load_dwordx4 v80, s[8:11], s28 offen lds
 s_add_u32 s28, s23, 0
 s_add_u32 m0, s25, 36864
 s_nop 0
 buffer_load_dwordx4 v4, s[72:75], s28 offen lds
 s_add_u32 s28, s23, 147456
 s_add_u32 m0, s25, 38912
 s_nop 0
 buffer_load_dwordx4 v4, s[72:75], s28 offen lds
 s_waitcnt vmcnt(16)
 ds_read_b128 a[44:47], v81 offset:2048
 ds_read_b128 a[60:63], v82 offset:2048
 s_add_u32 s28, s23, 294912
 s_add_u32 m0, s25, 40960
 s_nop 0
 buffer_load_dwordx4 v4, s[72:75], s28 offen lds
 s_waitcnt vmcnt(15)
 ds_read_b128 a[76:79], v81 offset:4096
 ds_read_b128 a[92:95], v82 offset:4096
 s_add_u32 s28, s23, 442368
 s_add_u32 m0, s25, 43008
 s_nop 0
 buffer_load_dwordx4 v4, s[72:75], s28 offen lds
 s_waitcnt vmcnt(14)
 ds_read_b128 a[108:111], v81 offset:6144
 ds_read_b128 a[124:127], v82 offset:6144
 s_add_u32 s28, s23, 589824
 s_add_u32 m0, s25, 45056
 s_nop 0
 buffer_load_dwordx4 v4, s[72:75], s28 offen lds
 s_waitcnt vmcnt(13)
 ds_read_b128 a[140:143], v81 offset:8192
 ds_read_b128 a[156:159], v82 offset:8192
 v_xor_b32 v4, 64, v4
 s_add_u32 s28, s23, 73728
 s_add_u32 m0, s25, 37888
 s_nop 0
 buffer_load_dwordx4 v4, s[72:75], s28 offen lds
 s_add_u32 s28, s23, 221184
 s_add_u32 m0, s25, 39936
 s_nop 0
 buffer_load_dwordx4 v4, s[72:75], s28 offen lds
 s_waitcnt vmcnt(13)
 ds_read_b128 a[172:175], v81 offset:10240
 ds_read_b128 a[188:191], v82 offset:10240
 s_add_u32 s28, s23, 368640
 s_add_u32 m0, s25, 41984
 s_nop 0
 buffer_load_dwordx4 v4, s[72:75], s28 offen lds
 s_waitcnt vmcnt(12)
 ds_read_b128 a[204:207], v81 offset:12288
 ds_read_b128 a[220:223], v82 offset:12288
 s_add_u32 s28, s23, 516096
 s_add_u32 m0, s25, 44032
 s_nop 0
 buffer_load_dwordx4 v4, s[72:75], s28 offen lds
 v_xor_b32 v4, 64, v4
 s_waitcnt vmcnt(11)
 ds_read_b128 a[236:239], v81 offset:14336
 ds_read_b128 a[252:255], v82 offset:14336
 s_add_u32 s29, s62, 2654208
 buffer_load_dword v8, v5, s[4:7], s29 offen
 s_waitcnt vmcnt(10)
 ds_read_b128 v[236:239], v81 offset:16384
 ds_read_b128 v[252:255], v82 offset:16384
 s_add_u32 s29, s58, 2654208
 s_mov_b64 s[46:47], 0xff
 s_lshl_b64 s[46:47], s[46:47], s59
 s_mov_b64 exec, s[46:47]
 buffer_load_dword v8, v5, s[4:7], s29 offen
 s_mov_b64 exec, -1
 s_waitcnt lgkmcnt(0)
 s_barrier
 s_add_u32 s28, s23, 2654208
 s_add_u32 m0, s25, 73728
 s_nop 0
 buffer_load_dwordx4 v4, s[68:71], s28 offen lds
 s_add_u32 s28, s23, 2801664
 s_add_u32 m0, s25, 75776
 s_nop 0
 buffer_load_dwordx4 v4, s[68:71], s28 offen lds
 s_add_u32 s28, s23, 2949120
 s_add_u32 m0, s25, 77824
 s_nop 0
 buffer_load_dwordx4 v4, s[68:71], s28 offen lds
 s_add_u32 s28, s23, 3096576
 s_add_u32 m0, s25, 79872
 s_nop 0
 buffer_load_dwordx4 v4, s[68:71], s28 offen lds
 s_add_u32 s28, s23, 3244032
 s_add_u32 m0, s25, 81920
 s_nop 0
 buffer_load_dwordx4 v4, s[68:71], s28 offen lds
 v_xor_b32 v4, 64, v4
 s_add_u32 s28, s23, 2727936
 s_add_u32 m0, s25, 74752
 s_nop 0
 buffer_load_dwordx4 v4, s[68:71], s28 offen lds
 s_add_u32 s28, s23, 2875392
 s_add_u32 m0, s25, 76800
 s_nop 0
 buffer_load_dwordx4 v4, s[68:71], s28 offen lds
 s_add_u32 s28, s23, 3022848
 s_add_u32 m0, s25, 78848
 s_nop 0
 buffer_load_dwordx4 v4, s[68:71], s28 offen lds
 s_add_u32 s28, s23, 3170304
 s_add_u32 m0, s25, 80896
 s_nop 0
 buffer_load_dwordx4 v4, s[68:71], s28 offen lds
 v_xor_b32 v4, 64, v4
 s_add_u32 s28, s23, 2654208
 s_add_u32 m0, s25, 110592
 s_nop 0
 buffer_load_dwordx4 v4, s[72:75], s28 offen lds
 s_add_u32 s28, s23, 2801664
 s_add_u32 m0, s25, 112640
 s_nop 0
 buffer_load_dwordx4 v4, s[72:75], s28 offen lds
 s_add_u32 s28, s23, 2949120
 s_add_u32 m0, s25, 114688
 s_nop 0
 buffer_load_dwordx4 v4, s[72:75], s28 offen lds
 s_add_u32 s28, s23, 3096576
 s_add_u32 m0, s25, 116736
 s_nop 0
 buffer_load_dwordx4 v4, s[72:75], s28 offen lds
 s_add_u32 s28, s23, 3244032
 s_add_u32 m0, s25, 118784
 s_nop 0
 buffer_load_dwordx4 v4, s[72:75], s28 offen lds
 v_xor_b32 v4, 64, v4
 s_add_u32 s28, s23, 2727936
 s_add_u32 m0, s25, 111616
 s_nop 0
 buffer_load_dwordx4 v4, s[72:75], s28 offen lds
 s_add_u32 s28, s23, 2875392
 s_add_u32 m0, s25, 113664
 s_nop 0
 buffer_load_dwordx4 v4, s[72:75], s28 offen lds
 s_add_u32 s28, s23, 3022848
 s_add_u32 m0, s25, 115712
 s_nop 0
 buffer_load_dwordx4 v4, s[72:75], s28 offen lds
 s_add_u32 s28, s23, 3170304
 s_add_u32 m0, s25, 117760
 s_nop 0
 buffer_load_dwordx4 v4, s[72:75], s28 offen lds
 v_xor_b32 v4, 64, v4
 s_waitcnt vmcnt(20)
 s_barrier
 ds_read_b64_tr_b16 v[16:17], v6 offset:0
 ds_read_b64_tr_b16 v[18:19], v6 offset:512
 ds_read_b64_tr_b16 v[20:21], v6 offset:4096
 ds_read_b64_tr_b16 v[22:23], v6 offset:4608
 ds_read_b64_tr_b16 v[24:25], v6 offset:8192
 ds_read_b64_tr_b16 v[26:27], v6 offset:8704
 ds_read_b64_tr_b16 v[28:29], v6 offset:12288
 ds_read_b64_tr_b16 v[30:31], v6 offset:12800
 ds_read_b64_tr_b16 v[32:33], v6 offset:16384
 ds_read_b64_tr_b16 v[34:35], v6 offset:16896
 ds_read_b64_tr_b16 v[36:37], v6 offset:20480
 ds_read_b64_tr_b16 v[38:39], v6 offset:20992
 ds_read_b64_tr_b16 v[40:41], v6 offset:24576
 ds_read_b64_tr_b16 v[42:43], v6 offset:25088
 ds_read_b64_tr_b16 v[44:45], v6 offset:28672
 ds_read_b64_tr_b16 v[46:47], v6 offset:29184
 ds_read_b64_tr_b16 v[48:49], v6 offset:32768
 ds_read_b64_tr_b16 v[50:51], v6 offset:33280
 v_add_u32 v6, 36864, v6
 s_waitcnt lgkmcnt(15)
 v_mfma_f32_16x16x32_bf16 v[96:99], v[16:19], a[0:3], 0
 ds_read_b64_tr_b16 v[52:53], v6 offset:0
 v_lshlrev_b32 v84, 4, v0
 s_waitcnt lgkmcnt(15)
 v_mfma_f32_16x16x32_bf16 v[96:99], v[20:23], a[16:19], v[96:99]
 v_add_u32 v84, 147456, v84
 v_and_b32 v80, 15, v0
 s_waitcnt lgkmcnt(13)
 v_mfma_f32_16x16x32_bf16 v[96:99], v[24:27], a[32:35], v[96:99]
 ds_read_b64_tr_b16 v[54:55], v6 offset:512
 s_waitcnt lgkmcnt(8)
 v_mfma_f32_16x16x32_bf16 v[96:99], v[28:31], a[48:51], v[96:99]
 v_lshrrev_b32 v81, 4, v0
 v_cvt_f32_u32 v82, v80
 v_mfma_f32_16x16x32_bf16 v[96:99], v[32:35], a[64:67], v[96:99]
 ds_read_b64_tr_b16 v[56:57], v6 offset:4096
 v_cvt_f32_u32 v83, v81
 v_mfma_f32_16x16x32_bf16 v[96:99], v[36:39], a[80:83], v[96:99]
 s_waitcnt lgkmcnt(3)
 v_lshrrev_b32 v176, 1, v80
 v_cvt_f32_u32 v176, v176
 v_mfma_f32_16x16x32_bf16 v[96:99], v[40:43], a[96:99], v[96:99]
 ds_read_b64_tr_b16 v[58:59], v6 offset:4608
 v_and_b32 v177, 1, v80
 v_mfma_f32_16x16x32_bf16 v[96:99], v[44:47], a[112:115], v[96:99]
 v_cvt_f32_u32 v177, v177
 v_cvt_f32_u32 v178, s3
 v_mfma_f32_16x16x32_bf16 v[96:99], v[48:51], a[128:131], v[96:99]
 ds_read_b64_tr_b16 v[60:61], v6 offset:8192
 v_mul_f32 v177, 0xbe800000, v177
 v_mfma_f32_16x16x32_bf16 v[100:103], v[16:19], a[4:7], 0
 v_mul_f32 v178, 0x3b800000, v178
 v_add_f32 v178, v178, v176
 v_mfma_f32_16x16x32_bf16 v[100:103], v[20:23], a[20:23], v[100:103]
 ds_read_b64_tr_b16 v[62:63], v6 offset:8704
 s_add_u32 s29, s62, 128
 v_mfma_f32_16x16x32_bf16 v[100:103], v[24:27], a[36:39], v[100:103]
 buffer_load_dword v8, v5, s[4:7], s29 offen
 v_mul_f32 v179, 0x3e000000, v178
 v_mfma_f32_16x16x32_bf16 v[100:103], v[28:31], a[52:55], v[100:103]
 ds_read_b64_tr_b16 v[64:65], v6 offset:12288
 v_mul_f32 v178, 4.0, v83
 v_mfma_f32_16x16x32_bf16 v[100:103], v[32:35], a[68:71], v[100:103]
 v_fma_f32 v160, v178, v179, v177
 v_add_f32 v162, v160, v179
 v_mfma_f32_16x16x32_bf16 v[100:103], v[36:39], a[84:87], v[100:103]
 ds_read_b64_tr_b16 v[66:67], v6 offset:12800
 v_add_f32 v164, v162, v179
 v_mfma_f32_16x16x32_bf16 v[100:103], v[40:43], a[100:103], v[100:103]
 v_add_f32 v166, v164, v179
 v_add_f32 v161, 0x3e800000, v160
 v_mfma_f32_16x16x32_bf16 v[100:103], v[44:47], a[116:119], v[100:103]
 ds_read_b64_tr_b16 v[68:69], v6 offset:16384
 v_add_f32 v163, 0x3e800000, v162
 v_mfma_f32_16x16x32_bf16 v[100:103], v[48:51], a[132:135], v[100:103]
 v_cos_f32 v160, v160
 v_mfma_f32_16x16x32_bf16 v[104:107], v[16:19], a[8:11], 0
 ds_read_b64_tr_b16 v[70:71], v6 offset:16896
 v_add_f32 v165, 0x3e800000, v164
 v_mfma_f32_16x16x32_bf16 v[104:107], v[20:23], a[24:27], v[104:107]
 v_cos_f32 v161, v161
 v_mfma_f32_16x16x32_bf16 v[104:107], v[24:27], a[40:43], v[104:107]
 ds_read_b64_tr_b16 v[72:73], v6 offset:20480
 v_add_f32 v167, 0x3e800000, v166
 v_mfma_f32_16x16x32_bf16 v[104:107], v[28:31], a[56:59], v[104:107]
 v_cos_f32 v162, v162
 v_mfma_f32_16x16x32_bf16 v[104:107], v[32:35], a[72:75], v[104:107]
 ds_read_b64_tr_b16 v[74:75], v6 offset:20992
 v_cvt_pk_bf16_f32 v184, v160, v161
 v_mfma_f32_16x16x32_bf16 v[104:107], v[36:39], a[88:91], v[104:107]
 v_cos_f32 v163, v163
 v_mfma_f32_16x16x32_bf16 v[104:107], v[40:43], a[104:107], v[104:107]
 ds_read_b64_tr_b16 v[76:77], v6 offset:24576
 v_cvt_pk_bf16_f32 v185, v162, v163
 v_mfma_f32_16x16x32_bf16 v[104:107], v[44:47], a[120:123], v[104:107]
 v_cos_f32 v164, v164
 v_mfma_f32_16x16x32_bf16 v[104:107], v[48:51], a[136:139], v[104:107]
 ds_read_b64_tr_b16 v[78:79], v6 offset:25088
 v_cmp_lt_u32 vcc, 1, v81
 v_mfma_f32_16x16x32_bf16 v[108:111], v[16:19], a[12:15], 0
 v_cos_f32 v165, v165
 v_mfma_f32_16x16x32_bf16 v[108:111], v[20:23], a[28:31], v[108:111]
 ds_read_b64_tr_b16 v[16:17], v6 offset:28672
 v_cvt_pk_bf16_f32 v186, v164, v165
 v_mfma_f32_16x16x32_bf16 v[108:111], v[24:27], a[44:47], v[108:111]
 v_cos_f32 v166, v166
 v_mfma_f32_16x16x32_bf16 v[108:111], v[28:31], a[60:63], v[108:111]
 ds_read_b64_tr_b16 v[18:19], v6 offset:29184
 v_cndmask_b32_e64 v184, v184, 0, vcc
 v_mfma_f32_16x16x32_bf16 v[108:111], v[32:35], a[76:79], v[108:111]
 v_cos_f32 v167, v167
 v_mfma_f32_16x16x32_bf16 v[108:111], v[36:39], a[92:95], v[108:111]
 ds_read_b64_tr_b16 v[20:21], v6 offset:32768
 v_cvt_pk_bf16_f32 v187, v166, v167
 v_mfma_f32_16x16x32_bf16 v[108:111], v[40:43], a[108:111], v[108:111]
 v_cndmask_b32_e64 v185, v185, 0, vcc
 v_cndmask_b32_e64 v186, v186, 0, vcc
 v_mfma_f32_16x16x32_bf16 v[108:111], v[44:47], a[124:127], v[108:111]
 ds_read_b64_tr_b16 v[22:23], v6 offset:33280
 v_cndmask_b32_e64 v187, v187, 0, vcc
 v_mfma_f32_16x16x32_bf16 v[108:111], v[48:51], a[140:143], v[108:111]
 s_waitcnt lgkmcnt(12)
 v_mul_f32 v177, 0x41000000, v83
 v_add_f32 v176, 0x41800000, v82
 v_mfma_f32_16x16x32_bf16 v[112:115], v[52:55], a[0:3], 0
 ds_read_b64_tr_b16 v[24:25], v7 offset:0
 v_mul_f32 v176, 0x3d2aaaab, v176
 v_mfma_f32_16x16x32_bf16 v[112:115], v[56:59], a[16:19], v[112:115]
 ds_write_b128 v84, v[184:187] offset:4096
 v_mfma_f32_16x16x32_bf16 v[112:115], v[60:63], a[32:35], v[112:115]
 ds_read_b64_tr_b16 v[26:27], v7 offset:512
 s_waitcnt lgkmcnt(9)
 v_mfma_f32_16x16x32_bf16 v[112:115], v[64:67], a[48:51], v[112:115]
 v_mul_f32 v160, v176, v177
 v_add_f32 v161, v160, v176
 v_mfma_f32_16x16x32_bf16 v[112:115], v[68:71], a[64:67], v[112:115]
 ds_read_b64_tr_b16 v[28:29], v7 offset:4096
 v_add_u32 v6, 36864, v6
 v_mfma_f32_16x16x32_bf16 v[112:115], v[72:75], a[80:83], v[112:115]
 s_waitcnt lgkmcnt(4)
 v_sin_f32 v168, v160
 v_mfma_f32_16x16x32_bf16 v[112:115], v[76:79], a[96:99], v[112:115]
 ds_read_b64_tr_b16 v[30:31], v7 offset:4608
 v_add_f32 v162, v161, v176
 v_mfma_f32_16x16x32_bf16 v[112:115], v[16:19], a[112:115], v[112:115]
 v_sin_f32 v169, v161
 v_mfma_f32_16x16x32_bf16 v[112:115], v[20:23], a[128:131], v[112:115]
 ds_read_b64_tr_b16 v[32:33], v7 offset:8192
 v_add_f32 v163, v162, v176
 v_mfma_f32_16x16x32_bf16 v[116:119], v[52:55], a[4:7], 0
 v_sin_f32 v170, v162
 v_mfma_f32_16x16x32_bf16 v[116:119], v[56:59], a[20:23], v[116:119]
 ds_read_b64_tr_b16 v[34:35], v7 offset:8704
 v_add_f32 v164, v163, v176
 v_mfma_f32_16x16x32_bf16 v[116:119], v[60:63], a[36:39], v[116:119]
 v_sin_f32 v171, v163
 v_mfma_f32_16x16x32_bf16 v[116:119], v[64:67], a[52:55], v[116:119]
 ds_read_b64_tr_b16 v[36:37], v7 offset:12288
 v_add_f32 v165, v164, v176
 v_mfma_f32_16x16x32_bf16 v[116:119], v[68:71], a[68:71], v[116:119]
 v_sin_f32 v172, v164
 v_mfma_f32_16x16x32_bf16 v[116:119], v[72:75], a[84:87], v[116:119]
 ds_read_b64_tr_b16 v[38:39], v7 offset:12800
 s_add_u32 s29, s58, 128
 v_mfma_f32_16x16x32_bf16 v[116:119], v[76:79], a[100:103], v[116:119]
 s_mov_b64 s[46:47], 0xff
 s_lshl_b64 s[46:47], s[46:47], s59
 s_mov_b64 exec, s[46:47]
 buffer_load_dword v8, v5, s[4:7], s29 offen
 s_mov_b64 exec, -1
 v_sin_f32 v173, v165
 v_mfma_f32_16x16x32_bf16 v[116:119], v[16:19], a[116:119], v[116:119]
 ds_read_b64_tr_b16 v[40:41], v7 offset:16384
 v_add_f32 v166, v165, v176
 v_mfma_f32_16x16x32_bf16 v[116:119], v[20:23], a[132:135], v[116:119]
 v_sin_f32 v174, v166
 v_mfma_f32_16x16x32_bf16 v[120:123], v[52:55], a[8:11], 0
 ds_read_b64_tr_b16 v[42:43], v7 offset:16896
 v_add_f32 v167, v166, v176
 v_mfma_f32_16x16x32_bf16 v[120:123], v[56:59], a[24:27], v[120:123]
 v_sin_f32 v175, v167
 v_mfma_f32_16x16x32_bf16 v[120:123], v[60:63], a[40:43], v[120:123]
 ds_read_b64_tr_b16 v[44:45], v7 offset:20480
 v_cmp_eq_u32 vcc, 3, v81
 v_mfma_f32_16x16x32_bf16 v[120:123], v[64:67], a[56:59], v[120:123]
 v_cos_f32 v160, v160
 v_mfma_f32_16x16x32_bf16 v[120:123], v[68:71], a[72:75], v[120:123]
 ds_read_b64_tr_b16 v[46:47], v7 offset:20992
 v_cvt_pk_bf16_f32 v192, v168, v169
 v_mfma_f32_16x16x32_bf16 v[120:123], v[72:75], a[88:91], v[120:123]
 v_cos_f32 v161, v161
 v_mfma_f32_16x16x32_bf16 v[120:123], v[76:79], a[104:107], v[120:123]
 ds_read_b64_tr_b16 v[48:49], v7 offset:24576
 v_cvt_pk_bf16_f32 v188, v160, v161
 v_mfma_f32_16x16x32_bf16 v[120:123], v[16:19], a[120:123], v[120:123]
 v_cos_f32 v162, v162
 v_mfma_f32_16x16x32_bf16 v[120:123], v[20:23], a[136:139], v[120:123]
 ds_read_b64_tr_b16 v[50:51], v7 offset:25088
 v_cvt_pk_bf16_f32 v193, v170, v171
 v_mfma_f32_16x16x32_bf16 v[124:127], v[52:55], a[12:15], 0
 v_cos_f32 v163, v163
 v_mfma_f32_16x16x32_bf16 v[124:127], v[56:59], a[28:31], v[124:127]
 ds_read_b64_tr_b16 v[52:53], v7 offset:28672
 v_cvt_pk_bf16_f32 v189, v162, v163
 v_mfma_f32_16x16x32_bf16 v[124:127], v[60:63], a[44:47], v[124:127]
 v_cos_f32 v164, v164
 v_mfma_f32_16x16x32_bf16 v[124:127], v[64:67], a[60:63], v[124:127]
 ds_read_b64_tr_b16 v[54:55], v7 offset:29184
 v_cvt_pk_bf16_f32 v194, v172, v173
 v_mfma_f32_16x16x32_bf16 v[124:127], v[68:71], a[76:79], v[124:127]
 v_cos_f32 v165, v165
 v_mfma_f32_16x16x32_bf16 v[124:127], v[72:75], a[92:95], v[124:127]
 ds_read_b64_tr_b16 v[56:57], v7 offset:32768
 v_cvt_pk_bf16_f32 v190, v164, v165
 v_mfma_f32_16x16x32_bf16 v[124:127], v[76:79], a[108:111], v[124:127]
 v_cos_f32 v166, v166
 v_mfma_f32_16x16x32_bf16 v[124:127], v[16:19], a[124:127], v[124:127]
 ds_read_b64_tr_b16 v[58:59], v7 offset:33280
 v_cvt_pk_bf16_f32 v195, v174, v175
 v_mfma_f32_16x16x32_bf16 v[124:127], v[20:23], a[140:143], v[124:127]
 s_waitcnt lgkmcnt(12)
 v_add_u32 v7, 36864, v7
 v_cndmask_b32_e64 v188, v188, 0, vcc
 v_mfma_f32_16x16x32_bf16 v[128:131], v[24:27], a[0:3], 0
 ds_read_b64_tr_b16 v[60:61], v7 offset:0
 v_cndmask_b32_e64 v192, v192, 0, vcc
 v_mfma_f32_16x16x32_bf16 v[128:131], v[28:31], a[16:19], v[128:131]
 v_cos_f32 v167, v167
 v_mfma_f32_16x16x32_bf16 v[128:131], v[32:35], a[32:35], v[128:131]
 ds_read_b64_tr_b16 v[62:63], v7 offset:512
 s_waitcnt lgkmcnt(8)
 v_mfma_f32_16x16x32_bf16 v[128:131], v[36:39], a[48:51], v[128:131]
 v_cvt_pk_bf16_f32 v191, v166, v167
 v_cndmask_b32_e64 v189, v189, 0, vcc
 v_mfma_f32_16x16x32_bf16 v[128:131], v[40:43], a[64:67], v[128:131]
 ds_read_b64_tr_b16 v[64:65], v7 offset:4096
 v_cndmask_b32_e64 v193, v193, 0, vcc
 v_mfma_f32_16x16x32_bf16 v[128:131], v[44:47], a[80:83], v[128:131]
 s_waitcnt lgkmcnt(3)
 v_cndmask_b32_e64 v190, v190, 0, vcc
 v_cndmask_b32_e64 v194, v194, 0, vcc
 v_mfma_f32_16x16x32_bf16 v[128:131], v[48:51], a[96:99], v[128:131]
 ds_read_b64_tr_b16 v[66:67], v7 offset:4608
 v_cndmask_b32_e64 v191, v191, 0, vcc
 v_mfma_f32_16x16x32_bf16 v[128:131], v[52:55], a[112:115], v[128:131]
 ds_write_b128 v84, v[188:191] offset:6144
 v_mfma_f32_16x16x32_bf16 v[128:131], v[56:59], a[128:131], v[128:131]
 ds_read_b64_tr_b16 v[68:69], v7 offset:8192
 v_cndmask_b32_e64 v195, v195, 0, vcc
 v_mfma_f32_16x16x32_bf16 v[132:135], v[24:27], a[4:7], 0
 ds_write_b128 v84, v[192:195] offset:8192
 v_mfma_f32_16x16x32_bf16 v[132:135], v[28:31], a[20:23], v[132:135]
 ds_read_b64_tr_b16 v[70:71], v7 offset:8704
 v_mul_f32 v177, 4.0, v83
 v_mfma_f32_16x16x32_bf16 v[132:135], v[32:35], a[36:39], v[132:135]
 v_lshl_add_u32 v178, v81, 2, 0
 v_mov_b32 v180, 2.0
 v_mfma_f32_16x16x32_bf16 v[132:135], v[36:39], a[52:55], v[132:135]
 ds_read_b64_tr_b16 v[72:73], v7 offset:12288
 v_cmp_eq_u32 vcc, 0, v178
 v_mfma_f32_16x16x32_bf16 v[132:135], v[40:43], a[68:71], v[132:135]
 s_nop 0
 v_cndmask_b32_e64 v180, v180, 1.0, vcc
 v_cmp_eq_u32 vcc, 12, v178
 v_mfma_f32_16x16x32_bf16 v[132:135], v[44:47], a[84:87], v[132:135]
 ds_read_b64_tr_b16 v[74:75], v7 offset:12800
 v_cndmask_b32_e64 v180, v180, 1.0, vcc
 v_mfma_f32_16x16x32_bf16 v[132:135], v[48:51], a[100:103], v[132:135]
 v_cmp_lt_u32 vcc, 12, v178
 s_nop 1
 v_cndmask_b32_e64 v180, v180, 0, vcc
 v_mfma_f32_16x16x32_bf16 v[132:135], v[52:55], a[116:119], v[132:135]
 ds_read_b64_tr_b16 v[76:77], v7 offset:16384
 v_lshl_add_u32 v178, v81, 2, 1
 v_mfma_f32_16x16x32_bf16 v[132:135], v[56:59], a[132:135], v[132:135]
 v_mov_b32 v181, 2.0
 v_cmp_eq_u32 vcc, 0, v178
 v_mfma_f32_16x16x32_bf16 v[136:139], v[24:27], a[8:11], 0
 ds_read_b64_tr_b16 v[78:79], v7 offset:16896
 v_cndmask_b32_e64 v181, v181, 1.0, vcc
 v_mfma_f32_16x16x32_bf16 v[136:139], v[28:31], a[24:27], v[136:139]
 v_cmp_eq_u32 vcc, 12, v178
 s_nop 1
 v_cndmask_b32_e64 v181, v181, 1.0, vcc
 v_mfma_f32_16x16x32_bf16 v[136:139], v[32:35], a[40:43], v[136:139]
 ds_read_b64_tr_b16 v[16:17], v7 offset:20480
 v_cmp_lt_u32 vcc, 12, v178
 v_mfma_f32_16x16x32_bf16 v[136:139], v[36:39], a[56:59], v[136:139]
 s_nop 0
 v_cndmask_b32_e64 v181, v181, 0, vcc
 v_lshl_add_u32 v178, v81, 2, 2
 v_mfma_f32_16x16x32_bf16 v[136:139], v[40:43], a[72:75], v[136:139]
 ds_read_b64_tr_b16 v[18:19], v7 offset:20992
 v_mov_b32 v182, 2.0
 v_mfma_f32_16x16x32_bf16 v[136:139], v[44:47], a[88:91], v[136:139]
 v_cmp_eq_u32 vcc, 0, v178
 s_nop 1
 v_cndmask_b32_e64 v182, v182, 1.0, vcc
 v_mfma_f32_16x16x32_bf16 v[136:139], v[48:51], a[104:107], v[136:139]
 ds_read_b64_tr_b16 v[20:21], v7 offset:24576
 v_cmp_eq_u32 vcc, 12, v178
 v_mfma_f32_16x16x32_bf16 v[136:139], v[52:55], a[120:123], v[136:139]
 s_nop 0
 v_cndmask_b32_e64 v182, v182, 1.0, vcc
 v_cmp_lt_u32 vcc, 12, v178
 v_mfma_f32_16x16x32_bf16 v[136:139], v[56:59], a[136:139], v[136:139]
 ds_read_b64_tr_b16 v[22:23], v7 offset:25088
 v_cndmask_b32_e64 v182, v182, 0, vcc
 v_mfma_f32_16x16x32_bf16 v[140:143], v[24:27], a[12:15], 0
 v_lshl_add_u32 v178, v81, 2, 3
 v_mov_b32 v183, 2.0
 v_mfma_f32_16x16x32_bf16 v[140:143], v[28:31], a[28:31], v[140:143]
 ds_read_b64_tr_b16 v[24:25], v7 offset:28672
 v_cmp_eq_u32 vcc, 0, v178
 v_mfma_f32_16x16x32_bf16 v[140:143], v[32:35], a[44:47], v[140:143]
 s_nop 0
 v_cndmask_b32_e64 v183, v183, 1.0, vcc
 v_cmp_eq_u32 vcc, 12, v178
 v_mfma_f32_16x16x32_bf16 v[140:143], v[36:39], a[60:63], v[140:143]
 ds_read_b64_tr_b16 v[26:27], v7 offset:29184
 v_cndmask_b32_e64 v183, v183, 1.0, vcc
 v_mfma_f32_16x16x32_bf16 v[140:143], v[40:43], a[76:79], v[140:143]
 v_cmp_lt_u32 vcc, 12, v178
 s_nop 1
 v_cndmask_b32_e64 v183, v183, 0, vcc
 v_mfma_f32_16x16x32_bf16 v[140:143], v[44:47], a[92:95], v[140:143]
 ds_read_b64_tr_b16 v[28:29], v7 offset:32768
 v_add_f32 v176, 0x00000000, v82
 v_mfma_f32_16x16x32_bf16 v[140:143], v[48:51], a[108:111], v[140:143]
 v_mul_f32 v176, 0x3ae38e39, v176
 v_mul_f32 v160, v176, v177
 v_mfma_f32_16x16x32_bf16 v[140:143], v[52:55], a[124:127], v[140:143]
 ds_read_b64_tr_b16 v[30:31], v7 offset:33280
 v_add_f32 v161, v160, v176
 v_mfma_f32_16x16x32_bf16 v[140:143], v[56:59], a[140:143], v[140:143]
 s_waitcnt lgkmcnt(12)
 v_add_u32 v7, 36864, v7
 v_add_f32 v162, v161, v176
 v_mfma_f32_16x16x32_bf16 v[144:147], v[60:63], a[0:3], 0
 v_sin_f32 v164, v160
 v_mfma_f32_16x16x32_bf16 v[144:147], v[64:67], a[16:19], v[144:147]
 v_sin_f32 v165, v161
 v_mfma_f32_16x16x32_bf16 v[144:147], v[68:71], a[32:35], v[144:147]
 s_waitcnt lgkmcnt(6)
 s_waitcnt lgkmcnt(0)
 s_waitcnt vmcnt(2)
 s_barrier
 v_mfma_f32_16x16x32_bf16 v[144:147], v[72:75], a[48:51], v[144:147]
 ds_read_b64_tr_b16 v[32:33], v6 offset:0
 v_add_f32 v163, v162, v176
 v_mfma_f32_16x16x32_bf16 v[144:147], v[76:79], a[64:67], v[144:147]
 ds_read_b64_tr_b16 v[34:35], v6 offset:512
 v_mul_f32 v200, v164, v180
 v_mfma_f32_16x16x32_bf16 v[144:147], v[16:19], a[80:83], v[144:147]
 v_sin_f32 v166, v162
 v_mfma_f32_16x16x32_bf16 v[144:147], v[20:23], a[96:99], v[144:147]
 ds_read_b64_tr_b16 v[36:37], v6 offset:4096
 v_mul_f32 v201, v165, v181
 v_mfma_f32_16x16x32_bf16 v[144:147], v[24:27], a[112:115], v[144:147]
 v_sin_f32 v167, v163
 v_mfma_f32_16x16x32_bf16 v[144:147], v[28:31], a[128:131], v[144:147]
 ds_read_b64_tr_b16 v[38:39], v6 offset:4608
 v_mul_f32 v202, v166, v182
 v_mfma_f32_16x16x32_bf16 v[148:151], v[60:63], a[4:7], 0
 v_cos_f32 v160, v160
 v_mfma_f32_16x16x32_bf16 v[148:151], v[64:67], a[20:23], v[148:151]
 ds_read_b64_tr_b16 v[40:41], v6 offset:8192
 v_mul_f32 v196, v160, v180
 v_mfma_f32_16x16x32_bf16 v[148:151], v[68:71], a[36:39], v[148:151]
 ds_read_b64_tr_b16 v[42:43], v6 offset:8704
 v_mul_f32 v203, v167, v183
 v_mfma_f32_16x16x32_bf16 v[148:151], v[72:75], a[52:55], v[148:151]
 ds_write_b128 v84, v[200:203] offset:11264
 v_mfma_f32_16x16x32_bf16 v[148:151], v[76:79], a[68:71], v[148:151]
 ds_read_b64_tr_b16 v[44:45], v6 offset:12288
 v_add_f32 v176, 0x41800000, v82
 v_mfma_f32_16x16x32_bf16 v[148:151], v[16:19], a[84:87], v[148:151]
 v_cos_f32 v161, v161
 v_mfma_f32_16x16x32_bf16 v[148:151], v[20:23], a[100:103], v[148:151]
 ds_read_b64_tr_b16 v[46:47], v6 offset:12800
 v_mul_f32 v197, v161, v181
 v_mfma_f32_16x16x32_bf16 v[148:151], v[24:27], a[116:119], v[148:151]
 v_cos_f32 v162, v162
 v_mfma_f32_16x16x32_bf16 v[148:151], v[28:31], a[132:135], v[148:151]
 ds_read_b64_tr_b16 v[48:49], v6 offset:16384
 v_mul_f32 v198, v162, v182
 v_mfma_f32_16x16x32_bf16 v[152:155], v[60:63], a[8:11], 0
 v_cos_f32 v163, v163
 v_mfma_f32_16x16x32_bf16 v[152:155], v[64:67], a[24:27], v[152:155]
 ds_read_b64_tr_b16 v[50:51], v6 offset:16896
 v_mul_f32 v199, v163, v183
 v_mfma_f32_16x16x32_bf16 v[152:155], v[68:71], a[40:43], v[152:155]
 ds_read_b64_tr_b16 v[52:53], v6 offset:20480
 v_mul_f32 v176, 0x3ae38e39, v176
 v_mfma_f32_16x16x32_bf16 v[152:155], v[72:75], a[56:59], v[152:155]
 ds_write_b128 v84, v[196:199] offset:9216
 v_mfma_f32_16x16x32_bf16 v[152:155], v[76:79], a[72:75], v[152:155]
 ds_read_b64_tr_b16 v[54:55], v6 offset:20992
 v_mul_f32 v160, v176, v177
 v_mfma_f32_16x16x32_bf16 v[152:155], v[16:19], a[88:91], v[152:155]
 v_sin_f32 v164, v160
 v_mfma_f32_16x16x32_bf16 v[152:155], v[20:23], a[104:107], v[152:155]
 ds_read_b64_tr_b16 v[56:57], v6 offset:24576
 v_add_f32 v161, v160, v176
 v_mfma_f32_16x16x32_bf16 v[152:155], v[24:27], a[120:123], v[152:155]
 v_sin_f32 v165, v161
 v_mfma_f32_16x16x32_bf16 v[152:155], v[28:31], a[136:139], v[152:155]
 ds_read_b64_tr_b16 v[58:59], v6 offset:25088
 v_add_f32 v162, v161, v176
 v_mfma_f32_16x16x32_bf16 v[156:159], v[60:63], a[12:15], 0
 v_sin_f32 v166, v162
 v_mfma_f32_16x16x32_bf16 v[156:159], v[64:67], a[28:31], v[156:159]
 ds_read_b64_tr_b16 v[60:61], v6 offset:28672
 v_add_f32 v163, v162, v176
 v_mfma_f32_16x16x32_bf16 v[156:159], v[68:71], a[44:47], v[156:159]
 ds_read_b64_tr_b16 v[62:63], v6 offset:29184
 v_mul_f32 v200, v164, v180
 v_mfma_f32_16x16x32_bf16 v[156:159], v[72:75], a[60:63], v[156:159]
 v_sin_f32 v167, v163
 v_mfma_f32_16x16x32_bf16 v[156:159], v[76:79], a[76:79], v[156:159]
 ds_read_b64_tr_b16 v[64:65], v6 offset:32768
 v_mul_f32 v201, v165, v181
 v_mfma_f32_16x16x32_bf16 v[156:159], v[16:19], a[92:95], v[156:159]
 v_cos_f32 v160, v160
 v_mfma_f32_16x16x32_bf16 v[156:159], v[20:23], a[108:111], v[156:159]
 ds_read_b64_tr_b16 v[66:67], v6 offset:33280
 v_mul_f32 v196, v160, v180
 v_mfma_f32_16x16x32_bf16 v[156:159], v[24:27], a[124:127], v[156:159]
 v_cos_f32 v161, v161
 v_mfma_f32_16x16x32_bf16 v[156:159], v[28:31], a[140:143], v[156:159]
 s_waitcnt lgkmcnt(14)
 v_add_u32 v6, 36864, v6
 v_mul_f32 v197, v161, v181
 v_mfma_f32_16x16x32_bf16 v[96:99], v[32:35], a[144:147], v[96:99]
 ds_read_b64_tr_b16 v[68:69], v6 offset:0
 v_mul_f32 v202, v166, v182
 v_mfma_f32_16x16x32_bf16 v[96:99], v[36:39], a[160:163], v[96:99]
 v_cos_f32 v162, v162
 v_mfma_f32_16x16x32_bf16 v[96:99], v[40:43], a[176:179], v[96:99]
 ds_read_b64_tr_b16 v[70:71], v6 offset:512
 s_waitcnt lgkmcnt(8)
 v_mfma_f32_16x16x32_bf16 v[96:99], v[44:47], a[192:195], v[96:99]
 v_cos_f32 v163, v163
 v_mfma_f32_16x16x32_bf16 v[96:99], v[48:51], a[208:211], v[96:99]
 ds_read_b64_tr_b16 v[72:73], v6 offset:4096
 v_mul_f32 v198, v162, v182
 v_mfma_f32_16x16x32_bf16 v[96:99], v[52:55], a[224:227], v[96:99]
 s_waitcnt lgkmcnt(3)
 v_mul_f32 v199, v163, v183
 v_mul_f32 v203, v167, v183
 v_mfma_f32_16x16x32_bf16 v[96:99], v[56:59], a[240:243], v[96:99]
 ds_read_b64_tr_b16 v[74:75], v6 offset:4608
 v_add_f32 v176, 0x00000000, v82
 v_mfma_f32_16x16x32_bf16 v[96:99], v[60:63], v[224:227], v[96:99]
 ds_write_b128 v84, v[196:199] offset:10240
 v_mfma_f32_16x16x32_bf16 v[96:99], v[64:67], v[240:243], v[96:99]
 ds_read_b64_tr_b16 v[76:77], v6 offset:8192
 v_mul_f32 v176, 0x3d2aaaab, v176
 v_mfma_f32_16x16x32_bf16 v[100:103], v[32:35], a[148:151], v[100:103]
 ds_write_b128 v84, v[200:203] offset:12288
 v_mfma_f32_16x16x32_bf16 v[100:103], v[36:39], a[164:167], v[100:103]
 ds_read_b64_tr_b16 v[78:79], v6 offset:8704
 s_add_u32 s29, s62, 2654336
 v_mfma_f32_16x16x32_bf16 v[100:103], v[40:43], a[180:183], v[100:103]
 buffer_load_dword v8, v5, s[4:7], s29 offen
 v_mul_f32 v160, v176, v177
 v_mfma_f32_16x16x32_bf16 v[100:103], v[44:47], a[196:199], v[100:103]
 ds_read_b64_tr_b16 v[16:17], v6 offset:12288
 v_add_f32 v161, v160, v176
 v_mfma_f32_16x16x32_bf16 v[100:103], v[48:51], a[212:215], v[100:103]
 v_add_f32 v162, v161, v176
 v_add_f32 v163, v162, v176
 v_mfma_f32_16x16x32_bf16 v[100:103], v[52:55], a[228:231], v[100:103]
 ds_read_b64_tr_b16 v[18:19], v6 offset:12800
 v_add_f32 v164, 0x3e800000, v160
 v_mfma_f32_16x16x32_bf16 v[100:103], v[56:59], a[244:247], v[100:103]
 v_cos_f32 v160, v160
 v_mfma_f32_16x16x32_bf16 v[100:103], v[60:63], v[228:231], v[100:103]
 ds_read_b64_tr_b16 v[20:21], v6 offset:16384
 v_add_f32 v165, 0x3e800000, v161
 v_mfma_f32_16x16x32_bf16 v[100:103], v[64:67], v[244:247], v[100:103]
 v_cos_f32 v161, v161
 v_mfma_f32_16x16x32_bf16 v[104:107], v[32:35], a[152:155], v[104:107]
 ds_read_b64_tr_b16 v[22:23], v6 offset:16896
 v_add_f32 v166, 0x3e800000, v162
 v_mfma_f32_16x16x32_bf16 v[104:107], v[36:39], a[168:171], v[104:107]
 v_cos_f32 v162, v162
 v_mfma_f32_16x16x32_bf16 v[104:107], v[40:43], a[184:187], v[104:107]
 ds_read_b64_tr_b16 v[24:25], v6 offset:20480
 v_add_f32 v167, 0x3e800000, v163
 v_mfma_f32_16x16x32_bf16 v[104:107], v[44:47], a[200:203], v[104:107]
 v_cos_f32 v163, v163
 v_mfma_f32_16x16x32_bf16 v[104:107], v[48:51], a[216:219], v[104:107]
 ds_read_b64_tr_b16 v[26:27], v6 offset:20992
 v_cvt_pk_bf16_f32 v204, v160, v161
 v_mfma_f32_16x16x32_bf16 v[104:107], v[52:55], a[232:235], v[104:107]
 v_cos_f32 v164, v164
 v_mfma_f32_16x16x32_bf16 v[104:107], v[56:59], a[248:251], v[104:107]
 ds_read_b64_tr_b16 v[28:29], v6 offset:24576
 v_cvt_pk_bf16_f32 v205, v162, v163
 v_mfma_f32_16x16x32_bf16 v[104:107], v[60:63], v[232:235], v[104:107]
 v_cos_f32 v165, v165
 v_mfma_f32_16x16x32_bf16 v[104:107], v[64:67], v[248:251], v[104:107]
 ds_read_b64_tr_b16 v[30:31], v6 offset:25088
 v_cvt_pk_bf16_f32 v206, v164, v165
 v_mfma_f32_16x16x32_bf16 v[108:111], v[32:35], a[156:159], v[108:111]
 v_cos_f32 v166, v166
 v_mfma_f32_16x16x32_bf16 v[108:111], v[36:39], a[172:175], v[108:111]
 ds_read_b64_tr_b16 v[32:33], v6 offset:28672
 v_add_f32 v176, 0x41800000, v82
 v_mfma_f32_16x16x32_bf16 v[108:111], v[40:43], a[188:191], v[108:111]
 v_cos_f32 v167, v167
 v_mfma_f32_16x16x32_bf16 v[108:111], v[44:47], a[204:207], v[108:111]
 ds_read_b64_tr_b16 v[34:35], v6 offset:29184
 v_cvt_pk_bf16_f32 v207, v166, v167
 v_mfma_f32_16x16x32_bf16 v[108:111], v[48:51], a[220:223], v[108:111]
 ds_write_b128 v84, v[204:207] offset:13312
 v_mfma_f32_16x16x32_bf16 v[108:111], v[52:55], a[236:239], v[108:111]
 ds_read_b64_tr_b16 v[36:37], v6 offset:32768
 v_mul_f32 v176, 0x3d2aaaab, v176
 v_mfma_f32_16x16x32_bf16 v[108:111], v[56:59], a[252:255], v[108:111]
 v_mul_f32 v160, v176, v177
 v_add_f32 v161, v160, v176
 v_mfma_f32_16x16x32_bf16 v[108:111], v[60:63], v[236:239], v[108:111]
 ds_read_b64_tr_b16 v[38:39], v6 offset:33280
 v_add_f32 v162, v161, v176
 v_mfma_f32_16x16x32_bf16 v[108:111], v[64:67], v[252:255], v[108:111]
 s_waitcnt lgkmcnt(13)
 v_add_f32 v163, v162, v176
 v_add_f32 v164, 0x3e800000, v160
 v_mfma_f32_16x16x32_bf16 v[112:115], v[68:71], a[144:147], v[112:115]
 ds_read_b64_tr_b16 v[40:41], v7 offset:0
 v_add_f32 v165, 0x3e800000, v161
 v_mfma_f32_16x16x32_bf16 v[112:115], v[72:75], a[160:163], v[112:115]
 v_cos_f32 v160, v160
 v_mfma_f32_16x16x32_bf16 v[112:115], v[76:79], a[176:179], v[112:115]
 ds_read_b64_tr_b16 v[42:43], v7 offset:512
 s_waitcnt lgkmcnt(9)
 v_mfma_f32_16x16x32_bf16 v[112:115], v[16:19], a[192:195], v[112:115]
 v_cos_f32 v161, v161
 v_mfma_f32_16x16x32_bf16 v[112:115], v[20:23], a[208:211], v[112:115]
 ds_read_b64_tr_b16 v[44:45], v7 offset:4096
 v_subrev_u32 v6, 110592, v6
 v_mfma_f32_16x16x32_bf16 v[112:115], v[24:27], a[224:227], v[112:115]
 s_waitcnt lgkmcnt(3)
 v_xor_b32 v6, 64, v6
 v_add_f32 v166, 0x3e800000, v162
 v_mfma_f32_16x16x32_bf16 v[112:115], v[28:31], a[240:243], v[112:115]
 ds_read_b64_tr_b16 v[46:47], v7 offset:4608
 v_add_f32 v167, 0x3e800000, v163
 v_mfma_f32_16x16x32_bf16 v[112:115], v[32:35], v[224:227], v[112:115]
 v_cos_f32 v162, v162
 v_mfma_f32_16x16x32_bf16 v[112:115], v[36:39], v[240:243], v[112:115]
 ds_read_b64_tr_b16 v[48:49], v7 offset:8192
 v_cvt_pk_bf16_f32 v204, v160, v161
 v_mfma_f32_16x16x32_bf16 v[116:119], v[68:71], a[148:151], v[116:119]
 v_cos_f32 v163, v163
 v_mfma_f32_16x16x32_bf16 v[116:119], v[72:75], a[164:167], v[116:119]
 ds_read_b64_tr_b16 v[50:51], v7 offset:8704
 v_cvt_pk_bf16_f32 v205, v162, v163
 v_mfma_f32_16x16x32_bf16 v[116:119], v[76:79], a[180:183], v[116:119]
 v_cos_f32 v164, v164
 v_mfma_f32_16x16x32_bf16 v[116:119], v[16:19], a[196:199], v[116:119]
 ds_read_b64_tr_b16 v[52:53], v7 offset:12288
 v_mfma_f32_16x16x32_bf16 v[116:119], v[20:23], a[212:215], v[116:119]
 v_cos_f32 v165, v165
 v_mfma_f32_16x16x32_bf16 v[116:119], v[24:27], a[228:231], v[116:119]
 ds_read_b64_tr_b16 v[54:55], v7 offset:12800
 s_add_u32 s29, s58, 2654336
 v_mfma_f32_16x16x32_bf16 v[116:119], v[28:31], a[244:247], v[116:119]
 s_mov_b64 s[46:47], 0xff
 s_lshl_b64 s[46:47], s[46:47], s59
 s_mov_b64 exec, s[46:47]
 buffer_load_dword v8, v5, s[4:7], s29 offen
 s_mov_b64 exec, -1
 v_cos_f32 v166, v166
 v_mfma_f32_16x16x32_bf16 v[116:119], v[32:35], v[228:231], v[116:119]
 ds_read_b64_tr_b16 v[56:57], v7 offset:16384
 v_cvt_pk_bf16_f32 v206, v164, v165
 v_mfma_f32_16x16x32_bf16 v[116:119], v[36:39], v[244:247], v[116:119]
 v_cos_f32 v167, v167
 v_mfma_f32_16x16x32_bf16 v[120:123], v[68:71], a[152:155], v[120:123]
 ds_read_b64_tr_b16 v[58:59], v7 offset:16896
 v_cvt_pk_bf16_f32 v207, v166, v167
 v_mfma_f32_16x16x32_bf16 v[120:123], v[72:75], a[168:171], v[120:123]
 ds_write_b128 v84, v[204:207] offset:14336
 v_mfma_f32_16x16x32_bf16 v[120:123], v[76:79], a[184:187], v[120:123]
 ds_read_b64_tr_b16 v[60:61], v7 offset:20480
 v_mfma_f32_16x16x32_bf16 v[120:123], v[16:19], a[200:203], v[120:123]
 v_mfma_f32_16x16x32_bf16 v[120:123], v[20:23], a[216:219], v[120:123]
 ds_read_b64_tr_b16 v[62:63], v7 offset:20992
 v_mfma_f32_16x16x32_bf16 v[120:123], v[24:27], a[232:235], v[120:123]
 v_mfma_f32_16x16x32_bf16 v[120:123], v[28:31], a[248:251], v[120:123]
 ds_read_b64_tr_b16 v[64:65], v7 offset:24576
 s_add_u32 s29, s63, 0
 v_mfma_f32_16x16x32_bf16 v[120:123], v[32:35], v[232:235], v[120:123]
 buffer_load_dword v8, v5, s[4:7], s29 offen
 v_mfma_f32_16x16x32_bf16 v[120:123], v[36:39], v[248:251], v[120:123]
 ds_read_b64_tr_b16 v[66:67], v7 offset:25088
 v_mfma_f32_16x16x32_bf16 v[124:127], v[68:71], a[156:159], v[124:127]
 v_mfma_f32_16x16x32_bf16 v[124:127], v[72:75], a[172:175], v[124:127]
 ds_read_b64_tr_b16 v[68:69], v7 offset:28672
 v_mfma_f32_16x16x32_bf16 v[124:127], v[76:79], a[188:191], v[124:127]
 v_mfma_f32_16x16x32_bf16 v[124:127], v[16:19], a[204:207], v[124:127]
 ds_read_b64_tr_b16 v[70:71], v7 offset:29184
 v_mfma_f32_16x16x32_bf16 v[124:127], v[20:23], a[220:223], v[124:127]
 v_mfma_f32_16x16x32_bf16 v[124:127], v[24:27], a[236:239], v[124:127]
 ds_read_b64_tr_b16 v[72:73], v7 offset:32768
 v_mfma_f32_16x16x32_bf16 v[124:127], v[28:31], a[252:255], v[124:127]
 v_mfma_f32_16x16x32_bf16 v[124:127], v[32:35], v[236:239], v[124:127]
 ds_read_b64_tr_b16 v[74:75], v7 offset:33280
 v_mfma_f32_16x16x32_bf16 v[124:127], v[36:39], v[252:255], v[124:127]
 s_waitcnt lgkmcnt(13)
 v_add_u32 v7, 36864, v7
 v_mfma_f32_16x16x32_bf16 v[128:131], v[40:43], a[144:147], v[128:131]
 ds_read_b64_tr_b16 v[76:77], v7 offset:0
 v_mfma_f32_16x16x32_bf16 v[128:131], v[44:47], a[160:163], v[128:131]
 v_mfma_f32_16x16x32_bf16 v[128:131], v[48:51], a[176:179], v[128:131]
 ds_read_b64_tr_b16 v[78:79], v7 offset:512
 s_waitcnt lgkmcnt(8)
 v_mfma_f32_16x16x32_bf16 v[128:131], v[52:55], a[192:195], v[128:131]
 v_mfma_f32_16x16x32_bf16 v[128:131], v[56:59], a[208:211], v[128:131]
 ds_read_b64_tr_b16 v[16:17], v7 offset:4096
 v_mfma_f32_16x16x32_bf16 v[128:131], v[60:63], a[224:227], v[128:131]
 s_waitcnt lgkmcnt(3)
 v_mfma_f32_16x16x32_bf16 v[128:131], v[64:67], a[240:243], v[128:131]
 ds_read_b64_tr_b16 v[18:19], v7 offset:4608
 v_mfma_f32_16x16x32_bf16 v[128:131], v[68:71], v[224:227], v[128:131]
 v_mfma_f32_16x16x32_bf16 v[128:131], v[72:75], v[240:243], v[128:131]
 ds_read_b64_tr_b16 v[20:21], v7 offset:8192
 v_mfma_f32_16x16x32_bf16 v[132:135], v[40:43], a[148:151], v[132:135]
 v_mfma_f32_16x16x32_bf16 v[132:135], v[44:47], a[164:167], v[132:135]
 ds_read_b64_tr_b16 v[22:23], v7 offset:8704
 v_mfma_f32_16x16x32_bf16 v[132:135], v[48:51], a[180:183], v[132:135]
 v_mfma_f32_16x16x32_bf16 v[132:135], v[52:55], a[196:199], v[132:135]
 ds_read_b64_tr_b16 v[24:25], v7 offset:12288
 v_mfma_f32_16x16x32_bf16 v[132:135], v[56:59], a[212:215], v[132:135]
 v_mfma_f32_16x16x32_bf16 v[132:135], v[60:63], a[228:231], v[132:135]
 ds_read_b64_tr_b16 v[26:27], v7 offset:12800
 v_mfma_f32_16x16x32_bf16 v[132:135], v[64:67], a[244:247], v[132:135]
 v_mfma_f32_16x16x32_bf16 v[132:135], v[68:71], v[228:231], v[132:135]
 ds_read_b64_tr_b16 v[28:29], v7 offset:16384
 v_mfma_f32_16x16x32_bf16 v[132:135], v[72:75], v[244:247], v[132:135]
 v_mfma_f32_16x16x32_bf16 v[136:139], v[40:43], a[152:155], v[136:139]
 ds_read_b64_tr_b16 v[30:31], v7 offset:16896
 v_mfma_f32_16x16x32_bf16 v[136:139], v[44:47], a[168:171], v[136:139]
 v_mfma_f32_16x16x32_bf16 v[136:139], v[48:51], a[184:187], v[136:139]
 ds_read_b64_tr_b16 v[32:33], v7 offset:20480
 v_mfma_f32_16x16x32_bf16 v[136:139], v[52:55], a[200:203], v[136:139]
 v_mfma_f32_16x16x32_bf16 v[136:139], v[56:59], a[216:219], v[136:139]
 ds_read_b64_tr_b16 v[34:35], v7 offset:20992
 v_mfma_f32_16x16x32_bf16 v[136:139], v[60:63], a[232:235], v[136:139]
 v_mfma_f32_16x16x32_bf16 v[136:139], v[64:67], a[248:251], v[136:139]
 ds_read_b64_tr_b16 v[36:37], v7 offset:24576
 v_mfma_f32_16x16x32_bf16 v[136:139], v[68:71], v[232:235], v[136:139]
 v_mfma_f32_16x16x32_bf16 v[136:139], v[72:75], v[248:251], v[136:139]
 ds_read_b64_tr_b16 v[38:39], v7 offset:25088
 v_mfma_f32_16x16x32_bf16 v[140:143], v[40:43], a[156:159], v[140:143]
 v_mfma_f32_16x16x32_bf16 v[140:143], v[44:47], a[172:175], v[140:143]
 ds_read_b64_tr_b16 v[40:41], v7 offset:28672
 v_mfma_f32_16x16x32_bf16 v[140:143], v[48:51], a[188:191], v[140:143]
 v_mfma_f32_16x16x32_bf16 v[140:143], v[52:55], a[204:207], v[140:143]
 ds_read_b64_tr_b16 v[42:43], v7 offset:29184
 v_mfma_f32_16x16x32_bf16 v[140:143], v[56:59], a[220:223], v[140:143]
 v_mfma_f32_16x16x32_bf16 v[140:143], v[60:63], a[236:239], v[140:143]
 ds_read_b64_tr_b16 v[44:45], v7 offset:32768
 v_mfma_f32_16x16x32_bf16 v[140:143], v[64:67], a[252:255], v[140:143]
 v_mfma_f32_16x16x32_bf16 v[140:143], v[68:71], v[236:239], v[140:143]
 ds_read_b64_tr_b16 v[46:47], v7 offset:33280
 v_mfma_f32_16x16x32_bf16 v[140:143], v[72:75], v[252:255], v[140:143]
 s_waitcnt lgkmcnt(12)
 v_subrev_u32 v7, 110592, v7
 v_mfma_f32_16x16x32_bf16 v[144:147], v[76:79], a[144:147], v[144:147]
 v_xor_b32 v7, 64, v7
 v_mfma_f32_16x16x32_bf16 v[144:147], v[16:19], a[160:163], v[144:147]
 v_mfma_f32_16x16x32_bf16 v[144:147], v[20:23], a[176:179], v[144:147]
 s_waitcnt lgkmcnt(6)
 s_waitcnt lgkmcnt(0)
 s_barrier
 v_mfma_f32_16x16x32_bf16 v[144:147], v[24:27], a[192:195], v[144:147]
 ds_read_b64_tr_b16 v[48:49], v6 offset:0
 s_lshl_b32 s43, s3, 2
 s_add_u32 s43, s43, 42594944
 v_mov_b32 v85, s60
 s_cmp_eq_u32 s20, 0
 s_cselect_b32 s77, s43, 0x7ff00000
 s_mov_b64 exec, 1
 buffer_store_dword v85, v1, s[12:15], s77 offen offset:0 sc1
 s_mov_b64 exec, -1
 v_mfma_f32_16x16x32_bf16 v[144:147], v[28:31], a[208:211], v[144:147]
 ds_read_b64_tr_b16 v[50:51], v6 offset:512
 v_mfma_f32_16x16x32_bf16 v[144:147], v[32:35], a[224:227], v[144:147]
 v_mfma_f32_16x16x32_bf16 v[144:147], v[36:39], a[240:243], v[144:147]
 ds_read_b64_tr_b16 v[52:53], v6 offset:4096
 v_mfma_f32_16x16x32_bf16 v[144:147], v[40:43], v[224:227], v[144:147]
 v_mfma_f32_16x16x32_bf16 v[144:147], v[44:47], v[240:243], v[144:147]
 ds_read_b64_tr_b16 v[54:55], v6 offset:4608
 v_mfma_f32_16x16x32_bf16 v[148:151], v[76:79], a[148:151], v[148:151]
 v_mfma_f32_16x16x32_bf16 v[148:151], v[16:19], a[164:167], v[148:151]
 ds_read_b64_tr_b16 v[56:57], v6 offset:8192
 v_mfma_f32_16x16x32_bf16 v[148:151], v[20:23], a[180:183], v[148:151]
 ds_read_b64_tr_b16 v[58:59], v6 offset:8704
 v_mfma_f32_16x16x32_bf16 v[148:151], v[24:27], a[196:199], v[148:151]
 v_mfma_f32_16x16x32_bf16 v[148:151], v[28:31], a[212:215], v[148:151]
 ds_read_b64_tr_b16 v[60:61], v6 offset:12288
 v_mfma_f32_16x16x32_bf16 v[148:151], v[32:35], a[228:231], v[148:151]
 v_mfma_f32_16x16x32_bf16 v[148:151], v[36:39], a[244:247], v[148:151]
 ds_read_b64_tr_b16 v[62:63], v6 offset:12800
 v_mfma_f32_16x16x32_bf16 v[148:151], v[40:43], v[228:231], v[148:151]
 v_mfma_f32_16x16x32_bf16 v[148:151], v[44:47], v[244:247], v[148:151]
 ds_read_b64_tr_b16 v[64:65], v6 offset:16384
 v_mfma_f32_16x16x32_bf16 v[152:155], v[76:79], a[152:155], v[152:155]
 v_mfma_f32_16x16x32_bf16 v[152:155], v[16:19], a[168:171], v[152:155]
 ds_read_b64_tr_b16 v[66:67], v6 offset:16896
 v_mfma_f32_16x16x32_bf16 v[152:155], v[20:23], a[184:187], v[152:155]
 ds_read_b64_tr_b16 v[68:69], v6 offset:20480
 v_mfma_f32_16x16x32_bf16 v[152:155], v[24:27], a[200:203], v[152:155]
 v_mfma_f32_16x16x32_bf16 v[152:155], v[28:31], a[216:219], v[152:155]
 ds_read_b64_tr_b16 v[70:71], v6 offset:20992
 v_mfma_f32_16x16x32_bf16 v[152:155], v[32:35], a[232:235], v[152:155]
 v_mfma_f32_16x16x32_bf16 v[152:155], v[36:39], a[248:251], v[152:155]
 ds_read_b64_tr_b16 v[72:73], v6 offset:24576
 v_mfma_f32_16x16x32_bf16 v[152:155], v[40:43], v[232:235], v[152:155]
 v_mfma_f32_16x16x32_bf16 v[152:155], v[44:47], v[248:251], v[152:155]
 ds_read_b64_tr_b16 v[74:75], v6 offset:25088
 v_mfma_f32_16x16x32_bf16 v[156:159], v[76:79], a[156:159], v[156:159]
 v_mfma_f32_16x16x32_bf16 v[156:159], v[16:19], a[172:175], v[156:159]
 ds_read_b64_tr_b16 v[76:77], v6 offset:28672
 v_mfma_f32_16x16x32_bf16 v[156:159], v[20:23], a[188:191], v[156:159]
 ds_read_b64_tr_b16 v[78:79], v6 offset:29184
 v_mfma_f32_16x16x32_bf16 v[156:159], v[24:27], a[204:207], v[156:159]
 v_mfma_f32_16x16x32_bf16 v[156:159], v[28:31], a[220:223], v[156:159]
 ds_read_b64_tr_b16 v[16:17], v6 offset:32768
 v_mfma_f32_16x16x32_bf16 v[156:159], v[32:35], a[236:239], v[156:159]
 v_mfma_f32_16x16x32_bf16 v[156:159], v[36:39], a[252:255], v[156:159]
 ds_read_b64_tr_b16 v[18:19], v6 offset:33280
 v_mfma_f32_16x16x32_bf16 v[156:159], v[40:43], v[236:239], v[156:159]
 v_mfma_f32_16x16x32_bf16 v[156:159], v[44:47], v[252:255], v[156:159]
 s_waitcnt lgkmcnt(12)
 v_add_u32 v6, 36864, v6
 v_mfma_f32_16x16x32_bf16 v[160:163], v[48:51], a[0:3], 0
 ds_read_b64_tr_b16 v[20:21], v6 offset:0
 v_mul_f32 v80, v96, v96
 v_mfma_f32_16x16x32_bf16 v[160:163], v[52:55], a[16:19], v[160:163]
 v_mul_f32 v81, v97, v97
 v_mul_f32 v82, v98, v98
 v_mfma_f32_16x16x32_bf16 v[160:163], v[56:59], a[32:35], v[160:163]
 ds_read_b64_tr_b16 v[22:23], v6 offset:512
 s_waitcnt lgkmcnt(8)
 v_mfma_f32_16x16x32_bf16 v[160:163], v[60:63], a[48:51], v[160:163]
 v_mul_f32 v83, v99, v99
 v_fma_f32 v80, v80, s30, v9
 v_mfma_f32_16x16x32_bf16 v[160:163], v[64:67], a[64:67], v[160:163]
 ds_read_b64_tr_b16 v[24:25], v6 offset:4096
 v_fma_f32 v81, v81, s30, v9
 v_mfma_f32_16x16x32_bf16 v[160:163], v[68:71], a[80:83], v[160:163]
 s_waitcnt lgkmcnt(3)
 v_fma_f32 v82, v82, s30, v9
 v_fma_f32 v83, v83, s30, v9
 v_mfma_f32_16x16x32_bf16 v[160:163], v[72:75], a[96:99], v[160:163]
 ds_read_b64_tr_b16 v[26:27], v6 offset:4608
 v_mul_f32 v80, v80, v96
 v_mfma_f32_16x16x32_bf16 v[160:163], v[76:79], a[112:115], v[160:163]
 v_exp_f32 v80, v80
 v_mfma_f32_16x16x32_bf16 v[160:163], v[16:19], a[128:131], v[160:163]
 ds_read_b64_tr_b16 v[28:29], v6 offset:8192
 v_mul_f32 v81, v81, v97
 v_mfma_f32_16x16x32_bf16 v[164:167], v[48:51], a[4:7], 0
 v_exp_f32 v81, v81
 v_mfma_f32_16x16x32_bf16 v[164:167], v[52:55], a[20:23], v[164:167]
 ds_read_b64_tr_b16 v[30:31], v6 offset:8704
 v_mul_f32 v82, v82, v98
 v_mfma_f32_16x16x32_bf16 v[164:167], v[56:59], a[36:39], v[164:167]
 v_exp_f32 v82, v82
 v_mfma_f32_16x16x32_bf16 v[164:167], v[60:63], a[52:55], v[164:167]
 ds_read_b64_tr_b16 v[32:33], v6 offset:12288
 v_mul_f32 v83, v83, v99
 v_mfma_f32_16x16x32_bf16 v[164:167], v[64:67], a[68:71], v[164:167]
 v_exp_f32 v83, v83
 v_mfma_f32_16x16x32_bf16 v[164:167], v[68:71], a[84:87], v[164:167]
 ds_read_b64_tr_b16 v[34:35], v6 offset:12800
 v_mul_f32 v112, v96, v112
 v_mfma_f32_16x16x32_bf16 v[164:167], v[72:75], a[100:103], v[164:167]
 v_mul_f32 v113, v97, v113
 v_mul_f32 v114, v98, v114
 v_mfma_f32_16x16x32_bf16 v[164:167], v[76:79], a[116:119], v[164:167]
 ds_read_b64_tr_b16 v[36:37], v6 offset:16384
 v_mul_f32 v115, v99, v115
 v_mfma_f32_16x16x32_bf16 v[164:167], v[16:19], a[132:135], v[164:167]
 v_add_f32 v80, 1.0, v80
 v_add_f32 v81, 1.0, v81
 v_mfma_f32_16x16x32_bf16 v[168:171], v[48:51], a[8:11], 0
 ds_read_b64_tr_b16 v[38:39], v6 offset:16896
 v_add_f32 v82, 1.0, v82
 v_mfma_f32_16x16x32_bf16 v[168:171], v[52:55], a[24:27], v[168:171]
 v_rcp_f32 v80, v80
 v_mfma_f32_16x16x32_bf16 v[168:171], v[56:59], a[40:43], v[168:171]
 ds_read_b64_tr_b16 v[40:41], v6 offset:20480
 v_add_f32 v83, 1.0, v83
 v_mfma_f32_16x16x32_bf16 v[168:171], v[60:63], a[56:59], v[168:171]
 v_rcp_f32 v81, v81
 v_mfma_f32_16x16x32_bf16 v[168:171], v[64:67], a[72:75], v[168:171]
 ds_read_b64_tr_b16 v[42:43], v6 offset:20992
 v_mul_f32 v112, v112, v80
 v_mfma_f32_16x16x32_bf16 v[168:171], v[68:71], a[88:91], v[168:171]
 v_rcp_f32 v82, v82
 v_mfma_f32_16x16x32_bf16 v[168:171], v[72:75], a[104:107], v[168:171]
 ds_read_b64_tr_b16 v[44:45], v6 offset:24576
 v_mul_f32 v113, v113, v81
 v_mfma_f32_16x16x32_bf16 v[168:171], v[76:79], a[120:123], v[168:171]
 v_rcp_f32 v83, v83
 v_mfma_f32_16x16x32_bf16 v[168:171], v[16:19], a[136:139], v[168:171]
 ds_read_b64_tr_b16 v[46:47], v6 offset:25088
 v_mul_f32 v114, v114, v82
 v_mfma_f32_16x16x32_bf16 v[172:175], v[48:51], a[12:15], 0
 v_mul_f32 v115, v115, v83
 v_cvt_pk_bf16_f32 v88, v112, v113
 v_mfma_f32_16x16x32_bf16 v[172:175], v[52:55], a[28:31], v[172:175]
 ds_read_b64_tr_b16 v[48:49], v6 offset:28672
 v_cvt_pk_bf16_f32 v89, v114, v115
 v_mfma_f32_16x16x32_bf16 v[172:175], v[56:59], a[44:47], v[172:175]
 v_mul_f32 v84, v128, v128
 v_mul_f32 v85, v129, v129
 v_mfma_f32_16x16x32_bf16 v[172:175], v[60:63], a[60:63], v[172:175]
 ds_read_b64_tr_b16 v[50:51], v6 offset:29184
 v_mul_f32 v86, v130, v130
 v_mfma_f32_16x16x32_bf16 v[172:175], v[64:67], a[76:79], v[172:175]
 v_mul_f32 v87, v131, v131
 v_fma_f32 v84, v84, s30, v9
 v_mfma_f32_16x16x32_bf16 v[172:175], v[68:71], a[92:95], v[172:175]
 ds_read_b64_tr_b16 v[52:53], v6 offset:32768
 v_fma_f32 v85, v85, s30, v9
 v_mfma_f32_16x16x32_bf16 v[172:175], v[72:75], a[108:111], v[172:175]
 v_fma_f32 v86, v86, s30, v9
 v_fma_f32 v87, v87, s30, v9
 v_mfma_f32_16x16x32_bf16 v[172:175], v[76:79], a[124:127], v[172:175]
 ds_read_b64_tr_b16 v[54:55], v6 offset:33280
 v_mul_f32 v84, v84, v128
 v_mfma_f32_16x16x32_bf16 v[172:175], v[16:19], a[140:143], v[172:175]
 s_waitcnt lgkmcnt(12)
 v_exp_f32 v84, v84
 v_mfma_f32_16x16x32_bf16 v[176:179], v[20:23], a[0:3], 0
 ds_read_b64_tr_b16 v[56:57], v7 offset:0
 v_mul_f32 v85, v85, v129
 v_mfma_f32_16x16x32_bf16 v[176:179], v[24:27], a[16:19], v[176:179]
 v_exp_f32 v85, v85
 v_mfma_f32_16x16x32_bf16 v[176:179], v[28:31], a[32:35], v[176:179]
 ds_read_b64_tr_b16 v[58:59], v7 offset:512
 s_waitcnt lgkmcnt(8)
 v_mfma_f32_16x16x32_bf16 v[176:179], v[32:35], a[48:51], v[176:179]
 v_mul_f32 v86, v86, v130
 v_mul_f32 v87, v87, v131
 v_mfma_f32_16x16x32_bf16 v[176:179], v[36:39], a[64:67], v[176:179]
 ds_read_b64_tr_b16 v[60:61], v7 offset:4096
 v_add_u32 v6, 36864, v6
 v_mfma_f32_16x16x32_bf16 v[176:179], v[40:43], a[80:83], v[176:179]
 s_waitcnt lgkmcnt(3)
 v_exp_f32 v86, v86
 v_mfma_f32_16x16x32_bf16 v[176:179], v[44:47], a[96:99], v[176:179]
 ds_read_b64_tr_b16 v[62:63], v7 offset:4608
 v_mul_f32 v144, v128, v144
 v_mfma_f32_16x16x32_bf16 v[176:179], v[48:51], a[112:115], v[176:179]
 v_exp_f32 v87, v87
 v_mfma_f32_16x16x32_bf16 v[176:179], v[52:55], a[128:131], v[176:179]
 ds_read_b64_tr_b16 v[64:65], v7 offset:8192
 v_mul_f32 v145, v129, v145
 v_mfma_f32_16x16x32_bf16 v[180:183], v[20:23], a[4:7], 0
 v_mul_f32 v146, v130, v146
 v_mul_f32 v147, v131, v147
 v_mfma_f32_16x16x32_bf16 v[180:183], v[24:27], a[20:23], v[180:183]
 ds_read_b64_tr_b16 v[66:67], v7 offset:8704
 v_add_f32 v84, 1.0, v84
 v_mfma_f32_16x16x32_bf16 v[180:183], v[28:31], a[36:39], v[180:183]
 s_add_u32 s36, s26, 0
 v_rcp_f32 v84, v84
 v_mfma_f32_16x16x32_bf16 v[180:183], v[32:35], a[52:55], v[180:183]
 ds_read_b64_tr_b16 v[68:69], v7 offset:12288
 v_add_f32 v85, 1.0, v85
 v_mfma_f32_16x16x32_bf16 v[180:183], v[36:39], a[68:71], v[180:183]
 v_rcp_f32 v85, v85
 v_mfma_f32_16x16x32_bf16 v[180:183], v[40:43], a[84:87], v[180:183]
 ds_read_b64_tr_b16 v[70:71], v7 offset:12800
 v_add_f32 v86, 1.0, v86
 v_mfma_f32_16x16x32_bf16 v[180:183], v[44:47], a[100:103], v[180:183]
 v_rcp_f32 v86, v86
 v_mfma_f32_16x16x32_bf16 v[180:183], v[48:51], a[116:119], v[180:183]
 ds_read_b64_tr_b16 v[72:73], v7 offset:16384
 v_add_f32 v87, 1.0, v87
 v_mfma_f32_16x16x32_bf16 v[180:183], v[52:55], a[132:135], v[180:183]
 v_rcp_f32 v87, v87
 v_mfma_f32_16x16x32_bf16 v[184:187], v[20:23], a[8:11], 0
 ds_read_b64_tr_b16 v[74:75], v7 offset:16896
 v_mul_f32 v144, v144, v84
 v_mfma_f32_16x16x32_bf16 v[184:187], v[24:27], a[24:27], v[184:187]
 v_mul_f32 v145, v145, v85
 v_mul_f32 v146, v146, v86
 v_mfma_f32_16x16x32_bf16 v[184:187], v[28:31], a[40:43], v[184:187]
 ds_read_b64_tr_b16 v[76:77], v7 offset:20480
 v_mul_f32 v147, v147, v87
 v_mfma_f32_16x16x32_bf16 v[184:187], v[32:35], a[56:59], v[184:187]
 v_cvt_pk_bf16_f32 v90, v144, v145
 v_cvt_pk_bf16_f32 v91, v146, v147
 v_mfma_f32_16x16x32_bf16 v[184:187], v[36:39], a[72:75], v[184:187]
 ds_read_b64_tr_b16 v[78:79], v7 offset:20992
 v_mul_f32 v80, v100, v100
 v_mfma_f32_16x16x32_bf16 v[184:187], v[40:43], a[88:91], v[184:187]
 buffer_store_dwordx4 v[88:91], v1, s[12:15], s36 offen sc1
 v_mfma_f32_16x16x32_bf16 v[184:187], v[44:47], a[104:107], v[184:187]
 ds_read_b64_tr_b16 v[16:17], v7 offset:24576
 s_add_u32 s29, s63, 2359296
 v_mfma_f32_16x16x32_bf16 v[184:187], v[48:51], a[120:123], v[184:187]
 buffer_load_dword v8, v5, s[4:7], s29 offen
 v_mul_f32 v81, v101, v101
 v_mfma_f32_16x16x32_bf16 v[184:187], v[52:55], a[136:139], v[184:187]
 ds_read_b64_tr_b16 v[18:19], v7 offset:25088
 v_mul_f32 v82, v102, v102
 v_mfma_f32_16x16x32_bf16 v[188:191], v[20:23], a[12:15], 0
 v_mul_f32 v83, v103, v103
 v_fma_f32 v80, v80, s30, v9
 v_mfma_f32_16x16x32_bf16 v[188:191], v[24:27], a[28:31], v[188:191]
 ds_read_b64_tr_b16 v[20:21], v7 offset:28672
 v_fma_f32 v81, v81, s30, v9
 v_mfma_f32_16x16x32_bf16 v[188:191], v[28:31], a[44:47], v[188:191]
 v_fma_f32 v82, v82, s30, v9
 v_fma_f32 v83, v83, s30, v9
 v_mfma_f32_16x16x32_bf16 v[188:191], v[32:35], a[60:63], v[188:191]
 ds_read_b64_tr_b16 v[22:23], v7 offset:29184
 v_mul_f32 v80, v80, v100
 v_mfma_f32_16x16x32_bf16 v[188:191], v[36:39], a[76:79], v[188:191]
 v_exp_f32 v80, v80
 v_mfma_f32_16x16x32_bf16 v[188:191], v[40:43], a[92:95], v[188:191]
 ds_read_b64_tr_b16 v[24:25], v7 offset:32768
 v_mul_f32 v81, v81, v101
 v_mfma_f32_16x16x32_bf16 v[188:191], v[44:47], a[108:111], v[188:191]
 v_exp_f32 v81, v81
 v_mfma_f32_16x16x32_bf16 v[188:191], v[48:51], a[124:127], v[188:191]
 ds_read_b64_tr_b16 v[26:27], v7 offset:33280
 v_mul_f32 v82, v82, v102
 v_mfma_f32_16x16x32_bf16 v[188:191], v[52:55], a[140:143], v[188:191]
 s_waitcnt lgkmcnt(12)
 v_add_u32 v7, 36864, v7
 v_mul_f32 v83, v83, v103
 v_mfma_f32_16x16x32_bf16 v[192:195], v[56:59], a[0:3], 0
 ds_read_b64_tr_b16 v[28:29], v7 offset:0
 v_mul_f32 v116, v100, v116
 v_mfma_f32_16x16x32_bf16 v[192:195], v[60:63], a[16:19], v[192:195]
 v_exp_f32 v82, v82
 v_mfma_f32_16x16x32_bf16 v[192:195], v[64:67], a[32:35], v[192:195]
 ds_read_b64_tr_b16 v[30:31], v7 offset:512
 s_waitcnt lgkmcnt(8)
 v_mfma_f32_16x16x32_bf16 v[192:195], v[68:71], a[48:51], v[192:195]
 v_exp_f32 v83, v83
 v_mfma_f32_16x16x32_bf16 v[192:195], v[72:75], a[64:67], v[192:195]
 ds_read_b64_tr_b16 v[32:33], v7 offset:4096
 v_mul_f32 v117, v101, v117
 v_mfma_f32_16x16x32_bf16 v[192:195], v[76:79], a[80:83], v[192:195]
 s_waitcnt lgkmcnt(3)
 v_mul_f32 v118, v102, v118
 v_mul_f32 v119, v103, v119
 v_mfma_f32_16x16x32_bf16 v[192:195], v[16:19], a[96:99], v[192:195]
 ds_read_b64_tr_b16 v[34:35], v7 offset:4608
 v_add_f32 v80, 1.0, v80
 v_mfma_f32_16x16x32_bf16 v[192:195], v[20:23], a[112:115], v[192:195]
 v_rcp_f32 v80, v80
 v_mfma_f32_16x16x32_bf16 v[192:195], v[24:27], a[128:131], v[192:195]
 ds_read_b64_tr_b16 v[36:37], v7 offset:8192
 v_add_f32 v81, 1.0, v81
 v_mfma_f32_16x16x32_bf16 v[196:199], v[56:59], a[4:7], 0
 v_rcp_f32 v81, v81
 v_mfma_f32_16x16x32_bf16 v[196:199], v[60:63], a[20:23], v[196:199]
 ds_read_b64_tr_b16 v[38:39], v7 offset:8704
 v_add_f32 v82, 1.0, v82
 v_mfma_f32_16x16x32_bf16 v[196:199], v[64:67], a[36:39], v[196:199]
 v_rcp_f32 v82, v82
 v_mfma_f32_16x16x32_bf16 v[196:199], v[68:71], a[52:55], v[196:199]
 ds_read_b64_tr_b16 v[40:41], v7 offset:12288
 v_add_f32 v83, 1.0, v83
 v_mfma_f32_16x16x32_bf16 v[196:199], v[72:75], a[68:71], v[196:199]
 v_rcp_f32 v83, v83
 v_mfma_f32_16x16x32_bf16 v[196:199], v[76:79], a[84:87], v[196:199]
 ds_read_b64_tr_b16 v[42:43], v7 offset:12800
 v_mul_f32 v116, v116, v80
 v_mfma_f32_16x16x32_bf16 v[196:199], v[16:19], a[100:103], v[196:199]
 v_mul_f32 v117, v117, v81
 v_mul_f32 v118, v118, v82
 v_mfma_f32_16x16x32_bf16 v[196:199], v[20:23], a[116:119], v[196:199]
 ds_read_b64_tr_b16 v[44:45], v7 offset:16384
 v_mul_f32 v119, v119, v83
 v_mfma_f32_16x16x32_bf16 v[196:199], v[24:27], a[132:135], v[196:199]
 v_cvt_pk_bf16_f32 v92, v116, v117
 v_cvt_pk_bf16_f32 v93, v118, v119
 v_mfma_f32_16x16x32_bf16 v[200:203], v[56:59], a[8:11], 0
 ds_read_b64_tr_b16 v[46:47], v7 offset:16896
 v_mul_f32 v84, v132, v132
 v_mfma_f32_16x16x32_bf16 v[200:203], v[60:63], a[24:27], v[200:203]
 v_mul_f32 v85, v133, v133
 v_mul_f32 v86, v134, v134
 v_mfma_f32_16x16x32_bf16 v[200:203], v[64:67], a[40:43], v[200:203]
 ds_read_b64_tr_b16 v[48:49], v7 offset:20480
 v_mul_f32 v87, v135, v135
 v_mfma_f32_16x16x32_bf16 v[200:203], v[68:71], a[56:59], v[200:203]
 v_fma_f32 v84, v84, s30, v9
 v_fma_f32 v85, v85, s30, v9
 v_mfma_f32_16x16x32_bf16 v[200:203], v[72:75], a[72:75], v[200:203]
 ds_read_b64_tr_b16 v[50:51], v7 offset:20992
 v_fma_f32 v86, v86, s30, v9
 v_mfma_f32_16x16x32_bf16 v[200:203], v[76:79], a[88:91], v[200:203]
 v_fma_f32 v87, v87, s30, v9
 v_mul_f32 v84, v84, v132
 v_mfma_f32_16x16x32_bf16 v[200:203], v[16:19], a[104:107], v[200:203]
 ds_read_b64_tr_b16 v[52:53], v7 offset:24576
 v_mul_f32 v85, v85, v133
 v_mfma_f32_16x16x32_bf16 v[200:203], v[20:23], a[120:123], v[200:203]
 v_exp_f32 v84, v84
 v_mfma_f32_16x16x32_bf16 v[200:203], v[24:27], a[136:139], v[200:203]
 ds_read_b64_tr_b16 v[54:55], v7 offset:25088
 v_mul_f32 v86, v86, v134
 v_mfma_f32_16x16x32_bf16 v[204:207], v[56:59], a[12:15], 0
 v_exp_f32 v85, v85
 v_mfma_f32_16x16x32_bf16 v[204:207], v[60:63], a[28:31], v[204:207]
 ds_read_b64_tr_b16 v[56:57], v7 offset:28672
 v_mul_f32 v87, v87, v135
 v_mfma_f32_16x16x32_bf16 v[204:207], v[64:67], a[44:47], v[204:207]
 v_exp_f32 v86, v86
 v_mfma_f32_16x16x32_bf16 v[204:207], v[68:71], a[60:63], v[204:207]
 ds_read_b64_tr_b16 v[58:59], v7 offset:29184
 v_mul_f32 v148, v132, v148
 v_mfma_f32_16x16x32_bf16 v[204:207], v[72:75], a[76:79], v[204:207]
 v_exp_f32 v87, v87
 v_mfma_f32_16x16x32_bf16 v[204:207], v[76:79], a[92:95], v[204:207]
 ds_read_b64_tr_b16 v[60:61], v7 offset:32768
 v_mul_f32 v149, v133, v149
 v_mfma_f32_16x16x32_bf16 v[204:207], v[16:19], a[108:111], v[204:207]
 v_mul_f32 v150, v134, v150
 v_mul_f32 v151, v135, v151
 v_mfma_f32_16x16x32_bf16 v[204:207], v[20:23], a[124:127], v[204:207]
 ds_read_b64_tr_b16 v[62:63], v7 offset:33280
 v_add_f32 v84, 1.0, v84
 v_mfma_f32_16x16x32_bf16 v[204:207], v[24:27], a[140:143], v[204:207]
 s_waitcnt lgkmcnt(12)
 s_add_u32 s37, s26, 147456
 v_add_u32 v7, 36864, v7
 v_mfma_f32_16x16x32_bf16 v[208:211], v[28:31], a[0:3], 0
 v_rcp_f32 v84, v84
 v_mfma_f32_16x16x32_bf16 v[208:211], v[32:35], a[16:19], v[208:211]
 v_add_f32 v85, 1.0, v85
 v_add_f32 v86, 1.0, v86
 v_mfma_f32_16x16x32_bf16 v[208:211], v[36:39], a[32:35], v[208:211]
 s_waitcnt lgkmcnt(6)
 s_waitcnt lgkmcnt(0)
 s_barrier
 v_mfma_f32_16x16x32_bf16 v[208:211], v[40:43], a[48:51], v[208:211]
 ds_read_b64_tr_b16 v[64:65], v6 offset:0
 v_add_f32 v87, 1.0, v87
 v_mfma_f32_16x16x32_bf16 v[208:211], v[44:47], a[64:67], v[208:211]
 ds_read_b64_tr_b16 v[66:67], v6 offset:512
 s_add_u32 s28, s23, 128
 v_mfma_f32_16x16x32_bf16 v[208:211], v[48:51], a[80:83], v[208:211]
 s_add_u32 m0, s25, 0
 v_mul_f32 v148, v148, v84
 v_mfma_f32_16x16x32_bf16 v[208:211], v[52:55], a[96:99], v[208:211]
 ds_read_b64_tr_b16 v[68:69], v6 offset:4096
 v_mul_f32 v80, v104, v104
 v_mfma_f32_16x16x32_bf16 v[208:211], v[56:59], a[112:115], v[208:211]
 buffer_load_dwordx4 v4, s[68:71], s28 offen lds
 v_mfma_f32_16x16x32_bf16 v[208:211], v[60:63], a[128:131], v[208:211]
 ds_read_b64_tr_b16 v[70:71], v6 offset:4608
 v_mul_f32 v81, v105, v105
 v_mfma_f32_16x16x32_bf16 v[212:215], v[28:31], a[4:7], 0
 s_add_u32 s28, s23, 147584
 v_rcp_f32 v85, v85
 v_mfma_f32_16x16x32_bf16 v[212:215], v[32:35], a[20:23], v[212:215]
 ds_read_b64_tr_b16 v[72:73], v6 offset:8192
 s_add_u32 m0, s25, 2048
 v_mfma_f32_16x16x32_bf16 v[212:215], v[36:39], a[36:39], v[212:215]
 ds_read_b64_tr_b16 v[74:75], v6 offset:8704
 v_mul_f32 v149, v149, v85
 v_mfma_f32_16x16x32_bf16 v[212:215], v[40:43], a[52:55], v[212:215]
 buffer_load_dwordx4 v4, s[68:71], s28 offen lds
 v_mfma_f32_16x16x32_bf16 v[212:215], v[44:47], a[68:71], v[212:215]
 ds_read_b64_tr_b16 v[76:77], v6 offset:12288
 v_cvt_pk_bf16_f32 v94, v148, v149
 v_mfma_f32_16x16x32_bf16 v[212:215], v[48:51], a[84:87], v[212:215]
 s_add_u32 s28, s23, 295040
 v_rcp_f32 v86, v86
 v_mfma_f32_16x16x32_bf16 v[212:215], v[52:55], a[100:103], v[212:215]
 ds_read_b64_tr_b16 v[78:79], v6 offset:12800
 s_add_u32 m0, s25, 4096
 v_mfma_f32_16x16x32_bf16 v[212:215], v[56:59], a[116:119], v[212:215]
 buffer_load_dwordx4 v4, s[68:71], s28 offen lds
 v_mfma_f32_16x16x32_bf16 v[212:215], v[60:63], a[132:135], v[212:215]
 ds_read_b64_tr_b16 v[16:17], v6 offset:16384
 v_mul_f32 v150, v150, v86
 v_mfma_f32_16x16x32_bf16 v[216:219], v[28:31], a[8:11], 0
 v_rcp_f32 v87, v87
 v_mfma_f32_16x16x32_bf16 v[216:219], v[32:35], a[24:27], v[216:219]
 ds_read_b64_tr_b16 v[18:19], v6 offset:16896
 s_add_u32 s28, s23, 442496
 v_mfma_f32_16x16x32_bf16 v[216:219], v[36:39], a[40:43], v[216:219]
 ds_read_b64_tr_b16 v[20:21], v6 offset:20480
 s_add_u32 m0, s25, 6144
 v_mfma_f32_16x16x32_bf16 v[216:219], v[40:43], a[56:59], v[216:219]
 buffer_load_dwordx4 v4, s[68:71], s28 offen lds
 v_mfma_f32_16x16x32_bf16 v[216:219], v[44:47], a[72:75], v[216:219]
 ds_read_b64_tr_b16 v[22:23], v6 offset:20992
 v_mul_f32 v151, v151, v87
 v_mfma_f32_16x16x32_bf16 v[216:219], v[48:51], a[88:91], v[216:219]
 v_cvt_pk_bf16_f32 v95, v150, v151
 v_mul_f32 v82, v106, v106
 v_mfma_f32_16x16x32_bf16 v[216:219], v[52:55], a[104:107], v[216:219]
 ds_read_b64_tr_b16 v[24:25], v6 offset:24576
 s_add_u32 s28, s23, 589952
 v_mfma_f32_16x16x32_bf16 v[216:219], v[56:59], a[120:123], v[216:219]
 s_add_u32 m0, s25, 8192
 v_mul_f32 v83, v107, v107
 v_fma_f32 v80, v80, s30, v9
 v_mfma_f32_16x16x32_bf16 v[216:219], v[60:63], a[136:139], v[216:219]
 ds_read_b64_tr_b16 v[26:27], v6 offset:25088
 v_fma_f32 v81, v81, s30, v9
 v_mfma_f32_16x16x32_bf16 v[220:223], v[28:31], a[12:15], 0
 buffer_load_dwordx4 v4, s[68:71], s28 offen lds
 v_mfma_f32_16x16x32_bf16 v[220:223], v[32:35], a[28:31], v[220:223]
 ds_read_b64_tr_b16 v[28:29], v6 offset:28672
 v_fma_f32 v82, v82, s30, v9
 v_mfma_f32_16x16x32_bf16 v[220:223], v[36:39], a[44:47], v[220:223]
 ds_read_b64_tr_b16 v[30:31], v6 offset:29184
 v_fma_f32 v83, v83, s30, v9
 v_mfma_f32_16x16x32_bf16 v[220:223], v[40:43], a[60:63], v[220:223]
 buffer_store_dwordx4 v[92:95], v1, s[12:15], s37 offen sc1
 v_mfma_f32_16x16x32_bf16 v[220:223], v[44:47], a[76:79], v[220:223]
 ds_read_b64_tr_b16 v[32:33], v6 offset:32768
 v_mul_f32 v80, v80, v104
 v_mfma_f32_16x16x32_bf16 v[220:223], v[48:51], a[92:95], v[220:223]
 v_exp_f32 v80, v80
 v_mfma_f32_16x16x32_bf16 v[220:223], v[52:55], a[108:111], v[220:223]
 ds_read_b64_tr_b16 v[34:35], v6 offset:33280
 v_mul_f32 v81, v81, v105
 v_mfma_f32_16x16x32_bf16 v[220:223], v[56:59], a[124:127], v[220:223]
 v_exp_f32 v81, v81
 v_mfma_f32_16x16x32_bf16 v[220:223], v[60:63], a[140:143], v[220:223]
 s_waitcnt lgkmcnt(12)
 v_add_u32 v6, 36864, v6
 v_mul_f32 v82, v82, v106
 v_mfma_f32_16x16x32_bf16 v[160:163], v[64:67], a[144:147], v[160:163]
 ds_read_b64_tr_b16 v[36:37], v6 offset:0
 v_mul_f32 v83, v83, v107
 v_mfma_f32_16x16x32_bf16 v[160:163], v[68:71], a[160:163], v[160:163]
 v_xor_b32 v4, 64, v4
 v_mul_f32 v120, v104, v120
 v_mfma_f32_16x16x32_bf16 v[160:163], v[72:75], a[176:179], v[160:163]
 ds_read_b64_tr_b16 v[38:39], v6 offset:512
 s_waitcnt lgkmcnt(8)
 v_mfma_f32_16x16x32_bf16 v[160:163], v[76:79], a[192:195], v[160:163]
 s_add_u32 s28, s23, 73856
 v_exp_f32 v82, v82
 v_mfma_f32_16x16x32_bf16 v[160:163], v[16:19], a[208:211], v[160:163]
 ds_read_b64_tr_b16 v[40:41], v6 offset:4096
 s_add_u32 m0, s25, 1024
 v_mfma_f32_16x16x32_bf16 v[160:163], v[20:23], a[224:227], v[160:163]
 s_waitcnt lgkmcnt(3)
 v_exp_f32 v83, v83
 v_mfma_f32_16x16x32_bf16 v[160:163], v[24:27], a[240:243], v[160:163]
 ds_read_b64_tr_b16 v[42:43], v6 offset:4608
 v_mul_f32 v121, v105, v121
 v_mfma_f32_16x16x32_bf16 v[160:163], v[28:31], v[224:227], v[160:163]
 buffer_load_dwordx4 v4, s[68:71], s28 offen lds
 v_mfma_f32_16x16x32_bf16 v[160:163], v[32:35], v[240:243], v[160:163]
 ds_read_b64_tr_b16 v[44:45], v6 offset:8192
 s_add_u32 s28, s23, 221312
 v_mfma_f32_16x16x32_bf16 v[164:167], v[64:67], a[148:151], v[164:167]
 s_add_u32 m0, s25, 3072
 v_mul_f32 v122, v106, v122
 v_mul_f32 v123, v107, v123
 v_mfma_f32_16x16x32_bf16 v[164:167], v[68:71], a[164:167], v[164:167]
 ds_read_b64_tr_b16 v[46:47], v6 offset:8704
 v_add_f32 v80, 1.0, v80
 v_mfma_f32_16x16x32_bf16 v[164:167], v[72:75], a[180:183], v[164:167]
 buffer_load_dwordx4 v4, s[68:71], s28 offen lds
 v_mfma_f32_16x16x32_bf16 v[164:167], v[76:79], a[196:199], v[164:167]
 ds_read_b64_tr_b16 v[48:49], v6 offset:12288
 s_add_u32 s28, s23, 368768
 v_mfma_f32_16x16x32_bf16 v[164:167], v[16:19], a[212:215], v[164:167]
 s_add_u32 m0, s25, 5120
 v_rcp_f32 v80, v80
 v_mfma_f32_16x16x32_bf16 v[164:167], v[20:23], a[228:231], v[164:167]
 ds_read_b64_tr_b16 v[50:51], v6 offset:12800
 v_add_f32 v81, 1.0, v81
 v_mfma_f32_16x16x32_bf16 v[164:167], v[24:27], a[244:247], v[164:167]
 buffer_load_dwordx4 v4, s[68:71], s28 offen lds
 v_mfma_f32_16x16x32_bf16 v[164:167], v[28:31], v[228:231], v[164:167]
 ds_read_b64_tr_b16 v[52:53], v6 offset:16384
 s_add_u32 s28, s23, 516224
 v_mfma_f32_16x16x32_bf16 v[164:167], v[32:35], v[244:247], v[164:167]
 s_add_u32 m0, s25, 7168
 v_rcp_f32 v81, v81
 v_mfma_f32_16x16x32_bf16 v[168:171], v[64:67], a[152:155], v[168:171]
 ds_read_b64_tr_b16 v[54:55], v6 offset:16896
 v_add_f32 v82, 1.0, v82
 v_mfma_f32_16x16x32_bf16 v[168:171], v[68:71], a[168:171], v[168:171]
 buffer_load_dwordx4 v4, s[68:71], s28 offen lds
 v_mfma_f32_16x16x32_bf16 v[168:171], v[72:75], a[184:187], v[168:171]
 ds_read_b64_tr_b16 v[56:57], v6 offset:20480
 v_xor_b32 v4, 64, v4
 v_mfma_f32_16x16x32_bf16 v[168:171], v[76:79], a[200:203], v[168:171]
 s_add_u32 s28, s23, 128
 v_rcp_f32 v82, v82
 v_mfma_f32_16x16x32_bf16 v[168:171], v[16:19], a[216:219], v[168:171]
 ds_read_b64_tr_b16 v[58:59], v6 offset:20992
 s_add_u32 m0, s25, 36864
 v_mfma_f32_16x16x32_bf16 v[168:171], v[20:23], a[232:235], v[168:171]
 buffer_load_dwordx4 v4, s[72:75], s28 offen lds
 v_mfma_f32_16x16x32_bf16 v[168:171], v[24:27], a[248:251], v[168:171]
 ds_read_b64_tr_b16 v[60:61], v6 offset:24576
 s_add_u32 s28, s23, 147584
 v_mfma_f32_16x16x32_bf16 v[168:171], v[28:31], v[232:235], v[168:171]
 s_add_u32 m0, s25, 38912
 v_add_f32 v83, 1.0, v83
 v_mul_f32 v120, v120, v80
 v_mfma_f32_16x16x32_bf16 v[168:171], v[32:35], v[248:251], v[168:171]
 ds_read_b64_tr_b16 v[62:63], v6 offset:25088
 v_mul_f32 v121, v121, v81
 v_mfma_f32_16x16x32_bf16 v[172:175], v[64:67], a[156:159], v[172:175]
 buffer_load_dwordx4 v4, s[72:75], s28 offen lds
 v_mfma_f32_16x16x32_bf16 v[172:175], v[68:71], a[172:175], v[172:175]
 ds_read_b64_tr_b16 v[64:65], v6 offset:28672
 s_add_u32 s28, s23, 295040
 v_mfma_f32_16x16x32_bf16 v[172:175], v[72:75], a[188:191], v[172:175]
 s_add_u32 m0, s25, 40960
 v_rcp_f32 v83, v83
 v_mfma_f32_16x16x32_bf16 v[172:175], v[76:79], a[204:207], v[172:175]
 ds_read_b64_tr_b16 v[66:67], v6 offset:29184
 v_mul_f32 v122, v122, v82
 v_mfma_f32_16x16x32_bf16 v[172:175], v[16:19], a[220:223], v[172:175]
 buffer_load_dwordx4 v4, s[72:75], s28 offen lds
 v_mfma_f32_16x16x32_bf16 v[172:175], v[20:23], a[236:239], v[172:175]
 ds_read_b64_tr_b16 v[68:69], v6 offset:32768
 s_add_u32 s28, s23, 442496
 v_mfma_f32_16x16x32_bf16 v[172:175], v[24:27], a[252:255], v[172:175]
 s_add_u32 m0, s25, 43008
 v_mul_f32 v123, v123, v83
 v_cvt_pk_bf16_f32 v88, v120, v121
 v_mfma_f32_16x16x32_bf16 v[172:175], v[28:31], v[236:239], v[172:175]
 ds_read_b64_tr_b16 v[70:71], v6 offset:33280
 v_cvt_pk_bf16_f32 v89, v122, v123
 v_mfma_f32_16x16x32_bf16 v[172:175], v[32:35], v[252:255], v[172:175]
 s_waitcnt lgkmcnt(12)
 v_mul_f32 v84, v136, v136
 v_mul_f32 v85, v137, v137
 v_mfma_f32_16x16x32_bf16 v[176:179], v[36:39], a[144:147], v[176:179]
 ds_read_b64_tr_b16 v[72:73], v7 offset:0
 v_mul_f32 v86, v138, v138
 v_mfma_f32_16x16x32_bf16 v[176:179], v[40:43], a[160:163], v[176:179]
 buffer_load_dwordx4 v4, s[72:75], s28 offen lds
 v_mfma_f32_16x16x32_bf16 v[176:179], v[44:47], a[176:179], v[176:179]
 ds_read_b64_tr_b16 v[74:75], v7 offset:512
 s_waitcnt lgkmcnt(8)
 v_mfma_f32_16x16x32_bf16 v[176:179], v[48:51], a[192:195], v[176:179]
 s_add_u32 s28, s23, 589952
 v_mul_f32 v87, v139, v139
 v_fma_f32 v84, v84, s30, v9
 v_mfma_f32_16x16x32_bf16 v[176:179], v[52:55], a[208:211], v[176:179]
 ds_read_b64_tr_b16 v[76:77], v7 offset:4096
 v_subrev_u32 v6, 110592, v6
 v_mfma_f32_16x16x32_bf16 v[176:179], v[56:59], a[224:227], v[176:179]
 s_add_u32 m0, s25, 45056
 s_waitcnt lgkmcnt(3)
 v_xor_b32 v6, 64, v6
 v_mfma_f32_16x16x32_bf16 v[176:179], v[60:63], a[240:243], v[176:179]
 ds_read_b64_tr_b16 v[78:79], v7 offset:4608
 v_fma_f32 v85, v85, s30, v9
 v_mfma_f32_16x16x32_bf16 v[176:179], v[64:67], v[224:227], v[176:179]
 buffer_load_dwordx4 v4, s[72:75], s28 offen lds
 v_mfma_f32_16x16x32_bf16 v[176:179], v[68:71], v[240:243], v[176:179]
 ds_read_b64_tr_b16 v[16:17], v7 offset:8192
 v_xor_b32 v4, 64, v4
 v_mfma_f32_16x16x32_bf16 v[180:183], v[36:39], a[148:151], v[180:183]
 s_add_u32 s28, s23, 73856
 v_fma_f32 v86, v86, s30, v9
 v_fma_f32 v87, v87, s30, v9
 v_mfma_f32_16x16x32_bf16 v[180:183], v[40:43], a[164:167], v[180:183]
 ds_read_b64_tr_b16 v[18:19], v7 offset:8704
 s_add_u32 m0, s25, 37888
 v_mfma_f32_16x16x32_bf16 v[180:183], v[44:47], a[180:183], v[180:183]
 buffer_load_dwordx4 v4, s[72:75], s28 offen lds
 v_mfma_f32_16x16x32_bf16 v[180:183], v[48:51], a[196:199], v[180:183]
 ds_read_b64_tr_b16 v[20:21], v7 offset:12288
 s_add_u32 s28, s23, 221312
 v_mfma_f32_16x16x32_bf16 v[180:183], v[52:55], a[212:215], v[180:183]
 s_add_u32 m0, s25, 39936
 v_mul_f32 v84, v84, v136
 v_mul_f32 v85, v85, v137
 v_mfma_f32_16x16x32_bf16 v[180:183], v[56:59], a[228:231], v[180:183]
 ds_read_b64_tr_b16 v[22:23], v7 offset:12800
 v_mul_f32 v86, v86, v138
 v_mfma_f32_16x16x32_bf16 v[180:183], v[60:63], a[244:247], v[180:183]
 buffer_load_dwordx4 v4, s[72:75], s28 offen lds
 v_mfma_f32_16x16x32_bf16 v[180:183], v[64:67], v[228:231], v[180:183]
 ds_read_b64_tr_b16 v[24:25], v7 offset:16384
 s_add_u32 s28, s23, 368768
 v_mfma_f32_16x16x32_bf16 v[180:183], v[68:71], v[244:247], v[180:183]
 s_add_u32 m0, s25, 41984
 v_exp_f32 v84, v84
 v_mfma_f32_16x16x32_bf16 v[184:187], v[36:39], a[152:155], v[184:187]
 ds_read_b64_tr_b16 v[26:27], v7 offset:16896
 v_mul_f32 v87, v87, v139
 v_mfma_f32_16x16x32_bf16 v[184:187], v[40:43], a[168:171], v[184:187]
 buffer_load_dwordx4 v4, s[72:75], s28 offen lds
 v_mfma_f32_16x16x32_bf16 v[184:187], v[44:47], a[184:187], v[184:187]
 ds_read_b64_tr_b16 v[28:29], v7 offset:20480
 s_add_u32 s28, s23, 516224
 v_mfma_f32_16x16x32_bf16 v[184:187], v[48:51], a[200:203], v[184:187]
 s_add_u32 m0, s25, 44032
 v_exp_f32 v85, v85
 v_mfma_f32_16x16x32_bf16 v[184:187], v[52:55], a[216:219], v[184:187]
 ds_read_b64_tr_b16 v[30:31], v7 offset:20992
 v_mul_f32 v152, v136, v152
 v_mfma_f32_16x16x32_bf16 v[184:187], v[56:59], a[232:235], v[184:187]
 buffer_load_dwordx4 v4, s[72:75], s28 offen lds
 v_mfma_f32_16x16x32_bf16 v[184:187], v[60:63], a[248:251], v[184:187]
 ds_read_b64_tr_b16 v[32:33], v7 offset:24576
 v_xor_b32 v4, 64, v4
 v_mfma_f32_16x16x32_bf16 v[184:187], v[64:67], v[232:235], v[184:187]
 s_add_u32 s29, s24, 4718592
 v_exp_f32 v86, v86
 v_mfma_f32_16x16x32_bf16 v[184:187], v[68:71], v[248:251], v[184:187]
 ds_read_b64_tr_b16 v[34:35], v7 offset:25088
 s_mov_b64 exec, s[78:79]
 buffer_load_dword v8, v5, s[4:7], s29 offen
 s_mov_b64 exec, -1
 v_mfma_f32_16x16x32_bf16 v[188:191], v[36:39], a[156:159], v[188:191]
 v_exp_f32 v87, v87
 v_mfma_f32_16x16x32_bf16 v[188:191], v[40:43], a[172:175], v[188:191]
 ds_read_b64_tr_b16 v[36:37], v7 offset:28672
 v_mul_f32 v153, v137, v153
 v_mfma_f32_16x16x32_bf16 v[188:191], v[44:47], a[188:191], v[188:191]
 v_mul_f32 v154, v138, v154
 v_mul_f32 v155, v139, v155
 v_mfma_f32_16x16x32_bf16 v[188:191], v[48:51], a[204:207], v[188:191]
 ds_read_b64_tr_b16 v[38:39], v7 offset:29184
 v_add_f32 v84, 1.0, v84
 v_mfma_f32_16x16x32_bf16 v[188:191], v[52:55], a[220:223], v[188:191]
 s_add_u32 s36, s26, 294912
 v_rcp_f32 v84, v84
 v_mfma_f32_16x16x32_bf16 v[188:191], v[56:59], a[236:239], v[188:191]
 ds_read_b64_tr_b16 v[40:41], v7 offset:32768
 v_add_f32 v85, 1.0, v85
 v_mfma_f32_16x16x32_bf16 v[188:191], v[60:63], a[252:255], v[188:191]
 v_rcp_f32 v85, v85
 v_mfma_f32_16x16x32_bf16 v[188:191], v[64:67], v[236:239], v[188:191]
 ds_read_b64_tr_b16 v[42:43], v7 offset:33280
 v_add_f32 v86, 1.0, v86
 v_mfma_f32_16x16x32_bf16 v[188:191], v[68:71], v[252:255], v[188:191]
 s_waitcnt lgkmcnt(12)
 v_add_u32 v7, 36864, v7
 v_add_f32 v87, 1.0, v87
 v_mfma_f32_16x16x32_bf16 v[192:195], v[72:75], a[144:147], v[192:195]
 ds_read_b64_tr_b16 v[44:45], v7 offset:0
 v_mul_f32 v152, v152, v84
 v_mfma_f32_16x16x32_bf16 v[192:195], v[76:79], a[160:163], v[192:195]
 v_rcp_f32 v86, v86
 v_mfma_f32_16x16x32_bf16 v[192:195], v[16:19], a[176:179], v[192:195]
 ds_read_b64_tr_b16 v[46:47], v7 offset:512
 s_waitcnt lgkmcnt(8)
 v_mfma_f32_16x16x32_bf16 v[192:195], v[20:23], a[192:195], v[192:195]
 v_rcp_f32 v87, v87
 v_mfma_f32_16x16x32_bf16 v[192:195], v[24:27], a[208:211], v[192:195]
 ds_read_b64_tr_b16 v[48:49], v7 offset:4096
 v_mul_f32 v153, v153, v85
 v_mfma_f32_16x16x32_bf16 v[192:195], v[28:31], a[224:227], v[192:195]
 s_waitcnt lgkmcnt(3)
 v_mul_f32 v154, v154, v86
 v_mul_f32 v155, v155, v87
 v_mfma_f32_16x16x32_bf16 v[192:195], v[32:35], a[240:243], v[192:195]
 ds_read_b64_tr_b16 v[50:51], v7 offset:4608
 v_cvt_pk_bf16_f32 v90, v152, v153
 v_mfma_f32_16x16x32_bf16 v[192:195], v[36:39], v[224:227], v[192:195]
 v_cvt_pk_bf16_f32 v91, v154, v155
 v_mul_f32 v80, v108, v108
 v_mfma_f32_16x16x32_bf16 v[192:195], v[40:43], v[240:243], v[192:195]
 ds_read_b64_tr_b16 v[52:53], v7 offset:8192
 v_mul_f32 v81, v109, v109
 v_mfma_f32_16x16x32_bf16 v[196:199], v[72:75], a[148:151], v[196:199]
 buffer_store_dwordx4 v[88:91], v1, s[12:15], s36 offen sc1
 v_mfma_f32_16x16x32_bf16 v[196:199], v[76:79], a[164:167], v[196:199]
 ds_read_b64_tr_b16 v[54:55], v7 offset:8704
 v_mul_f32 v82, v110, v110
 v_mfma_f32_16x16x32_bf16 v[196:199], v[16:19], a[180:183], v[196:199]
 v_mul_f32 v83, v111, v111
 v_fma_f32 v80, v80, s30, v9
 v_mfma_f32_16x16x32_bf16 v[196:199], v[20:23], a[196:199], v[196:199]
 ds_read_b64_tr_b16 v[56:57], v7 offset:12288
 v_fma_f32 v81, v81, s30, v9
 v_mfma_f32_16x16x32_bf16 v[196:199], v[24:27], a[212:215], v[196:199]
 v_fma_f32 v82, v82, s30, v9
 v_fma_f32 v83, v83, s30, v9
 v_mfma_f32_16x16x32_bf16 v[196:199], v[28:31], a[228:231], v[196:199]
 ds_read_b64_tr_b16 v[58:59], v7 offset:12800
 v_mul_f32 v80, v80, v108
 v_mfma_f32_16x16x32_bf16 v[196:199], v[32:35], a[244:247], v[196:199]
 v_exp_f32 v80, v80
 v_mfma_f32_16x16x32_bf16 v[196:199], v[36:39], v[228:231], v[196:199]
 ds_read_b64_tr_b16 v[60:61], v7 offset:16384
 v_mul_f32 v81, v81, v109
 v_mfma_f32_16x16x32_bf16 v[196:199], v[40:43], v[244:247], v[196:199]
 v_exp_f32 v81, v81
 v_mfma_f32_16x16x32_bf16 v[200:203], v[72:75], a[152:155], v[200:203]
 ds_read_b64_tr_b16 v[62:63], v7 offset:16896
 v_mul_f32 v82, v82, v110
 v_mfma_f32_16x16x32_bf16 v[200:203], v[76:79], a[168:171], v[200:203]
 v_exp_f32 v82, v82
 v_mfma_f32_16x16x32_bf16 v[200:203], v[16:19], a[184:187], v[200:203]
 ds_read_b64_tr_b16 v[64:65], v7 offset:20480
 v_mul_f32 v83, v83, v111
 v_mfma_f32_16x16x32_bf16 v[200:203], v[20:23], a[200:203], v[200:203]
 v_exp_f32 v83, v83
 v_mfma_f32_16x16x32_bf16 v[200:203], v[24:27], a[216:219], v[200:203]
 ds_read_b64_tr_b16 v[66:67], v7 offset:20992
 v_mul_f32 v124, v108, v124
 v_mfma_f32_16x16x32_bf16 v[200:203], v[28:31], a[232:235], v[200:203]
 v_mul_f32 v125, v109, v125
 v_mul_f32 v126, v110, v126
 v_mfma_f32_16x16x32_bf16 v[200:203], v[32:35], a[248:251], v[200:203]
 ds_read_b64_tr_b16 v[68:69], v7 offset:24576
 v_mul_f32 v127, v111, v127
 v_mfma_f32_16x16x32_bf16 v[200:203], v[36:39], v[232:235], v[200:203]
 v_add_f32 v80, 1.0, v80
 v_add_f32 v81, 1.0, v81
 v_mfma_f32_16x16x32_bf16 v[200:203], v[40:43], v[248:251], v[200:203]
 ds_read_b64_tr_b16 v[70:71], v7 offset:25088
 v_add_f32 v82, 1.0, v82
 v_mfma_f32_16x16x32_bf16 v[204:207], v[72:75], a[156:159], v[204:207]
 v_rcp_f32 v80, v80
 v_mfma_f32_16x16x32_bf16 v[204:207], v[76:79], a[172:175], v[204:207]
 ds_read_b64_tr_b16 v[72:73], v7 offset:28672
 v_add_f32 v83, 1.0, v83
 v_mfma_f32_16x16x32_bf16 v[204:207], v[16:19], a[188:191], v[204:207]
 v_rcp_f32 v81, v81
 v_mfma_f32_16x16x32_bf16 v[204:207], v[20:23], a[204:207], v[204:207]
 ds_read_b64_tr_b16 v[74:75], v7 offset:29184
 v_mul_f32 v124, v124, v80
 v_mfma_f32_16x16x32_bf16 v[204:207], v[24:27], a[220:223], v[204:207]
 v_rcp_f32 v82, v82
 v_mfma_f32_16x16x32_bf16 v[204:207], v[28:31], a[236:239], v[204:207]
 ds_read_b64_tr_b16 v[76:77], v7 offset:32768
 v_mul_f32 v125, v125, v81
 v_mfma_f32_16x16x32_bf16 v[204:207], v[32:35], a[252:255], v[204:207]
 v_rcp_f32 v83, v83
 v_mfma_f32_16x16x32_bf16 v[204:207], v[36:39], v[236:239], v[204:207]
 ds_read_b64_tr_b16 v[78:79], v7 offset:33280
 v_mul_f32 v126, v126, v82
 v_mfma_f32_16x16x32_bf16 v[204:207], v[40:43], v[252:255], v[204:207]
 s_waitcnt lgkmcnt(12)
 v_subrev_u32 v7, 110592, v7
 v_mul_f32 v127, v127, v83
 v_mfma_f32_16x16x32_bf16 v[208:211], v[44:47], a[144:147], v[208:211]
 v_xor_b32 v7, 64, v7
 v_cvt_pk_bf16_f32 v92, v124, v125
 v_mfma_f32_16x16x32_bf16 v[208:211], v[48:51], a[160:163], v[208:211]
 v_cvt_pk_bf16_f32 v93, v126, v127
 v_mul_f32 v84, v140, v140
 v_mfma_f32_16x16x32_bf16 v[208:211], v[52:55], a[176:179], v[208:211]
 s_waitcnt lgkmcnt(6)
 s_waitcnt lgkmcnt(0)
 s_waitcnt vmcnt(2)
 s_barrier
 v_mfma_f32_16x16x32_bf16 v[208:211], v[56:59], a[192:195], v[208:211]
 ds_read_b64_tr_b16 v[16:17], v6 offset:0
 v_mul_f32 v85, v141, v141
 v_mfma_f32_16x16x32_bf16 v[208:211], v[60:63], a[208:211], v[208:211]
 ds_read_b64_tr_b16 v[18:19], v6 offset:512
 s_add_u32 s28, s23, 2654336
 v_mfma_f32_16x16x32_bf16 v[208:211], v[64:67], a[224:227], v[208:211]
 s_add_u32 m0, s25, 73728
 v_mul_f32 v86, v142, v142
 v_mfma_f32_16x16x32_bf16 v[208:211], v[68:71], a[240:243], v[208:211]
 ds_read_b64_tr_b16 v[20:21], v6 offset:4096
 v_mul_f32 v87, v143, v143
 v_mfma_f32_16x16x32_bf16 v[208:211], v[72:75], v[224:227], v[208:211]
 buffer_load_dwordx4 v4, s[68:71], s28 offen lds
 v_mfma_f32_16x16x32_bf16 v[208:211], v[76:79], v[240:243], v[208:211]
 ds_read_b64_tr_b16 v[22:23], v6 offset:4608
 v_fma_f32 v84, v84, s30, v9
 v_mfma_f32_16x16x32_bf16 v[212:215], v[44:47], a[148:151], v[212:215]
 s_add_u32 s28, s23, 2801792
 v_fma_f32 v85, v85, s30, v9
 v_fma_f32 v86, v86, s30, v9
 v_mfma_f32_16x16x32_bf16 v[212:215], v[48:51], a[164:167], v[212:215]
 ds_read_b64_tr_b16 v[24:25], v6 offset:8192
 s_add_u32 m0, s25, 75776
 v_mfma_f32_16x16x32_bf16 v[212:215], v[52:55], a[180:183], v[212:215]
 ds_read_b64_tr_b16 v[26:27], v6 offset:8704
 v_fma_f32 v87, v87, s30, v9
 v_mfma_f32_16x16x32_bf16 v[212:215], v[56:59], a[196:199], v[212:215]
 buffer_load_dwordx4 v4, s[68:71], s28 offen lds
 v_mfma_f32_16x16x32_bf16 v[212:215], v[60:63], a[212:215], v[212:215]
 ds_read_b64_tr_b16 v[28:29], v6 offset:12288
 v_mul_f32 v84, v84, v140
 v_mfma_f32_16x16x32_bf16 v[212:215], v[64:67], a[228:231], v[212:215]
 s_add_u32 s28, s23, 2949248
 v_exp_f32 v84, v84
 v_mfma_f32_16x16x32_bf16 v[212:215], v[68:71], a[244:247], v[212:215]
 ds_read_b64_tr_b16 v[30:31], v6 offset:12800
 s_add_u32 m0, s25, 77824
 v_mfma_f32_16x16x32_bf16 v[212:215], v[72:75], v[228:231], v[212:215]
 buffer_load_dwordx4 v4, s[68:71], s28 offen lds
 v_mfma_f32_16x16x32_bf16 v[212:215], v[76:79], v[244:247], v[212:215]
 ds_read_b64_tr_b16 v[32:33], v6 offset:16384
 v_mul_f32 v85, v85, v141
 v_mfma_f32_16x16x32_bf16 v[216:219], v[44:47], a[152:155], v[216:219]
 v_exp_f32 v85, v85
 v_mfma_f32_16x16x32_bf16 v[216:219], v[48:51], a[168:171], v[216:219]
 ds_read_b64_tr_b16 v[34:35], v6 offset:16896
 s_add_u32 s28, s23, 3096704
 v_mfma_f32_16x16x32_bf16 v[216:219], v[52:55], a[184:187], v[216:219]
 ds_read_b64_tr_b16 v[36:37], v6 offset:20480
 s_add_u32 m0, s25, 79872
 v_mfma_f32_16x16x32_bf16 v[216:219], v[56:59], a[200:203], v[216:219]
 buffer_load_dwordx4 v4, s[68:71], s28 offen lds
 v_mfma_f32_16x16x32_bf16 v[216:219], v[60:63], a[216:219], v[216:219]
 ds_read_b64_tr_b16 v[38:39], v6 offset:20992
 v_mul_f32 v86, v86, v142
 v_mfma_f32_16x16x32_bf16 v[216:219], v[64:67], a[232:235], v[216:219]
 v_exp_f32 v86, v86
 v_mfma_f32_16x16x32_bf16 v[216:219], v[68:71], a[248:251], v[216:219]
 ds_read_b64_tr_b16 v[40:41], v6 offset:24576
 s_add_u32 s28, s23, 3244160
 v_mfma_f32_16x16x32_bf16 v[216:219], v[72:75], v[232:235], v[216:219]
 s_add_u32 m0, s25, 81920
 v_mul_f32 v87, v87, v143
 v_mul_f32 v156, v140, v156
 v_mfma_f32_16x16x32_bf16 v[216:219], v[76:79], v[248:251], v[216:219]
 ds_read_b64_tr_b16 v[42:43], v6 offset:25088
 v_mul_f32 v157, v141, v157
 v_mfma_f32_16x16x32_bf16 v[220:223], v[44:47], a[156:159], v[220:223]
 buffer_load_dwordx4 v4, s[68:71], s28 offen lds
 v_mfma_f32_16x16x32_bf16 v[220:223], v[48:51], a[172:175], v[220:223]
 ds_read_b64_tr_b16 v[44:45], v6 offset:28672
 v_mul_f32 v158, v142, v158
 v_mfma_f32_16x16x32_bf16 v[220:223], v[52:55], a[188:191], v[220:223]
 ds_read_b64_tr_b16 v[46:47], v6 offset:29184
 v_mul_f32 v159, v143, v159
 v_mfma_f32_16x16x32_bf16 v[220:223], v[56:59], a[204:207], v[220:223]
 v_exp_f32 v87, v87
 v_mfma_f32_16x16x32_bf16 v[220:223], v[60:63], a[220:223], v[220:223]
 ds_read_b64_tr_b16 v[48:49], v6 offset:32768
 v_add_f32 v84, 1.0, v84
 v_mfma_f32_16x16x32_bf16 v[220:223], v[64:67], a[236:239], v[220:223]
 s_add_u32 s37, s26, 442368
 v_rcp_f32 v84, v84
 v_mfma_f32_16x16x32_bf16 v[220:223], v[68:71], a[252:255], v[220:223]
 ds_read_b64_tr_b16 v[50:51], v6 offset:33280
 v_add_f32 v85, 1.0, v85
 v_mfma_f32_16x16x32_bf16 v[220:223], v[72:75], v[236:239], v[220:223]
 v_rcp_f32 v85, v85
 v_mfma_f32_16x16x32_bf16 v[220:223], v[76:79], v[252:255], v[220:223]
 s_waitcnt lgkmcnt(12)
 v_add_u32 v6, 36864, v6
 v_add_f32 v86, 1.0, v86
 v_mfma_f32_16x16x32_bf16 v[96:99], v[16:19], a[0:3], 0
 ds_read_b64_tr_b16 v[52:53], v6 offset:0
 v_add_f32 v87, 1.0, v87
 v_mfma_f32_16x16x32_bf16 v[96:99], v[20:23], a[16:19], v[96:99]
 v_xor_b32 v4, 64, v4
 v_mul_f32 v156, v156, v84
 v_mfma_f32_16x16x32_bf16 v[96:99], v[24:27], a[32:35], v[96:99]
 ds_read_b64_tr_b16 v[54:55], v6 offset:512
 s_waitcnt lgkmcnt(8)
 v_mfma_f32_16x16x32_bf16 v[96:99], v[28:31], a[48:51], v[96:99]
 s_add_u32 s28, s23, 2728064
 v_rcp_f32 v86, v86
 v_mfma_f32_16x16x32_bf16 v[96:99], v[32:35], a[64:67], v[96:99]
 ds_read_b64_tr_b16 v[56:57], v6 offset:4096
 s_add_u32 m0, s25, 74752
 v_mfma_f32_16x16x32_bf16 v[96:99], v[36:39], a[80:83], v[96:99]
 s_waitcnt lgkmcnt(3)
 v_rcp_f32 v87, v87
 v_mfma_f32_16x16x32_bf16 v[96:99], v[40:43], a[96:99], v[96:99]
 ds_read_b64_tr_b16 v[58:59], v6 offset:4608
 v_mul_f32 v157, v157, v85
 v_mfma_f32_16x16x32_bf16 v[96:99], v[44:47], a[112:115], v[96:99]
 buffer_load_dwordx4 v4, s[68:71], s28 offen lds
 v_mfma_f32_16x16x32_bf16 v[96:99], v[48:51], a[128:131], v[96:99]
 ds_read_b64_tr_b16 v[60:61], v6 offset:8192
 s_add_u32 s28, s23, 2875520
 v_mfma_f32_16x16x32_bf16 v[100:103], v[16:19], a[4:7], 0
 s_add_u32 m0, s25, 76800
 v_mul_f32 v158, v158, v86
 v_mul_f32 v159, v159, v87
 v_mfma_f32_16x16x32_bf16 v[100:103], v[20:23], a[20:23], v[100:103]
 ds_read_b64_tr_b16 v[62:63], v6 offset:8704
 v_cvt_pk_bf16_f32 v94, v156, v157
 v_mfma_f32_16x16x32_bf16 v[100:103], v[24:27], a[36:39], v[100:103]
 buffer_load_dwordx4 v4, s[68:71], s28 offen lds
 v_mfma_f32_16x16x32_bf16 v[100:103], v[28:31], a[52:55], v[100:103]
 ds_read_b64_tr_b16 v[64:65], v6 offset:12288
 s_add_u32 s28, s23, 3022976
 v_mfma_f32_16x16x32_bf16 v[100:103], v[32:35], a[68:71], v[100:103]
 s_add_u32 m0, s25, 78848
 v_cvt_pk_bf16_f32 v95, v158, v159
 v_mul_f32 v80, v160, v160
 v_mfma_f32_16x16x32_bf16 v[100:103], v[36:39], a[84:87], v[100:103]
 ds_read_b64_tr_b16 v[66:67], v6 offset:12800
 v_mul_f32 v81, v161, v161
 v_mfma_f32_16x16x32_bf16 v[100:103], v[40:43], a[100:103], v[100:103]
 buffer_load_dwordx4 v4, s[68:71], s28 offen lds
 v_mfma_f32_16x16x32_bf16 v[100:103], v[44:47], a[116:119], v[100:103]
 ds_read_b64_tr_b16 v[68:69], v6 offset:16384
 s_add_u32 s28, s23, 3170432
 v_mfma_f32_16x16x32_bf16 v[100:103], v[48:51], a[132:135], v[100:103]
 s_add_u32 m0, s25, 80896
 v_mul_f32 v82, v162, v162
 v_mul_f32 v83, v163, v163
 v_mfma_f32_16x16x32_bf16 v[104:107], v[16:19], a[8:11], 0
 ds_read_b64_tr_b16 v[70:71], v6 offset:16896
 v_fma_f32 v80, v80, s30, v9
 v_mfma_f32_16x16x32_bf16 v[104:107], v[20:23], a[24:27], v[104:107]
 buffer_load_dwordx4 v4, s[68:71], s28 offen lds
 v_mfma_f32_16x16x32_bf16 v[104:107], v[24:27], a[40:43], v[104:107]
 ds_read_b64_tr_b16 v[72:73], v6 offset:20480
 v_xor_b32 v4, 64, v4
 v_mfma_f32_16x16x32_bf16 v[104:107], v[28:31], a[56:59], v[104:107]
 s_add_u32 s28, s23, 2654336
 v_fma_f32 v81, v81, s30, v9
 v_fma_f32 v82, v82, s30, v9
 v_mfma_f32_16x16x32_bf16 v[104:107], v[32:35], a[72:75], v[104:107]
 ds_read_b64_tr_b16 v[74:75], v6 offset:20992
 s_add_u32 m0, s25, 110592
 v_mfma_f32_16x16x32_bf16 v[104:107], v[36:39], a[88:91], v[104:107]
 buffer_load_dwordx4 v4, s[72:75], s28 offen lds
 v_mfma_f32_16x16x32_bf16 v[104:107], v[40:43], a[104:107], v[104:107]
 ds_read_b64_tr_b16 v[76:77], v6 offset:24576
 s_add_u32 s28, s23, 2801792
 v_mfma_f32_16x16x32_bf16 v[104:107], v[44:47], a[120:123], v[104:107]
 s_add_u32 m0, s25, 112640
 v_fma_f32 v83, v83, s30, v9
 v_mul_f32 v80, v80, v160
 v_mfma_f32_16x16x32_bf16 v[104:107], v[48:51], a[136:139], v[104:107]
 ds_read_b64_tr_b16 v[78:79], v6 offset:25088
 v_mul_f32 v81, v81, v161
 v_mfma_f32_16x16x32_bf16 v[108:111], v[16:19], a[12:15], 0
 buffer_load_dwordx4 v4, s[72:75], s28 offen lds
 v_mfma_f32_16x16x32_bf16 v[108:111], v[20:23], a[28:31], v[108:111]
 ds_read_b64_tr_b16 v[16:17], v6 offset:28672
 s_add_u32 s28, s23, 2949248
 v_mfma_f32_16x16x32_bf16 v[108:111], v[24:27], a[44:47], v[108:111]
 s_add_u32 m0, s25, 114688
 v_exp_f32 v80, v80
 v_mfma_f32_16x16x32_bf16 v[108:111], v[28:31], a[60:63], v[108:111]
 ds_read_b64_tr_b16 v[18:19], v6 offset:29184
 v_mul_f32 v82, v82, v162
 v_mfma_f32_16x16x32_bf16 v[108:111], v[32:35], a[76:79], v[108:111]
 buffer_load_dwordx4 v4, s[72:75], s28 offen lds
 v_mfma_f32_16x16x32_bf16 v[108:111], v[36:39], a[92:95], v[108:111]
 ds_read_b64_tr_b16 v[20:21], v6 offset:32768
 s_add_u32 s28, s23, 3096704
 v_mfma_f32_16x16x32_bf16 v[108:111], v[40:43], a[108:111], v[108:111]
 s_add_u32 m0, s25, 116736
 v_exp_f32 v81, v81
 v_mfma_f32_16x16x32_bf16 v[108:111], v[44:47], a[124:127], v[108:111]
 ds_read_b64_tr_b16 v[22:23], v6 offset:33280
 v_mul_f32 v83, v83, v163
 v_mfma_f32_16x16x32_bf16 v[108:111], v[48:51], a[140:143], v[108:111]
 s_waitcnt lgkmcnt(12)
 v_exp_f32 v82, v82
 v_mfma_f32_16x16x32_bf16 v[112:115], v[52:55], a[0:3], 0
 ds_read_b64_tr_b16 v[24:25], v7 offset:0
 v_mul_f32 v176, v160, v176
 v_mfma_f32_16x16x32_bf16 v[112:115], v[56:59], a[16:19], v[112:115]
 buffer_load_dwordx4 v4, s[72:75], s28 offen lds
 v_mfma_f32_16x16x32_bf16 v[112:115], v[60:63], a[32:35], v[112:115]
 ds_read_b64_tr_b16 v[26:27], v7 offset:512
 s_waitcnt lgkmcnt(8)
 v_mfma_f32_16x16x32_bf16 v[112:115], v[64:67], a[48:51], v[112:115]
 s_add_u32 s28, s23, 3244160
 v_exp_f32 v83, v83
 v_mfma_f32_16x16x32_bf16 v[112:115], v[68:71], a[64:67], v[112:115]
 ds_read_b64_tr_b16 v[28:29], v7 offset:4096
 v_add_u32 v6, 36864, v6
 v_mfma_f32_16x16x32_bf16 v[112:115], v[72:75], a[80:83], v[112:115]
 s_add_u32 m0, s25, 118784
 s_waitcnt lgkmcnt(3)
 v_mul_f32 v177, v161, v177
 v_mfma_f32_16x16x32_bf16 v[112:115], v[76:79], a[96:99], v[112:115]
 ds_read_b64_tr_b16 v[30:31], v7 offset:4608
 v_mul_f32 v178, v162, v178
 v_mfma_f32_16x16x32_bf16 v[112:115], v[16:19], a[112:115], v[112:115]
 buffer_load_dwordx4 v4, s[72:75], s28 offen lds
 v_mfma_f32_16x16x32_bf16 v[112:115], v[20:23], a[128:131], v[112:115]
 ds_read_b64_tr_b16 v[32:33], v7 offset:8192
 v_xor_b32 v4, 64, v4
 v_mfma_f32_16x16x32_bf16 v[116:119], v[52:55], a[4:7], 0
 s_add_u32 s28, s23, 2728064
 v_mul_f32 v179, v163, v179
 v_add_f32 v80, 1.0, v80
 v_mfma_f32_16x16x32_bf16 v[116:119], v[56:59], a[20:23], v[116:119]
 ds_read_b64_tr_b16 v[34:35], v7 offset:8704
 s_add_u32 m0, s25, 111616
 v_mfma_f32_16x16x32_bf16 v[116:119], v[60:63], a[36:39], v[116:119]
 buffer_load_dwordx4 v4, s[72:75], s28 offen lds
 v_mfma_f32_16x16x32_bf16 v[116:119], v[64:67], a[52:55], v[116:119]
 ds_read_b64_tr_b16 v[36:37], v7 offset:12288
 s_add_u32 s28, s23, 2875520
 v_mfma_f32_16x16x32_bf16 v[116:119], v[68:71], a[68:71], v[116:119]
 s_add_u32 m0, s25, 113664
 v_rcp_f32 v80, v80
 v_mfma_f32_16x16x32_bf16 v[116:119], v[72:75], a[84:87], v[116:119]
 ds_read_b64_tr_b16 v[38:39], v7 offset:12800
 v_add_f32 v81, 1.0, v81
 v_mfma_f32_16x16x32_bf16 v[116:119], v[76:79], a[100:103], v[116:119]
 buffer_load_dwordx4 v4, s[72:75], s28 offen lds
 v_mfma_f32_16x16x32_bf16 v[116:119], v[16:19], a[116:119], v[116:119]
 ds_read_b64_tr_b16 v[40:41], v7 offset:16384
 s_add_u32 s28, s23, 3022976
 v_mfma_f32_16x16x32_bf16 v[116:119], v[20:23], a[132:135], v[116:119]
 s_add_u32 m0, s25, 115712
 v_rcp_f32 v81, v81
 v_mfma_f32_16x16x32_bf16 v[120:123], v[52:55], a[8:11], 0
 ds_read_b64_tr_b16 v[42:43], v7 offset:16896
 v_add_f32 v82, 1.0, v82
 v_mfma_f32_16x16x32_bf16 v[120:123], v[56:59], a[24:27], v[120:123]
 buffer_load_dwordx4 v4, s[72:75], s28 offen lds
 v_mfma_f32_16x16x32_bf16 v[120:123], v[60:63], a[40:43], v[120:123]
 ds_read_b64_tr_b16 v[44:45], v7 offset:20480
 s_add_u32 s28, s23, 3170432
 v_mfma_f32_16x16x32_bf16 v[120:123], v[64:67], a[56:59], v[120:123]
 s_add_u32 m0, s25, 117760
 v_rcp_f32 v82, v82
 v_mfma_f32_16x16x32_bf16 v[120:123], v[68:71], a[72:75], v[120:123]
 ds_read_b64_tr_b16 v[46:47], v7 offset:20992
 v_add_f32 v83, 1.0, v83
 v_mfma_f32_16x16x32_bf16 v[120:123], v[72:75], a[88:91], v[120:123]
 buffer_load_dwordx4 v4, s[72:75], s28 offen lds
 v_mfma_f32_16x16x32_bf16 v[120:123], v[76:79], a[104:107], v[120:123]
 ds_read_b64_tr_b16 v[48:49], v7 offset:24576
 v_xor_b32 v4, 64, v4
 v_mfma_f32_16x16x32_bf16 v[120:123], v[16:19], a[120:123], v[120:123]
 s_lshr_b32 s44, s2, 3
 v_rcp_f32 v83, v83
 v_mfma_f32_16x16x32_bf16 v[120:123], v[20:23], a[136:139], v[120:123]
 ds_read_b64_tr_b16 v[50:51], v7 offset:25088
 s_lshl_b32 s44, s44, 2
 v_mfma_f32_16x16x32_bf16 v[124:127], v[52:55], a[12:15], 0
 s_add_u32 s44, s44, s20
 v_mul_f32 v176, v176, v80
 v_mul_f32 v177, v177, v81
 v_mfma_f32_16x16x32_bf16 v[124:127], v[56:59], a[28:31], v[124:127]
 ds_read_b64_tr_b16 v[52:53], v7 offset:28672
 s_mul_i32 s44, s44, 3
 v_mfma_f32_16x16x32_bf16 v[124:127], v[60:63], a[44:47], v[124:127]
 s_add_u32 s44, s44, 0
 v_mul_f32 v178, v178, v82
 v_mul_f32 v179, v179, v83
 v_mfma_f32_16x16x32_bf16 v[124:127], v[64:67], a[60:63], v[124:127]
 ds_read_b64_tr_b16 v[54:55], v7 offset:29184
 s_mul_i32 s45, s44, 911
 v_mfma_f32_16x16x32_bf16 v[124:127], v[68:71], a[76:79], v[124:127]
 s_lshr_b32 s45, s45, 16
 v_cvt_pk_bf16_f32 v88, v176, v177
 v_cvt_pk_bf16_f32 v89, v178, v179
 v_mfma_f32_16x16x32_bf16 v[124:127], v[72:75], a[92:95], v[124:127]
 ds_read_b64_tr_b16 v[56:57], v7 offset:32768
 s_mul_i32 s43, s45, 72
 v_mfma_f32_16x16x32_bf16 v[124:127], v[76:79], a[108:111], v[124:127]
 s_sub_u32 s44, s44, s43
 v_mul_f32 v84, v192, v192
 v_mul_f32 v85, v193, v193
 v_mfma_f32_16x16x32_bf16 v[124:127], v[16:19], a[124:127], v[124:127]
 ds_read_b64_tr_b16 v[58:59], v7 offset:33280
 s_lshl_b32 s44, s44, 7
 v_mfma_f32_16x16x32_bf16 v[124:127], v[20:23], a[140:143], v[124:127]
 s_mul_i32 s45, s45, 294912
 s_waitcnt lgkmcnt(12)
 v_add_u32 v7, 36864, v7
 v_mfma_f32_16x16x32_bf16 v[128:131], v[24:27], a[0:3], 0
 ds_read_b64_tr_b16 v[60:61], v7 offset:0
 s_add_u32 s44, s44, s45
 v_mfma_f32_16x16x32_bf16 v[128:131], v[28:31], a[16:19], v[128:131]
 s_mul_i32 s45, s88, 1327104
 v_mul_f32 v86, v194, v194
 v_mul_f32 v87, v195, v195
 v_mfma_f32_16x16x32_bf16 v[128:131], v[32:35], a[32:35], v[128:131]
 ds_read_b64_tr_b16 v[62:63], v7 offset:512
 s_waitcnt lgkmcnt(8)
 v_mfma_f32_16x16x32_bf16 v[128:131], v[36:39], a[48:51], v[128:131]
 s_add_u32 s44, s44, s45
 v_fma_f32 v84, v84, s30, v9
 v_fma_f32 v85, v85, s30, v9
 v_mfma_f32_16x16x32_bf16 v[128:131], v[40:43], a[64:67], v[128:131]
 ds_read_b64_tr_b16 v[64:65], v7 offset:4096
 v_fma_f32 v86, v86, s30, v9
 v_mfma_f32_16x16x32_bf16 v[128:131], v[44:47], a[80:83], v[128:131]
 buffer_load_dword v8, v5, s[16:19], s44 offen
 s_waitcnt lgkmcnt(3)
 v_mfma_f32_16x16x32_bf16 v[128:131], v[48:51], a[96:99], v[128:131]
 ds_read_b64_tr_b16 v[66:67], v7 offset:4608
 v_fma_f32 v87, v87, s30, v9
 v_mfma_f32_16x16x32_bf16 v[128:131], v[52:55], a[112:115], v[128:131]
 buffer_store_dwordx4 v[92:95], v1, s[12:15], s37 offen sc1
 v_mfma_f32_16x16x32_bf16 v[128:131], v[56:59], a[128:131], v[128:131]
 ds_read_b64_tr_b16 v[68:69], v7 offset:8192
 v_mul_f32 v84, v84, v192
 v_mfma_f32_16x16x32_bf16 v[132:135], v[24:27], a[4:7], 0
 v_exp_f32 v84, v84
 v_mfma_f32_16x16x32_bf16 v[132:135], v[28:31], a[20:23], v[132:135]
 ds_read_b64_tr_b16 v[70:71], v7 offset:8704
 v_mul_f32 v85, v85, v193
 v_mfma_f32_16x16x32_bf16 v[132:135], v[32:35], a[36:39], v[132:135]
 v_exp_f32 v85, v85
 v_mfma_f32_16x16x32_bf16 v[132:135], v[36:39], a[52:55], v[132:135]
 ds_read_b64_tr_b16 v[72:73], v7 offset:12288
 v_mul_f32 v86, v86, v194
 v_mfma_f32_16x16x32_bf16 v[132:135], v[40:43], a[68:71], v[132:135]
 v_exp_f32 v86, v86
 v_mfma_f32_16x16x32_bf16 v[132:135], v[44:47], a[84:87], v[132:135]
 ds_read_b64_tr_b16 v[74:75], v7 offset:12800
 v_mul_f32 v87, v87, v195
 v_mfma_f32_16x16x32_bf16 v[132:135], v[48:51], a[100:103], v[132:135]
 v_exp_f32 v87, v87
 v_mfma_f32_16x16x32_bf16 v[132:135], v[52:55], a[116:119], v[132:135]
 ds_read_b64_tr_b16 v[76:77], v7 offset:16384
 v_mul_f32 v208, v192, v208
 v_mfma_f32_16x16x32_bf16 v[132:135], v[56:59], a[132:135], v[132:135]
 v_mul_f32 v209, v193, v209
 v_mul_f32 v210, v194, v210
 v_mfma_f32_16x16x32_bf16 v[136:139], v[24:27], a[8:11], 0
 ds_read_b64_tr_b16 v[78:79], v7 offset:16896
 v_mul_f32 v211, v195, v211
 v_mfma_f32_16x16x32_bf16 v[136:139], v[28:31], a[24:27], v[136:139]
 v_add_f32 v84, 1.0, v84
 v_add_f32 v85, 1.0, v85
 v_mfma_f32_16x16x32_bf16 v[136:139], v[32:35], a[40:43], v[136:139]
 ds_read_b64_tr_b16 v[16:17], v7 offset:20480
 v_add_f32 v86, 1.0, v86
 v_mfma_f32_16x16x32_bf16 v[136:139], v[36:39], a[56:59], v[136:139]
 s_add_u32 s36, s26, 1024
 v_rcp_f32 v84, v84
 v_mfma_f32_16x16x32_bf16 v[136:139], v[40:43], a[72:75], v[136:139]
 ds_read_b64_tr_b16 v[18:19], v7 offset:20992
 v_add_f32 v87, 1.0, v87
 v_mfma_f32_16x16x32_bf16 v[136:139], v[44:47], a[88:91], v[136:139]
 v_rcp_f32 v85, v85
 v_mfma_f32_16x16x32_bf16 v[136:139], v[48:51], a[104:107], v[136:139]
 ds_read_b64_tr_b16 v[20:21], v7 offset:24576
 v_mul_f32 v208, v208, v84
 v_mfma_f32_16x16x32_bf16 v[136:139], v[52:55], a[120:123], v[136:139]
 v_rcp_f32 v86, v86
 v_mfma_f32_16x16x32_bf16 v[136:139], v[56:59], a[136:139], v[136:139]
 ds_read_b64_tr_b16 v[22:23], v7 offset:25088
 v_mul_f32 v209, v209, v85
 v_mfma_f32_16x16x32_bf16 v[140:143], v[24:27], a[12:15], 0
 v_rcp_f32 v87, v87
 v_mfma_f32_16x16x32_bf16 v[140:143], v[28:31], a[28:31], v[140:143]
 ds_read_b64_tr_b16 v[24:25], v7 offset:28672
 v_mul_f32 v210, v210, v86
 v_mfma_f32_16x16x32_bf16 v[140:143], v[32:35], a[44:47], v[140:143]
 v_mul_f32 v211, v211, v87
 v_cvt_pk_bf16_f32 v90, v208, v209
 v_mfma_f32_16x16x32_bf16 v[140:143], v[36:39], a[60:63], v[140:143]
 ds_read_b64_tr_b16 v[26:27], v7 offset:29184
 v_cvt_pk_bf16_f32 v91, v210, v211
 v_mfma_f32_16x16x32_bf16 v[140:143], v[40:43], a[76:79], v[140:143]
 buffer_store_dwordx4 v[88:91], v1, s[12:15], s36 offen sc1
 v_mfma_f32_16x16x32_bf16 v[140:143], v[44:47], a[92:95], v[140:143]
 ds_read_b64_tr_b16 v[28:29], v7 offset:32768
 v_mul_f32 v80, v164, v164
 v_mfma_f32_16x16x32_bf16 v[140:143], v[48:51], a[108:111], v[140:143]
 v_mul_f32 v81, v165, v165
 v_mul_f32 v82, v166, v166
 v_mfma_f32_16x16x32_bf16 v[140:143], v[52:55], a[124:127], v[140:143]
 ds_read_b64_tr_b16 v[30:31], v7 offset:33280
 v_mul_f32 v83, v167, v167
 v_mfma_f32_16x16x32_bf16 v[140:143], v[56:59], a[140:143], v[140:143]
 s_waitcnt lgkmcnt(12)
 v_add_u32 v7, 36864, v7
 v_fma_f32 v80, v80, s30, v9
 v_mfma_f32_16x16x32_bf16 v[144:147], v[60:63], a[0:3], 0
 v_fma_f32 v81, v81, s30, v9
 v_fma_f32 v82, v82, s30, v9
 v_mfma_f32_16x16x32_bf16 v[144:147], v[64:67], a[16:19], v[144:147]
 v_fma_f32 v83, v83, s30, v9
 v_mul_f32 v80, v80, v164
 v_mfma_f32_16x16x32_bf16 v[144:147], v[68:71], a[32:35], v[144:147]
 s_waitcnt lgkmcnt(6)
 s_waitcnt lgkmcnt(0)
 s_waitcnt vmcnt(3)
 s_barrier
 v_mfma_f32_16x16x32_bf16 v[144:147], v[72:75], a[48:51], v[144:147]
 ds_read_b64_tr_b16 v[32:33], v6 offset:0
 v_mul_f32 v81, v81, v165
 v_mfma_f32_16x16x32_bf16 v[144:147], v[76:79], a[64:67], v[144:147]
 ds_read_b64_tr_b16 v[34:35], v6 offset:512
 v_mul_f32 v82, v82, v166
 v_mfma_f32_16x16x32_bf16 v[144:147], v[16:19], a[80:83], v[144:147]
 v_exp_f32 v80, v80
 v_mfma_f32_16x16x32_bf16 v[144:147], v[20:23], a[96:99], v[144:147]
 ds_read_b64_tr_b16 v[36:37], v6 offset:4096
 v_mul_f32 v83, v83, v167
 v_mfma_f32_16x16x32_bf16 v[144:147], v[24:27], a[112:115], v[144:147]
 v_exp_f32 v81, v81
 v_mfma_f32_16x16x32_bf16 v[144:147], v[28:31], a[128:131], v[144:147]
 ds_read_b64_tr_b16 v[38:39], v6 offset:4608
 v_mul_f32 v180, v164, v180
 v_mfma_f32_16x16x32_bf16 v[148:151], v[60:63], a[4:7], 0
 v_exp_f32 v82, v82
 v_mfma_f32_16x16x32_bf16 v[148:151], v[64:67], a[20:23], v[148:151]
 ds_read_b64_tr_b16 v[40:41], v6 offset:8192
 v_mul_f32 v181, v165, v181
 v_mfma_f32_16x16x32_bf16 v[148:151], v[68:71], a[36:39], v[148:151]
 ds_read_b64_tr_b16 v[42:43], v6 offset:8704
 v_mul_f32 v182, v166, v182
 v_mfma_f32_16x16x32_bf16 v[148:151], v[72:75], a[52:55], v[148:151]
 v_exp_f32 v83, v83
 v_mfma_f32_16x16x32_bf16 v[148:151], v[76:79], a[68:71], v[148:151]
 ds_read_b64_tr_b16 v[44:45], v6 offset:12288
 v_mul_f32 v183, v167, v183
 v_mfma_f32_16x16x32_bf16 v[148:151], v[16:19], a[84:87], v[148:151]
 v_add_f32 v80, 1.0, v80
 v_add_f32 v81, 1.0, v81
 v_mfma_f32_16x16x32_bf16 v[148:151], v[20:23], a[100:103], v[148:151]
 ds_read_b64_tr_b16 v[46:47], v6 offset:12800
 v_add_f32 v82, 1.0, v82
 v_mfma_f32_16x16x32_bf16 v[148:151], v[24:27], a[116:119], v[148:151]
 v_rcp_f32 v80, v80
 v_mfma_f32_16x16x32_bf16 v[148:151], v[28:31], a[132:135], v[148:151]
 ds_read_b64_tr_b16 v[48:49], v6 offset:16384
 v_add_f32 v83, 1.0, v83
 v_mfma_f32_16x16x32_bf16 v[152:155], v[60:63], a[8:11], 0
 v_rcp_f32 v81, v81
 v_mfma_f32_16x16x32_bf16 v[152:155], v[64:67], a[24:27], v[152:155]
 ds_read_b64_tr_b16 v[50:51], v6 offset:16896
 v_mul_f32 v180, v180, v80
 v_mfma_f32_16x16x32_bf16 v[152:155], v[68:71], a[40:43], v[152:155]
 ds_read_b64_tr_b16 v[52:53], v6 offset:20480
 v_mul_f32 v181, v181, v81
 v_mfma_f32_16x16x32_bf16 v[152:155], v[72:75], a[56:59], v[152:155]
 v_rcp_f32 v82, v82
 v_mfma_f32_16x16x32_bf16 v[152:155], v[76:79], a[72:75], v[152:155]
 ds_read_b64_tr_b16 v[54:55], v6 offset:20992
 v_mul_f32 v182, v182, v82
 v_mfma_f32_16x16x32_bf16 v[152:155], v[16:19], a[88:91], v[152:155]
 v_rcp_f32 v83, v83
 v_mfma_f32_16x16x32_bf16 v[152:155], v[20:23], a[104:107], v[152:155]
 ds_read_b64_tr_b16 v[56:57], v6 offset:24576
 v_mul_f32 v183, v183, v83
 v_mfma_f32_16x16x32_bf16 v[152:155], v[24:27], a[120:123], v[152:155]
 v_cvt_pk_bf16_f32 v92, v180, v181
 v_cvt_pk_bf16_f32 v93, v182, v183
 v_mfma_f32_16x16x32_bf16 v[152:155], v[28:31], a[136:139], v[152:155]
 ds_read_b64_tr_b16 v[58:59], v6 offset:25088
 v_mul_f32 v84, v196, v196
 v_mfma_f32_16x16x32_bf16 v[156:159], v[60:63], a[12:15], 0
 v_mul_f32 v85, v197, v197
 v_mul_f32 v86, v198, v198
 v_mfma_f32_16x16x32_bf16 v[156:159], v[64:67], a[28:31], v[156:159]
 ds_read_b64_tr_b16 v[60:61], v6 offset:28672
 v_mul_f32 v87, v199, v199
 v_mfma_f32_16x16x32_bf16 v[156:159], v[68:71], a[44:47], v[156:159]
 ds_read_b64_tr_b16 v[62:63], v6 offset:29184
 v_fma_f32 v84, v84, s30, v9
 v_mfma_f32_16x16x32_bf16 v[156:159], v[72:75], a[60:63], v[156:159]
 v_fma_f32 v85, v85, s30, v9
 v_fma_f32 v86, v86, s30, v9
 v_mfma_f32_16x16x32_bf16 v[156:159], v[76:79], a[76:79], v[156:159]
 ds_read_b64_tr_b16 v[64:65], v6 offset:32768
 v_fma_f32 v87, v87, s30, v9
 v_mfma_f32_16x16x32_bf16 v[156:159], v[16:19], a[92:95], v[156:159]
 v_mul_f32 v84, v84, v196
 v_mul_f32 v85, v85, v197
 v_mfma_f32_16x16x32_bf16 v[156:159], v[20:23], a[108:111], v[156:159]
 ds_read_b64_tr_b16 v[66:67], v6 offset:33280
 v_mul_f32 v86, v86, v198
 v_mfma_f32_16x16x32_bf16 v[156:159], v[24:27], a[124:127], v[156:159]
 v_exp_f32 v84, v84
 v_mfma_f32_16x16x32_bf16 v[156:159], v[28:31], a[140:143], v[156:159]
 s_waitcnt lgkmcnt(12)
 v_add_u32 v6, 36864, v6
 v_mul_f32 v87, v87, v199
 v_mfma_f32_16x16x32_bf16 v[96:99], v[32:35], a[144:147], v[96:99]
 ds_read_b64_tr_b16 v[68:69], v6 offset:0
 v_mul_f32 v212, v196, v212
 v_mfma_f32_16x16x32_bf16 v[96:99], v[36:39], a[160:163], v[96:99]
 v_exp_f32 v85, v85
 v_mfma_f32_16x16x32_bf16 v[96:99], v[40:43], a[176:179], v[96:99]
 ds_read_b64_tr_b16 v[70:71], v6 offset:512
 s_waitcnt lgkmcnt(8)
 v_mfma_f32_16x16x32_bf16 v[96:99], v[44:47], a[192:195], v[96:99]
 v_exp_f32 v86, v86
 v_mfma_f32_16x16x32_bf16 v[96:99], v[48:51], a[208:211], v[96:99]
 ds_read_b64_tr_b16 v[72:73], v6 offset:4096
 v_mul_f32 v213, v197, v213
 v_mfma_f32_16x16x32_bf16 v[96:99], v[52:55], a[224:227], v[96:99]
 s_waitcnt lgkmcnt(3)
 v_exp_f32 v87, v87
 v_mfma_f32_16x16x32_bf16 v[96:99], v[56:59], a[240:243], v[96:99]
 ds_read_b64_tr_b16 v[74:75], v6 offset:4608
 v_mul_f32 v214, v198, v214
 v_mfma_f32_16x16x32_bf16 v[96:99], v[60:63], v[224:227], v[96:99]
 v_mul_f32 v215, v199, v215
 v_add_f32 v84, 1.0, v84
 v_mfma_f32_16x16x32_bf16 v[96:99], v[64:67], v[240:243], v[96:99]
 ds_read_b64_tr_b16 v[76:77], v6 offset:8192
 v_add_f32 v85, 1.0, v85
 v_mfma_f32_16x16x32_bf16 v[100:103], v[32:35], a[148:151], v[100:103]
 s_add_u32 s37, s26, 148480
 v_rcp_f32 v84, v84
 v_mfma_f32_16x16x32_bf16 v[100:103], v[36:39], a[164:167], v[100:103]
 ds_read_b64_tr_b16 v[78:79], v6 offset:8704
 v_add_f32 v86, 1.0, v86
 v_mfma_f32_16x16x32_bf16 v[100:103], v[40:43], a[180:183], v[100:103]
 v_rcp_f32 v85, v85
 v_mfma_f32_16x16x32_bf16 v[100:103], v[44:47], a[196:199], v[100:103]
 ds_read_b64_tr_b16 v[16:17], v6 offset:12288
 v_add_f32 v87, 1.0, v87
 v_mfma_f32_16x16x32_bf16 v[100:103], v[48:51], a[212:215], v[100:103]
 v_rcp_f32 v86, v86
 v_mfma_f32_16x16x32_bf16 v[100:103], v[52:55], a[228:231], v[100:103]
 ds_read_b64_tr_b16 v[18:19], v6 offset:12800
 v_mul_f32 v212, v212, v84
 v_mfma_f32_16x16x32_bf16 v[100:103], v[56:59], a[244:247], v[100:103]
 v_rcp_f32 v87, v87
 v_mfma_f32_16x16x32_bf16 v[100:103], v[60:63], v[228:231], v[100:103]
 ds_read_b64_tr_b16 v[20:21], v6 offset:16384
 v_mul_f32 v213, v213, v85
 v_mfma_f32_16x16x32_bf16 v[100:103], v[64:67], v[244:247], v[100:103]
 v_mul_f32 v214, v214, v86
 v_mul_f32 v215, v215, v87
 v_mfma_f32_16x16x32_bf16 v[104:107], v[32:35], a[152:155], v[104:107]
 ds_read_b64_tr_b16 v[22:23], v6 offset:16896
 v_cvt_pk_bf16_f32 v94, v212, v213
 v_mfma_f32_16x16x32_bf16 v[104:107], v[36:39], a[168:171], v[104:107]
 v_cvt_pk_bf16_f32 v95, v214, v215
 v_mul_f32 v80, v168, v168
 v_mfma_f32_16x16x32_bf16 v[104:107], v[40:43], a[184:187], v[104:107]
 ds_read_b64_tr_b16 v[24:25], v6 offset:20480
 v_mul_f32 v81, v169, v169
 v_mfma_f32_16x16x32_bf16 v[104:107], v[44:47], a[200:203], v[104:107]
 buffer_store_dwordx4 v[92:95], v1, s[12:15], s37 offen sc1
 v_mfma_f32_16x16x32_bf16 v[104:107], v[48:51], a[216:219], v[104:107]
 ds_read_b64_tr_b16 v[26:27], v6 offset:20992
 v_mul_f32 v82, v170, v170
 v_mfma_f32_16x16x32_bf16 v[104:107], v[52:55], a[232:235], v[104:107]
 v_mul_f32 v83, v171, v171
 v_fma_f32 v80, v80, s30, v9
 v_mfma_f32_16x16x32_bf16 v[104:107], v[56:59], a[248:251], v[104:107]
 ds_read_b64_tr_b16 v[28:29], v6 offset:24576
 v_fma_f32 v81, v81, s30, v9
 v_mfma_f32_16x16x32_bf16 v[104:107], v[60:63], v[232:235], v[104:107]
 v_fma_f32 v82, v82, s30, v9
 v_fma_f32 v83, v83, s30, v9
 v_mfma_f32_16x16x32_bf16 v[104:107], v[64:67], v[248:251], v[104:107]
 ds_read_b64_tr_b16 v[30:31], v6 offset:25088
 v_mul_f32 v80, v80, v168
 v_mfma_f32_16x16x32_bf16 v[108:111], v[32:35], a[156:159], v[108:111]
 v_exp_f32 v80, v80
 v_mfma_f32_16x16x32_bf16 v[108:111], v[36:39], a[172:175], v[108:111]
 ds_read_b64_tr_b16 v[32:33], v6 offset:28672
 v_mul_f32 v81, v81, v169
 v_mfma_f32_16x16x32_bf16 v[108:111], v[40:43], a[188:191], v[108:111]
 v_exp_f32 v81, v81
 v_mfma_f32_16x16x32_bf16 v[108:111], v[44:47], a[204:207], v[108:111]
 ds_read_b64_tr_b16 v[34:35], v6 offset:29184
 v_mul_f32 v82, v82, v170
 v_mfma_f32_16x16x32_bf16 v[108:111], v[48:51], a[220:223], v[108:111]
 v_exp_f32 v82, v82
 v_mfma_f32_16x16x32_bf16 v[108:111], v[52:55], a[236:239], v[108:111]
 ds_read_b64_tr_b16 v[36:37], v6 offset:32768
 v_mul_f32 v83, v83, v171
 v_mfma_f32_16x16x32_bf16 v[108:111], v[56:59], a[252:255], v[108:111]
 v_exp_f32 v83, v83
 v_mfma_f32_16x16x32_bf16 v[108:111], v[60:63], v[236:239], v[108:111]
 ds_read_b64_tr_b16 v[38:39], v6 offset:33280
 v_mul_f32 v184, v168, v184
 v_mfma_f32_16x16x32_bf16 v[108:111], v[64:67], v[252:255], v[108:111]
 s_waitcnt lgkmcnt(12)
 v_mul_f32 v185, v169, v185
 v_mul_f32 v186, v170, v186
 v_mfma_f32_16x16x32_bf16 v[112:115], v[68:71], a[144:147], v[112:115]
 ds_read_b64_tr_b16 v[40:41], v7 offset:0
 v_mul_f32 v187, v171, v187
 v_mfma_f32_16x16x32_bf16 v[112:115], v[72:75], a[160:163], v[112:115]
 v_add_f32 v80, 1.0, v80
 v_add_f32 v81, 1.0, v81
 v_mfma_f32_16x16x32_bf16 v[112:115], v[76:79], a[176:179], v[112:115]
 ds_read_b64_tr_b16 v[42:43], v7 offset:512
 s_waitcnt lgkmcnt(8)
 v_mfma_f32_16x16x32_bf16 v[112:115], v[16:19], a[192:195], v[112:115]
 v_rcp_f32 v80, v80
 v_mfma_f32_16x16x32_bf16 v[112:115], v[20:23], a[208:211], v[112:115]
 ds_read_b64_tr_b16 v[44:45], v7 offset:4096
 v_subrev_u32 v6, 110592, v6
 v_mfma_f32_16x16x32_bf16 v[112:115], v[24:27], a[224:227], v[112:115]
 s_waitcnt lgkmcnt(3)
 v_xor_b32 v6, 64, v6
 v_add_f32 v82, 1.0, v82
 v_mfma_f32_16x16x32_bf16 v[112:115], v[28:31], a[240:243], v[112:115]
 ds_read_b64_tr_b16 v[46:47], v7 offset:4608
 v_add_f32 v83, 1.0, v83
 v_mfma_f32_16x16x32_bf16 v[112:115], v[32:35], v[224:227], v[112:115]
 v_rcp_f32 v81, v81
 v_mfma_f32_16x16x32_bf16 v[112:115], v[36:39], v[240:243], v[112:115]
 ds_read_b64_tr_b16 v[48:49], v7 offset:8192
 v_mul_f32 v184, v184, v80
 v_mfma_f32_16x16x32_bf16 v[116:119], v[68:71], a[148:151], v[116:119]
 v_rcp_f32 v82, v82
 v_mfma_f32_16x16x32_bf16 v[116:119], v[72:75], a[164:167], v[116:119]
 ds_read_b64_tr_b16 v[50:51], v7 offset:8704
 v_mul_f32 v185, v185, v81
 v_mfma_f32_16x16x32_bf16 v[116:119], v[76:79], a[180:183], v[116:119]
 v_rcp_f32 v83, v83
 v_mfma_f32_16x16x32_bf16 v[116:119], v[16:19], a[196:199], v[116:119]
 ds_read_b64_tr_b16 v[52:53], v7 offset:12288
 v_mul_f32 v186, v186, v82
 v_mfma_f32_16x16x32_bf16 v[116:119], v[20:23], a[212:215], v[116:119]
 v_mul_f32 v187, v187, v83
 v_cvt_pk_bf16_f32 v88, v184, v185
 v_mfma_f32_16x16x32_bf16 v[116:119], v[24:27], a[228:231], v[116:119]
 ds_read_b64_tr_b16 v[54:55], v7 offset:12800
 v_cvt_pk_bf16_f32 v89, v186, v187
 v_mfma_f32_16x16x32_bf16 v[116:119], v[28:31], a[244:247], v[116:119]
 v_mul_f32 v84, v200, v200
 v_mul_f32 v85, v201, v201
 v_mfma_f32_16x16x32_bf16 v[116:119], v[32:35], v[228:231], v[116:119]
 ds_read_b64_tr_b16 v[56:57], v7 offset:16384
 v_mul_f32 v86, v202, v202
 v_mfma_f32_16x16x32_bf16 v[116:119], v[36:39], v[244:247], v[116:119]
 v_mul_f32 v87, v203, v203
 v_fma_f32 v84, v84, s30, v9
 v_mfma_f32_16x16x32_bf16 v[120:123], v[68:71], a[152:155], v[120:123]
 ds_read_b64_tr_b16 v[58:59], v7 offset:16896
 v_fma_f32 v85, v85, s30, v9
 v_mfma_f32_16x16x32_bf16 v[120:123], v[72:75], a[168:171], v[120:123]
 v_fma_f32 v86, v86, s30, v9
 v_fma_f32 v87, v87, s30, v9
 v_mfma_f32_16x16x32_bf16 v[120:123], v[76:79], a[184:187], v[120:123]
 ds_read_b64_tr_b16 v[60:61], v7 offset:20480
 v_mul_f32 v84, v84, v200
 v_mfma_f32_16x16x32_bf16 v[120:123], v[16:19], a[200:203], v[120:123]
 v_exp_f32 v84, v84
 v_mfma_f32_16x16x32_bf16 v[120:123], v[20:23], a[216:219], v[120:123]
 ds_read_b64_tr_b16 v[62:63], v7 offset:20992
 v_mul_f32 v85, v85, v201
 v_mfma_f32_16x16x32_bf16 v[120:123], v[24:27], a[232:235], v[120:123]
 v_exp_f32 v85, v85
 v_mfma_f32_16x16x32_bf16 v[120:123], v[28:31], a[248:251], v[120:123]
 ds_read_b64_tr_b16 v[64:65], v7 offset:24576
 s_lshr_b32 s44, s2, 3
 v_mfma_f32_16x16x32_bf16 v[120:123], v[32:35], v[232:235], v[120:123]
 s_lshl_b32 s44, s44, 2
 v_mul_f32 v86, v86, v202
 v_mul_f32 v87, v87, v203
 v_mfma_f32_16x16x32_bf16 v[120:123], v[36:39], v[248:251], v[120:123]
 ds_read_b64_tr_b16 v[66:67], v7 offset:25088
 s_add_u32 s44, s44, s20
 v_mfma_f32_16x16x32_bf16 v[124:127], v[68:71], a[156:159], v[124:127]
 s_mul_i32 s44, s44, 3
 v_exp_f32 v86, v86
 v_mfma_f32_16x16x32_bf16 v[124:127], v[72:75], a[172:175], v[124:127]
 ds_read_b64_tr_b16 v[68:69], v7 offset:28672
 s_add_u32 s44, s44, 1
 v_mfma_f32_16x16x32_bf16 v[124:127], v[76:79], a[188:191], v[124:127]
 s_mul_i32 s45, s44, 911
 v_exp_f32 v87, v87
 v_mfma_f32_16x16x32_bf16 v[124:127], v[16:19], a[204:207], v[124:127]
 ds_read_b64_tr_b16 v[70:71], v7 offset:29184
 s_lshr_b32 s45, s45, 16
 v_mfma_f32_16x16x32_bf16 v[124:127], v[20:23], a[220:223], v[124:127]
 s_mul_i32 s43, s45, 72
 v_mul_f32 v216, v200, v216
 v_mul_f32 v217, v201, v217
 v_mfma_f32_16x16x32_bf16 v[124:127], v[24:27], a[236:239], v[124:127]
 ds_read_b64_tr_b16 v[72:73], v7 offset:32768
 s_sub_u32 s44, s44, s43
 v_mfma_f32_16x16x32_bf16 v[124:127], v[28:31], a[252:255], v[124:127]
 s_lshl_b32 s44, s44, 7
 v_mul_f32 v218, v202, v218
 v_mul_f32 v219, v203, v219
 v_mfma_f32_16x16x32_bf16 v[124:127], v[32:35], v[236:239], v[124:127]
 ds_read_b64_tr_b16 v[74:75], v7 offset:33280
 s_mul_i32 s45, s45, 294912
 v_mfma_f32_16x16x32_bf16 v[124:127], v[36:39], v[252:255], v[124:127]
 s_add_u32 s44, s44, s45
 s_waitcnt lgkmcnt(12)
 v_add_u32 v7, 36864, v7
 v_mfma_f32_16x16x32_bf16 v[128:131], v[40:43], a[144:147], v[128:131]
 ds_read_b64_tr_b16 v[76:77], v7 offset:0
 s_mul_i32 s45, s88, 1327104
 v_mfma_f32_16x16x32_bf16 v[128:131], v[44:47], a[160:163], v[128:131]
 s_add_u32 s44, s44, s45
 v_add_f32 v84, 1.0, v84
 v_add_f32 v85, 1.0, v85
 v_mfma_f32_16x16x32_bf16 v[128:131], v[48:51], a[176:179], v[128:131]
 ds_read_b64_tr_b16 v[78:79], v7 offset:512
 s_waitcnt lgkmcnt(8)
 v_mfma_f32_16x16x32_bf16 v[128:131], v[52:55], a[192:195], v[128:131]
 buffer_load_dword v8, v5, s[16:19], s44 offen
 v_add_f32 v86, 1.0, v86
 v_mfma_f32_16x16x32_bf16 v[128:131], v[56:59], a[208:211], v[128:131]
 ds_read_b64_tr_b16 v[16:17], v7 offset:4096
 v_add_f32 v87, 1.0, v87
 v_mfma_f32_16x16x32_bf16 v[128:131], v[60:63], a[224:227], v[128:131]
 s_waitcnt lgkmcnt(3)
 s_add_u32 s36, s26, 295936
 v_mul_f32 v80, v172, v172
 v_mfma_f32_16x16x32_bf16 v[128:131], v[64:67], a[240:243], v[128:131]
 ds_read_b64_tr_b16 v[18:19], v7 offset:4608
 v_mul_f32 v81, v173, v173
 v_mfma_f32_16x16x32_bf16 v[128:131], v[68:71], v[224:227], v[128:131]
 v_rcp_f32 v84, v84
 v_mfma_f32_16x16x32_bf16 v[128:131], v[72:75], v[240:243], v[128:131]
 ds_read_b64_tr_b16 v[20:21], v7 offset:8192
 v_mul_f32 v216, v216, v84
 v_mfma_f32_16x16x32_bf16 v[132:135], v[40:43], a[148:151], v[132:135]
 v_rcp_f32 v85, v85
 v_mfma_f32_16x16x32_bf16 v[132:135], v[44:47], a[164:167], v[132:135]
 ds_read_b64_tr_b16 v[22:23], v7 offset:8704
 v_mul_f32 v217, v217, v85
 v_mfma_f32_16x16x32_bf16 v[132:135], v[48:51], a[180:183], v[132:135]
 v_rcp_f32 v86, v86
 v_mfma_f32_16x16x32_bf16 v[132:135], v[52:55], a[196:199], v[132:135]
 ds_read_b64_tr_b16 v[24:25], v7 offset:12288
 v_mul_f32 v218, v218, v86
 v_mfma_f32_16x16x32_bf16 v[132:135], v[56:59], a[212:215], v[132:135]
 v_rcp_f32 v87, v87
 v_mfma_f32_16x16x32_bf16 v[132:135], v[60:63], a[228:231], v[132:135]
 ds_read_b64_tr_b16 v[26:27], v7 offset:12800
 v_mul_f32 v219, v219, v87
 v_mfma_f32_16x16x32_bf16 v[132:135], v[64:67], a[244:247], v[132:135]
 v_cvt_pk_bf16_f32 v90, v216, v217
 v_cvt_pk_bf16_f32 v91, v218, v219
 v_mfma_f32_16x16x32_bf16 v[132:135], v[68:71], v[228:231], v[132:135]
 ds_read_b64_tr_b16 v[28:29], v7 offset:16384
 v_mul_f32 v82, v174, v174
 v_mfma_f32_16x16x32_bf16 v[132:135], v[72:75], v[244:247], v[132:135]
 buffer_store_dwordx4 v[88:91], v1, s[12:15], s36 offen sc1
 v_mfma_f32_16x16x32_bf16 v[136:139], v[40:43], a[152:155], v[136:139]
 ds_read_b64_tr_b16 v[30:31], v7 offset:16896
 v_mul_f32 v83, v175, v175
 v_mfma_f32_16x16x32_bf16 v[136:139], v[44:47], a[168:171], v[136:139]
 v_fma_f32 v80, v80, s30, v9
 v_fma_f32 v81, v81, s30, v9
 v_mfma_f32_16x16x32_bf16 v[136:139], v[48:51], a[184:187], v[136:139]
 ds_read_b64_tr_b16 v[32:33], v7 offset:20480
 v_fma_f32 v82, v82, s30, v9
 v_mfma_f32_16x16x32_bf16 v[136:139], v[52:55], a[200:203], v[136:139]
 v_fma_f32 v83, v83, s30, v9
 v_mul_f32 v80, v80, v172
 v_mfma_f32_16x16x32_bf16 v[136:139], v[56:59], a[216:219], v[136:139]
 ds_read_b64_tr_b16 v[34:35], v7 offset:20992
 v_mul_f32 v81, v81, v173
 v_mfma_f32_16x16x32_bf16 v[136:139], v[60:63], a[232:235], v[136:139]
 v_exp_f32 v80, v80
 v_mfma_f32_16x16x32_bf16 v[136:139], v[64:67], a[248:251], v[136:139]
 ds_read_b64_tr_b16 v[36:37], v7 offset:24576
 v_mul_f32 v82, v82, v174
 v_mfma_f32_16x16x32_bf16 v[136:139], v[68:71], v[232:235], v[136:139]
 v_exp_f32 v81, v81
 v_mfma_f32_16x16x32_bf16 v[136:139], v[72:75], v[248:251], v[136:139]
 ds_read_b64_tr_b16 v[38:39], v7 offset:25088
 v_mul_f32 v83, v83, v175
 v_mfma_f32_16x16x32_bf16 v[140:143], v[40:43], a[156:159], v[140:143]
 v_exp_f32 v82, v82
 v_mfma_f32_16x16x32_bf16 v[140:143], v[44:47], a[172:175], v[140:143]
 ds_read_b64_tr_b16 v[40:41], v7 offset:28672
 v_mul_f32 v188, v172, v188
 v_mfma_f32_16x16x32_bf16 v[140:143], v[48:51], a[188:191], v[140:143]
 v_exp_f32 v83, v83
 v_mfma_f32_16x16x32_bf16 v[140:143], v[52:55], a[204:207], v[140:143]
 ds_read_b64_tr_b16 v[42:43], v7 offset:29184
 v_mul_f32 v189, v173, v189
 v_mfma_f32_16x16x32_bf16 v[140:143], v[56:59], a[220:223], v[140:143]
 v_mul_f32 v190, v174, v190
 v_mul_f32 v191, v175, v191
 v_mfma_f32_16x16x32_bf16 v[140:143], v[60:63], a[236:239], v[140:143]
 ds_read_b64_tr_b16 v[44:45], v7 offset:32768
 v_add_f32 v80, 1.0, v80
 v_mfma_f32_16x16x32_bf16 v[140:143], v[64:67], a[252:255], v[140:143]
 v_rcp_f32 v80, v80
 v_mfma_f32_16x16x32_bf16 v[140:143], v[68:71], v[236:239], v[140:143]
 ds_read_b64_tr_b16 v[46:47], v7 offset:33280
 v_add_f32 v81, 1.0, v81
 v_mfma_f32_16x16x32_bf16 v[140:143], v[72:75], v[252:255], v[140:143]
 s_waitcnt lgkmcnt(12)
 v_subrev_u32 v7, 110592, v7
 v_add_f32 v82, 1.0, v82
 v_mfma_f32_16x16x32_bf16 v[144:147], v[76:79], a[144:147], v[144:147]
 v_xor_b32 v7, 64, v7
 v_add_f32 v83, 1.0, v83
 v_mfma_f32_16x16x32_bf16 v[144:147], v[16:19], a[160:163], v[144:147]
 v_rcp_f32 v81, v81
 v_mfma_f32_16x16x32_bf16 v[144:147], v[20:23], a[176:179], v[144:147]
 s_waitcnt lgkmcnt(6)
 v_rcp_f32 v82, v82
 v_mfma_f32_16x16x32_bf16 v[144:147], v[24:27], a[192:195], v[144:147]
 ds_read_b64_tr_b16 v[48:49], v6 offset:0
 v_mul_f32 v188, v188, v80
 v_mfma_f32_16x16x32_bf16 v[144:147], v[28:31], a[208:211], v[144:147]
 ds_read_b64_tr_b16 v[50:51], v6 offset:512
 v_mul_f32 v189, v189, v81
 v_mfma_f32_16x16x32_bf16 v[144:147], v[32:35], a[224:227], v[144:147]
 s_waitcnt lgkmcnt(2)
 v_rcp_f32 v83, v83
 v_mfma_f32_16x16x32_bf16 v[144:147], v[36:39], a[240:243], v[144:147]
 ds_read_b64_tr_b16 v[52:53], v6 offset:4096
 v_mul_f32 v190, v190, v82
 v_mfma_f32_16x16x32_bf16 v[144:147], v[40:43], v[224:227], v[144:147]
 v_mul_f32 v191, v191, v83
 v_cvt_pk_bf16_f32 v92, v188, v189
 v_mfma_f32_16x16x32_bf16 v[144:147], v[44:47], v[240:243], v[144:147]
 ds_read_b64_tr_b16 v[54:55], v6 offset:4608
 v_cvt_pk_bf16_f32 v93, v190, v191
 v_mfma_f32_16x16x32_bf16 v[148:151], v[76:79], a[148:151], v[148:151]
 v_mul_f32 v84, v204, v204
 v_mul_f32 v85, v205, v205
 v_mfma_f32_16x16x32_bf16 v[148:151], v[16:19], a[164:167], v[148:151]
 ds_read_b64_tr_b16 v[56:57], v6 offset:8192
 v_mul_f32 v86, v206, v206
 v_mfma_f32_16x16x32_bf16 v[148:151], v[20:23], a[180:183], v[148:151]
 ds_read_b64_tr_b16 v[58:59], v6 offset:8704
 v_mul_f32 v87, v207, v207
 v_mfma_f32_16x16x32_bf16 v[148:151], v[24:27], a[196:199], v[148:151]
 v_fma_f32 v84, v84, s30, v9
 v_fma_f32 v85, v85, s30, v9
 v_mfma_f32_16x16x32_bf16 v[148:151], v[28:31], a[212:215], v[148:151]
 ds_read_b64_tr_b16 v[60:61], v6 offset:12288
 v_fma_f32 v86, v86, s30, v9
 v_mfma_f32_16x16x32_bf16 v[148:151], v[32:35], a[228:231], v[148:151]
 v_fma_f32 v87, v87, s30, v9
 v_mul_f32 v84, v84, v204
 v_mfma_f32_16x16x32_bf16 v[148:151], v[36:39], a[244:247], v[148:151]
 ds_read_b64_tr_b16 v[62:63], v6 offset:12800
 v_mul_f32 v85, v85, v205
 v_mfma_f32_16x16x32_bf16 v[148:151], v[40:43], v[228:231], v[148:151]
 v_exp_f32 v84, v84
 v_mfma_f32_16x16x32_bf16 v[148:151], v[44:47], v[244:247], v[148:151]
 ds_read_b64_tr_b16 v[64:65], v6 offset:16384
 v_mul_f32 v86, v86, v206
 v_mfma_f32_16x16x32_bf16 v[152:155], v[76:79], a[152:155], v[152:155]
 v_exp_f32 v85, v85
 v_mfma_f32_16x16x32_bf16 v[152:155], v[16:19], a[168:171], v[152:155]
 ds_read_b64_tr_b16 v[66:67], v6 offset:16896
 v_mul_f32 v87, v87, v207
 v_mfma_f32_16x16x32_bf16 v[152:155], v[20:23], a[184:187], v[152:155]
 ds_read_b64_tr_b16 v[68:69], v6 offset:20480
 v_mul_f32 v220, v204, v220
 v_mfma_f32_16x16x32_bf16 v[152:155], v[24:27], a[200:203], v[152:155]
 v_exp_f32 v86, v86
 v_mfma_f32_16x16x32_bf16 v[152:155], v[28:31], a[216:219], v[152:155]
 ds_read_b64_tr_b16 v[70:71], v6 offset:20992
 v_mul_f32 v221, v205, v221
 v_mfma_f32_16x16x32_bf16 v[152:155], v[32:35], a[232:235], v[152:155]
 v_exp_f32 v87, v87
 v_mfma_f32_16x16x32_bf16 v[152:155], v[36:39], a[248:251], v[152:155]
 ds_read_b64_tr_b16 v[72:73], v6 offset:24576
 v_mul_f32 v222, v206, v222
 v_mfma_f32_16x16x32_bf16 v[152:155], v[40:43], v[232:235], v[152:155]
 v_mul_f32 v223, v207, v223
 v_add_f32 v84, 1.0, v84
 v_mfma_f32_16x16x32_bf16 v[152:155], v[44:47], v[248:251], v[152:155]
 ds_read_b64_tr_b16 v[74:75], v6 offset:25088
 v_add_f32 v85, 1.0, v85
 v_mfma_f32_16x16x32_bf16 v[156:159], v[76:79], a[156:159], v[156:159]
 s_add_u32 s37, s26, 443392
 v_rcp_f32 v84, v84
 v_mfma_f32_16x16x32_bf16 v[156:159], v[16:19], a[172:175], v[156:159]
 ds_read_b64_tr_b16 v[76:77], v6 offset:28672
 v_add_f32 v86, 1.0, v86
 v_mfma_f32_16x16x32_bf16 v[156:159], v[20:23], a[188:191], v[156:159]
 ds_read_b64_tr_b16 v[78:79], v6 offset:29184
 v_add_f32 v87, 1.0, v87
 v_mfma_f32_16x16x32_bf16 v[156:159], v[24:27], a[204:207], v[156:159]
 v_rcp_f32 v85, v85
 v_mfma_f32_16x16x32_bf16 v[156:159], v[28:31], a[220:223], v[156:159]
 ds_read_b64_tr_b16 v[16:17], v6 offset:32768
 v_mul_f32 v220, v220, v84
 v_mfma_f32_16x16x32_bf16 v[156:159], v[32:35], a[236:239], v[156:159]
 v_rcp_f32 v86, v86
 v_mfma_f32_16x16x32_bf16 v[156:159], v[36:39], a[252:255], v[156:159]
 ds_read_b64_tr_b16 v[18:19], v6 offset:33280
 v_mul_f32 v221, v221, v85
 v_mfma_f32_16x16x32_bf16 v[156:159], v[40:43], v[236:239], v[156:159]
 v_rcp_f32 v87, v87
 v_mfma_f32_16x16x32_bf16 v[156:159], v[44:47], v[252:255], v[156:159]
 s_waitcnt lgkmcnt(12)
 v_add_u32 v6, 36864, v6
 v_mul_f32 v222, v222, v86
 v_mfma_f32_16x16x32_bf16 v[160:163], v[48:51], a[0:3], 0
 ds_read_b64_tr_b16 v[20:21], v6 offset:0
 v_mul_f32 v223, v223, v87
 v_mfma_f32_16x16x32_bf16 v[160:163], v[52:55], a[16:19], v[160:163]
 v_cvt_pk_bf16_f32 v94, v220, v221
 v_cvt_pk_bf16_f32 v95, v222, v223
 v_mfma_f32_16x16x32_bf16 v[160:163], v[56:59], a[32:35], v[160:163]
 ds_read_b64_tr_b16 v[22:23], v6 offset:512
 s_waitcnt lgkmcnt(8)
 v_mfma_f32_16x16x32_bf16 v[160:163], v[60:63], a[48:51], v[160:163]
 buffer_store_dwordx4 v[92:95], v1, s[12:15], s37 offen sc1
 v_mfma_f32_16x16x32_bf16 v[160:163], v[64:67], a[64:67], v[160:163]
 ds_read_b64_tr_b16 v[24:25], v6 offset:4096
 v_mul_f32 v80, v96, v96
 v_mfma_f32_16x16x32_bf16 v[160:163], v[68:71], a[80:83], v[160:163]
 s_waitcnt lgkmcnt(3)
 v_mul_f32 v81, v97, v97
 v_mul_f32 v82, v98, v98
 v_mfma_f32_16x16x32_bf16 v[160:163], v[72:75], a[96:99], v[160:163]
 ds_read_b64_tr_b16 v[26:27], v6 offset:4608
 v_mul_f32 v83, v99, v99
 v_mfma_f32_16x16x32_bf16 v[160:163], v[76:79], a[112:115], v[160:163]
 v_fma_f32 v80, v80, s30, v9
 v_fma_f32 v81, v81, s30, v9
 v_mfma_f32_16x16x32_bf16 v[160:163], v[16:19], a[128:131], v[160:163]
 ds_read_b64_tr_b16 v[28:29], v6 offset:8192
 v_fma_f32 v82, v82, s30, v9
 v_mfma_f32_16x16x32_bf16 v[164:167], v[48:51], a[4:7], 0
 v_fma_f32 v83, v83, s30, v9
 v_mul_f32 v80, v80, v96
 v_mfma_f32_16x16x32_bf16 v[164:167], v[52:55], a[20:23], v[164:167]
 ds_read_b64_tr_b16 v[30:31], v6 offset:8704
 v_mul_f32 v81, v81, v97
 v_mfma_f32_16x16x32_bf16 v[164:167], v[56:59], a[36:39], v[164:167]
 v_exp_f32 v80, v80
 v_mfma_f32_16x16x32_bf16 v[164:167], v[60:63], a[52:55], v[164:167]
 ds_read_b64_tr_b16 v[32:33], v6 offset:12288
 v_mul_f32 v82, v82, v98
 v_mfma_f32_16x16x32_bf16 v[164:167], v[64:67], a[68:71], v[164:167]
 v_exp_f32 v81, v81
 v_mfma_f32_16x16x32_bf16 v[164:167], v[68:71], a[84:87], v[164:167]
 ds_read_b64_tr_b16 v[34:35], v6 offset:12800
 v_mul_f32 v83, v83, v99
 v_mfma_f32_16x16x32_bf16 v[164:167], v[72:75], a[100:103], v[164:167]
 v_exp_f32 v82, v82
 v_mfma_f32_16x16x32_bf16 v[164:167], v[76:79], a[116:119], v[164:167]
 ds_read_b64_tr_b16 v[36:37], v6 offset:16384
 v_mul_f32 v112, v96, v112
 v_mfma_f32_16x16x32_bf16 v[164:167], v[16:19], a[132:135], v[164:167]
 v_exp_f32 v83, v83
 v_mfma_f32_16x16x32_bf16 v[168:171], v[48:51], a[8:11], 0
 ds_read_b64_tr_b16 v[38:39], v6 offset:16896
 v_mul_f32 v113, v97, v113
 v_mfma_f32_16x16x32_bf16 v[168:171], v[52:55], a[24:27], v[168:171]
 v_mul_f32 v114, v98, v114
 v_mul_f32 v115, v99, v115
 v_mfma_f32_16x16x32_bf16 v[168:171], v[56:59], a[40:43], v[168:171]
 ds_read_b64_tr_b16 v[40:41], v6 offset:20480
 v_add_f32 v80, 1.0, v80
 v_mfma_f32_16x16x32_bf16 v[168:171], v[60:63], a[56:59], v[168:171]
 v_rcp_f32 v80, v80
 v_mfma_f32_16x16x32_bf16 v[168:171], v[64:67], a[72:75], v[168:171]
 ds_read_b64_tr_b16 v[42:43], v6 offset:20992
 v_add_f32 v81, 1.0, v81
 v_mfma_f32_16x16x32_bf16 v[168:171], v[68:71], a[88:91], v[168:171]
 v_rcp_f32 v81, v81
 v_mfma_f32_16x16x32_bf16 v[168:171], v[72:75], a[104:107], v[168:171]
 ds_read_b64_tr_b16 v[44:45], v6 offset:24576
 v_add_f32 v82, 1.0, v82
 v_mfma_f32_16x16x32_bf16 v[168:171], v[76:79], a[120:123], v[168:171]
 v_rcp_f32 v82, v82
 v_mfma_f32_16x16x32_bf16 v[168:171], v[16:19], a[136:139], v[168:171]
 ds_read_b64_tr_b16 v[46:47], v6 offset:25088
 v_add_f32 v83, 1.0, v83
 v_mfma_f32_16x16x32_bf16 v[172:175], v[48:51], a[12:15], 0
 v_rcp_f32 v83, v83
 v_mfma_f32_16x16x32_bf16 v[172:175], v[52:55], a[28:31], v[172:175]
 ds_read_b64_tr_b16 v[48:49], v6 offset:28672
 v_mul_f32 v112, v112, v80
 v_mfma_f32_16x16x32_bf16 v[172:175], v[56:59], a[44:47], v[172:175]
 v_mul_f32 v113, v113, v81
 v_mul_f32 v114, v114, v82
 v_mfma_f32_16x16x32_bf16 v[172:175], v[60:63], a[60:63], v[172:175]
 ds_read_b64_tr_b16 v[50:51], v6 offset:29184
 v_mul_f32 v115, v115, v83
 v_mfma_f32_16x16x32_bf16 v[172:175], v[64:67], a[76:79], v[172:175]
 v_cvt_pk_bf16_f32 v88, v112, v113
 v_cvt_pk_bf16_f32 v89, v114, v115
 v_mfma_f32_16x16x32_bf16 v[172:175], v[68:71], a[92:95], v[172:175]
 ds_read_b64_tr_b16 v[52:53], v6 offset:32768
 v_mul_f32 v84, v128, v128
 v_mfma_f32_16x16x32_bf16 v[172:175], v[72:75], a[108:111], v[172:175]
 v_mul_f32 v85, v129, v129
 v_mul_f32 v86, v130, v130
 v_mfma_f32_16x16x32_bf16 v[172:175], v[76:79], a[124:127], v[172:175]
 ds_read_b64_tr_b16 v[54:55], v6 offset:33280
 v_mul_f32 v87, v131, v131
 v_mfma_f32_16x16x32_bf16 v[172:175], v[16:19], a[140:143], v[172:175]
 s_waitcnt lgkmcnt(12)
 v_fma_f32 v84, v84, s30, v9
 v_fma_f32 v85, v85, s30, v9
 v_mfma_f32_16x16x32_bf16 v[176:179], v[20:23], a[0:3], 0
 ds_read_b64_tr_b16 v[56:57], v7 offset:0
 v_fma_f32 v86, v86, s30, v9
 v_mfma_f32_16x16x32_bf16 v[176:179], v[24:27], a[16:19], v[176:179]
 v_fma_f32 v87, v87, s30, v9
 v_mul_f32 v84, v84, v128
 v_mfma_f32_16x16x32_bf16 v[176:179], v[28:31], a[32:35], v[176:179]
 ds_read_b64_tr_b16 v[58:59], v7 offset:512
 s_waitcnt lgkmcnt(8)
 v_mfma_f32_16x16x32_bf16 v[176:179], v[32:35], a[48:51], v[176:179]
 v_exp_f32 v84, v84
 v_mfma_f32_16x16x32_bf16 v[176:179], v[36:39], a[64:67], v[176:179]
 ds_read_b64_tr_b16 v[60:61], v7 offset:4096
 v_add_u32 v6, 36864, v6
 v_mfma_f32_16x16x32_bf16 v[176:179], v[40:43], a[80:83], v[176:179]
 s_waitcnt lgkmcnt(3)
 v_mul_f32 v85, v85, v129
 v_mul_f32 v86, v86, v130
 v_mfma_f32_16x16x32_bf16 v[176:179], v[44:47], a[96:99], v[176:179]
 ds_read_b64_tr_b16 v[62:63], v7 offset:4608
 v_mul_f32 v87, v87, v131
 v_mfma_f32_16x16x32_bf16 v[176:179], v[48:51], a[112:115], v[176:179]
 v_exp_f32 v85, v85
 v_mfma_f32_16x16x32_bf16 v[176:179], v[52:55], a[128:131], v[176:179]
 ds_read_b64_tr_b16 v[64:65], v7 offset:8192
 v_mul_f32 v144, v128, v144
 v_mfma_f32_16x16x32_bf16 v[180:183], v[20:23], a[4:7], 0
 v_exp_f32 v86, v86
 v_mfma_f32_16x16x32_bf16 v[180:183], v[24:27], a[20:23], v[180:183]
 ds_read_b64_tr_b16 v[66:67], v7 offset:8704
 v_mul_f32 v145, v129, v145
 v_mfma_f32_16x16x32_bf16 v[180:183], v[28:31], a[36:39], v[180:183]
 v_exp_f32 v87, v87
 v_mfma_f32_16x16x32_bf16 v[180:183], v[32:35], a[52:55], v[180:183]
 ds_read_b64_tr_b16 v[68:69], v7 offset:12288
 v_mul_f32 v146, v130, v146
 v_mfma_f32_16x16x32_bf16 v[180:183], v[36:39], a[68:71], v[180:183]
 v_mul_f32 v147, v131, v147
 v_add_f32 v84, 1.0, v84
 v_mfma_f32_16x16x32_bf16 v[180:183], v[40:43], a[84:87], v[180:183]
 ds_read_b64_tr_b16 v[70:71], v7 offset:12800
 v_add_f32 v85, 1.0, v85
 v_mfma_f32_16x16x32_bf16 v[180:183], v[44:47], a[100:103], v[180:183]
 s_add_u32 s36, s26, 2048
 v_rcp_f32 v84, v84
 v_mfma_f32_16x16x32_bf16 v[180:183], v[48:51], a[116:119], v[180:183]
 ds_read_b64_tr_b16 v[72:73], v7 offset:16384
 v_add_f32 v86, 1.0, v86
 v_mfma_f32_16x16x32_bf16 v[180:183], v[52:55], a[132:135], v[180:183]
 v_rcp_f32 v85, v85
 v_mfma_f32_16x16x32_bf16 v[184:187], v[20:23], a[8:11], 0
 ds_read_b64_tr_b16 v[74:75], v7 offset:16896
 v_add_f32 v87, 1.0, v87
 v_mfma_f32_16x16x32_bf16 v[184:187], v[24:27], a[24:27], v[184:187]
 v_rcp_f32 v86, v86
 v_mfma_f32_16x16x32_bf16 v[184:187], v[28:31], a[40:43], v[184:187]
 ds_read_b64_tr_b16 v[76:77], v7 offset:20480
 v_mul_f32 v144, v144, v84
 v_mfma_f32_16x16x32_bf16 v[184:187], v[32:35], a[56:59], v[184:187]
 v_rcp_f32 v87, v87
 v_mfma_f32_16x16x32_bf16 v[184:187], v[36:39], a[72:75], v[184:187]
 ds_read_b64_tr_b16 v[78:79], v7 offset:20992
 v_mul_f32 v145, v145, v85
 v_mfma_f32_16x16x32_bf16 v[184:187], v[40:43], a[88:91], v[184:187]
 v_mul_f32 v146, v146, v86
 v_mul_f32 v147, v147, v87
 v_mfma_f32_16x16x32_bf16 v[184:187], v[44:47], a[104:107], v[184:187]
 ds_read_b64_tr_b16 v[16:17], v7 offset:24576
 s_lshr_b32 s44, s2, 3
 v_mfma_f32_16x16x32_bf16 v[184:187], v[48:51], a[120:123], v[184:187]
 s_lshl_b32 s44, s44, 2
 v_cvt_pk_bf16_f32 v90, v144, v145
 v_cvt_pk_bf16_f32 v91, v146, v147
 v_mfma_f32_16x16x32_bf16 v[184:187], v[52:55], a[136:139], v[184:187]
 ds_read_b64_tr_b16 v[18:19], v7 offset:25088
 s_add_u32 s44, s44, s20
 v_mfma_f32_16x16x32_bf16 v[188:191], v[20:23], a[12:15], 0
 s_mul_i32 s44, s44, 3
 v_mul_f32 v80, v100, v100
 v_mul_f32 v81, v101, v101
 v_mfma_f32_16x16x32_bf16 v[188:191], v[24:27], a[28:31], v[188:191]
 ds_read_b64_tr_b16 v[20:21], v7 offset:28672
 s_add_u32 s44, s44, 2
 v_mfma_f32_16x16x32_bf16 v[188:191], v[28:31], a[44:47], v[188:191]
 s_mul_i32 s45, s44, 911
 v_mul_f32 v82, v102, v102
 v_mul_f32 v83, v103, v103
 v_mfma_f32_16x16x32_bf16 v[188:191], v[32:35], a[60:63], v[188:191]
 ds_read_b64_tr_b16 v[22:23], v7 offset:29184
 s_lshr_b32 s45, s45, 16
 v_mfma_f32_16x16x32_bf16 v[188:191], v[36:39], a[76:79], v[188:191]
 s_mul_i32 s43, s45, 72
 v_fma_f32 v80, v80, s30, v9
 v_fma_f32 v81, v81, s30, v9
 v_mfma_f32_16x16x32_bf16 v[188:191], v[40:43], a[92:95], v[188:191]
 ds_read_b64_tr_b16 v[24:25], v7 offset:32768
 s_sub_u32 s44, s44, s43
 v_mfma_f32_16x16x32_bf16 v[188:191], v[44:47], a[108:111], v[188:191]
 s_lshl_b32 s44, s44, 7
 v_fma_f32 v82, v82, s30, v9
 v_fma_f32 v83, v83, s30, v9
 v_mfma_f32_16x16x32_bf16 v[188:191], v[48:51], a[124:127], v[188:191]
 ds_read_b64_tr_b16 v[26:27], v7 offset:33280
 s_mul_i32 s45, s45, 294912
 v_mfma_f32_16x16x32_bf16 v[188:191], v[52:55], a[140:143], v[188:191]
 s_add_u32 s44, s44, s45
 s_waitcnt lgkmcnt(12)
 v_add_u32 v7, 36864, v7
 v_mfma_f32_16x16x32_bf16 v[192:195], v[56:59], a[0:3], 0
 ds_read_b64_tr_b16 v[28:29], v7 offset:0
 s_mul_i32 s45, s88, 1327104
 v_mfma_f32_16x16x32_bf16 v[192:195], v[60:63], a[16:19], v[192:195]
 s_add_u32 s44, s44, s45
 v_mul_f32 v80, v80, v100
 v_mul_f32 v81, v81, v101
 v_mfma_f32_16x16x32_bf16 v[192:195], v[64:67], a[32:35], v[192:195]
 ds_read_b64_tr_b16 v[30:31], v7 offset:512
 s_waitcnt lgkmcnt(8)
 v_mfma_f32_16x16x32_bf16 v[192:195], v[68:71], a[48:51], v[192:195]
 buffer_load_dword v8, v5, s[16:19], s44 offen
 v_mul_f32 v82, v82, v102
 v_mfma_f32_16x16x32_bf16 v[192:195], v[72:75], a[64:67], v[192:195]
 ds_read_b64_tr_b16 v[32:33], v7 offset:4096
 v_mul_f32 v83, v83, v103
 v_mfma_f32_16x16x32_bf16 v[192:195], v[76:79], a[80:83], v[192:195]
 s_waitcnt lgkmcnt(3)
 v_exp_f32 v80, v80
 v_mfma_f32_16x16x32_bf16 v[192:195], v[16:19], a[96:99], v[192:195]
 ds_read_b64_tr_b16 v[34:35], v7 offset:4608
 v_mul_f32 v116, v100, v116
 v_mfma_f32_16x16x32_bf16 v[192:195], v[20:23], a[112:115], v[192:195]
 buffer_store_dwordx4 v[88:91], v1, s[12:15], s36 offen sc1
 v_mfma_f32_16x16x32_bf16 v[192:195], v[24:27], a[128:131], v[192:195]
 ds_read_b64_tr_b16 v[36:37], v7 offset:8192
 v_mul_f32 v117, v101, v117
 v_mfma_f32_16x16x32_bf16 v[196:199], v[56:59], a[4:7], 0
 v_exp_f32 v81, v81
 v_mfma_f32_16x16x32_bf16 v[196:199], v[60:63], a[20:23], v[196:199]
 ds_read_b64_tr_b16 v[38:39], v7 offset:8704
 v_mul_f32 v118, v102, v118
 v_mfma_f32_16x16x32_bf16 v[196:199], v[64:67], a[36:39], v[196:199]
 v_exp_f32 v82, v82
 v_mfma_f32_16x16x32_bf16 v[196:199], v[68:71], a[52:55], v[196:199]
 ds_read_b64_tr_b16 v[40:41], v7 offset:12288
 v_mul_f32 v119, v103, v119
 v_mfma_f32_16x16x32_bf16 v[196:199], v[72:75], a[68:71], v[196:199]
 v_exp_f32 v83, v83
 v_mfma_f32_16x16x32_bf16 v[196:199], v[76:79], a[84:87], v[196:199]
 ds_read_b64_tr_b16 v[42:43], v7 offset:12800
 v_add_f32 v80, 1.0, v80
 v_mfma_f32_16x16x32_bf16 v[196:199], v[16:19], a[100:103], v[196:199]
 v_rcp_f32 v80, v80
 v_mfma_f32_16x16x32_bf16 v[196:199], v[20:23], a[116:119], v[196:199]
 ds_read_b64_tr_b16 v[44:45], v7 offset:16384
 v_add_f32 v81, 1.0, v81
 v_mfma_f32_16x16x32_bf16 v[196:199], v[24:27], a[132:135], v[196:199]
 v_rcp_f32 v81, v81
 v_mfma_f32_16x16x32_bf16 v[200:203], v[56:59], a[8:11], 0
 ds_read_b64_tr_b16 v[46:47], v7 offset:16896
 v_add_f32 v82, 1.0, v82
 v_mfma_f32_16x16x32_bf16 v[200:203], v[60:63], a[24:27], v[200:203]
 v_rcp_f32 v82, v82
 v_mfma_f32_16x16x32_bf16 v[200:203], v[64:67], a[40:43], v[200:203]
 ds_read_b64_tr_b16 v[48:49], v7 offset:20480
 v_add_f32 v83, 1.0, v83
 v_mfma_f32_16x16x32_bf16 v[200:203], v[68:71], a[56:59], v[200:203]
 v_rcp_f32 v83, v83
 v_mfma_f32_16x16x32_bf16 v[200:203], v[72:75], a[72:75], v[200:203]
 ds_read_b64_tr_b16 v[50:51], v7 offset:20992
 v_mul_f32 v116, v116, v80
 v_mfma_f32_16x16x32_bf16 v[200:203], v[76:79], a[88:91], v[200:203]
 v_mul_f32 v117, v117, v81
 v_mul_f32 v118, v118, v82
 v_mfma_f32_16x16x32_bf16 v[200:203], v[16:19], a[104:107], v[200:203]
 ds_read_b64_tr_b16 v[52:53], v7 offset:24576
 v_mul_f32 v119, v119, v83
 v_mfma_f32_16x16x32_bf16 v[200:203], v[20:23], a[120:123], v[200:203]
 v_cvt_pk_bf16_f32 v92, v116, v117
 v_cvt_pk_bf16_f32 v93, v118, v119
 v_mfma_f32_16x16x32_bf16 v[200:203], v[24:27], a[136:139], v[200:203]
 ds_read_b64_tr_b16 v[54:55], v7 offset:25088
 v_mul_f32 v84, v132, v132
 v_mfma_f32_16x16x32_bf16 v[204:207], v[56:59], a[12:15], 0
 v_mul_f32 v85, v133, v133
 v_mul_f32 v86, v134, v134
 v_mfma_f32_16x16x32_bf16 v[204:207], v[60:63], a[28:31], v[204:207]
 ds_read_b64_tr_b16 v[56:57], v7 offset:28672
 v_mul_f32 v87, v135, v135
 v_mfma_f32_16x16x32_bf16 v[204:207], v[64:67], a[44:47], v[204:207]
 v_fma_f32 v84, v84, s30, v9
 v_fma_f32 v85, v85, s30, v9
 v_mfma_f32_16x16x32_bf16 v[204:207], v[68:71], a[60:63], v[204:207]
 ds_read_b64_tr_b16 v[58:59], v7 offset:29184
 v_fma_f32 v86, v86, s30, v9
 v_mfma_f32_16x16x32_bf16 v[204:207], v[72:75], a[76:79], v[204:207]
 v_fma_f32 v87, v87, s30, v9
 v_mul_f32 v84, v84, v132
 v_mfma_f32_16x16x32_bf16 v[204:207], v[76:79], a[92:95], v[204:207]
 ds_read_b64_tr_b16 v[60:61], v7 offset:32768
 v_mul_f32 v85, v85, v133
 v_mfma_f32_16x16x32_bf16 v[204:207], v[16:19], a[108:111], v[204:207]
 v_exp_f32 v84, v84
 v_mfma_f32_16x16x32_bf16 v[204:207], v[20:23], a[124:127], v[204:207]
 ds_read_b64_tr_b16 v[62:63], v7 offset:33280
 v_mul_f32 v86, v86, v134
 v_mfma_f32_16x16x32_bf16 v[204:207], v[24:27], a[140:143], v[204:207]
 s_waitcnt lgkmcnt(12)
 v_add_u32 v7, 36864, v7
 v_mul_f32 v87, v87, v135
 v_mfma_f32_16x16x32_bf16 v[208:211], v[28:31], a[0:3], 0
 v_exp_f32 v85, v85
 v_mfma_f32_16x16x32_bf16 v[208:211], v[32:35], a[16:19], v[208:211]
 v_exp_f32 v86, v86
 v_mfma_f32_16x16x32_bf16 v[208:211], v[36:39], a[32:35], v[208:211]
 s_waitcnt vmcnt(2)
 s_waitcnt lgkmcnt(6)
 s_waitcnt lgkmcnt(0)
 s_barrier
 v_mfma_f32_16x16x32_bf16 v[208:211], v[40:43], a[48:51], v[208:211]
 ds_read_b64_tr_b16 v[64:65], v6 offset:0
 v_mov_b32 v4, s60
 s_cmp_eq_u32 s20, 0
 s_cselect_b32 s77, s31, 0x7ff00000
 s_mov_b64 exec, 1
 buffer_store_dword v4, v1, s[12:15], s77 offen offset:0 sc1
 s_mov_b64 exec, -1
 v_mfma_f32_16x16x32_bf16 v[208:211], v[44:47], a[64:67], v[208:211]
 ds_read_b64_tr_b16 v[66:67], v6 offset:512
 s_add_u32 s28, s24, 0
 v_mfma_f32_16x16x32_bf16 v[208:211], v[48:51], a[80:83], v[208:211]
 s_add_u32 m0, s82, 0
 v_mul_f32 v148, v132, v148
 v_mfma_f32_16x16x32_bf16 v[208:211], v[52:55], a[96:99], v[208:211]
 ds_read_b64_tr_b16 v[68:69], v6 offset:4096
 v_mul_f32 v149, v133, v149
 v_mfma_f32_16x16x32_bf16 v[208:211], v[56:59], a[112:115], v[208:211]
 buffer_load_dwordx4 v5, s[4:7], s28 offen lds
 v_mfma_f32_16x16x32_bf16 v[208:211], v[60:63], a[128:131], v[208:211]
 ds_read_b64_tr_b16 v[70:71], v6 offset:4608
 v_mul_f32 v150, v134, v150
 v_mfma_f32_16x16x32_bf16 v[212:215], v[28:31], a[4:7], 0
 v_exp_f32 v87, v87
 v_mfma_f32_16x16x32_bf16 v[212:215], v[32:35], a[20:23], v[212:215]
 ds_read_b64_tr_b16 v[72:73], v6 offset:8192
 v_mul_f32 v151, v135, v151
 v_mfma_f32_16x16x32_bf16 v[212:215], v[36:39], a[36:39], v[212:215]
 ds_read_b64_tr_b16 v[74:75], v6 offset:8704
 v_add_f32 v84, 1.0, v84
 v_mfma_f32_16x16x32_bf16 v[212:215], v[40:43], a[52:55], v[212:215]
 s_add_u32 s37, s26, 149504
 v_rcp_f32 v84, v84
 v_mfma_f32_16x16x32_bf16 v[212:215], v[44:47], a[68:71], v[212:215]
 ds_read_b64_tr_b16 v[76:77], v6 offset:12288
 v_add_f32 v85, 1.0, v85
 v_mfma_f32_16x16x32_bf16 v[212:215], v[48:51], a[84:87], v[212:215]
 v_rcp_f32 v85, v85
 v_mfma_f32_16x16x32_bf16 v[212:215], v[52:55], a[100:103], v[212:215]
 ds_read_b64_tr_b16 v[78:79], v6 offset:12800
 v_add_f32 v86, 1.0, v86
 v_mfma_f32_16x16x32_bf16 v[212:215], v[56:59], a[116:119], v[212:215]
 s_add_u32 s28, s24, 589824
 v_rcp_f32 v86, v86
 v_mfma_f32_16x16x32_bf16 v[212:215], v[60:63], a[132:135], v[212:215]
 ds_read_b64_tr_b16 v[16:17], v6 offset:16384
 s_add_u32 m0, s82, 2048
 v_mfma_f32_16x16x32_bf16 v[216:219], v[28:31], a[8:11], 0
 buffer_load_dwordx4 v5, s[4:7], s28 offen lds
 v_mfma_f32_16x16x32_bf16 v[216:219], v[32:35], a[24:27], v[216:219]
 ds_read_b64_tr_b16 v[18:19], v6 offset:16896
 v_add_f32 v87, 1.0, v87
 v_mfma_f32_16x16x32_bf16 v[216:219], v[36:39], a[40:43], v[216:219]
 ds_read_b64_tr_b16 v[20:21], v6 offset:20480
 v_mul_f32 v148, v148, v84
 v_mfma_f32_16x16x32_bf16 v[216:219], v[40:43], a[56:59], v[216:219]
 v_rcp_f32 v87, v87
 v_mfma_f32_16x16x32_bf16 v[216:219], v[44:47], a[72:75], v[216:219]
 ds_read_b64_tr_b16 v[22:23], v6 offset:20992
 v_mul_f32 v149, v149, v85
 v_mfma_f32_16x16x32_bf16 v[216:219], v[48:51], a[88:91], v[216:219]
 v_mul_f32 v150, v150, v86
 v_mul_f32 v151, v151, v87
 v_mfma_f32_16x16x32_bf16 v[216:219], v[52:55], a[104:107], v[216:219]
 ds_read_b64_tr_b16 v[24:25], v6 offset:24576
 v_cvt_pk_bf16_f32 v94, v148, v149
 v_mfma_f32_16x16x32_bf16 v[216:219], v[56:59], a[120:123], v[216:219]
 v_cvt_pk_bf16_f32 v95, v150, v151
 v_mul_f32 v80, v104, v104
 v_mfma_f32_16x16x32_bf16 v[216:219], v[60:63], a[136:139], v[216:219]
 ds_read_b64_tr_b16 v[26:27], v6 offset:25088
 v_mul_f32 v81, v105, v105
 v_mfma_f32_16x16x32_bf16 v[220:223], v[28:31], a[12:15], 0
 buffer_store_dwordx4 v[92:95], v1, s[12:15], s37 offen sc1
 v_mfma_f32_16x16x32_bf16 v[220:223], v[32:35], a[28:31], v[220:223]
 ds_read_b64_tr_b16 v[28:29], v6 offset:28672
 v_mul_f32 v82, v106, v106
 v_mfma_f32_16x16x32_bf16 v[220:223], v[36:39], a[44:47], v[220:223]
 ds_read_b64_tr_b16 v[30:31], v6 offset:29184
 v_mul_f32 v83, v107, v107
 v_mfma_f32_16x16x32_bf16 v[220:223], v[40:43], a[60:63], v[220:223]
 v_fma_f32 v80, v80, s30, v9
 v_fma_f32 v81, v81, s30, v9
 v_mfma_f32_16x16x32_bf16 v[220:223], v[44:47], a[76:79], v[220:223]
 ds_read_b64_tr_b16 v[32:33], v6 offset:32768
 v_fma_f32 v82, v82, s30, v9
 v_mfma_f32_16x16x32_bf16 v[220:223], v[48:51], a[92:95], v[220:223]
 v_fma_f32 v83, v83, s30, v9
 v_mul_f32 v80, v80, v104
 v_mfma_f32_16x16x32_bf16 v[220:223], v[52:55], a[108:111], v[220:223]
 ds_read_b64_tr_b16 v[34:35], v6 offset:33280
 v_mul_f32 v81, v81, v105
 v_mfma_f32_16x16x32_bf16 v[220:223], v[56:59], a[124:127], v[220:223]
 v_exp_f32 v80, v80
 v_mfma_f32_16x16x32_bf16 v[220:223], v[60:63], a[140:143], v[220:223]
 s_waitcnt lgkmcnt(12)
 v_add_u32 v6, 36864, v6
 v_mul_f32 v82, v82, v106
 v_mfma_f32_16x16x32_bf16 v[160:163], v[64:67], a[144:147], v[160:163]
 ds_read_b64_tr_b16 v[36:37], v6 offset:0
 v_mul_f32 v83, v83, v107
 v_mfma_f32_16x16x32_bf16 v[160:163], v[68:71], a[160:163], v[160:163]
 s_add_u32 s28, s24, 1179648
 v_exp_f32 v81, v81
 v_mfma_f32_16x16x32_bf16 v[160:163], v[72:75], a[176:179], v[160:163]
 ds_read_b64_tr_b16 v[38:39], v6 offset:512
 s_waitcnt lgkmcnt(8)
 v_mfma_f32_16x16x32_bf16 v[160:163], v[76:79], a[192:195], v[160:163]
 s_add_u32 m0, s82, 4096
 v_exp_f32 v82, v82
 v_mfma_f32_16x16x32_bf16 v[160:163], v[16:19], a[208:211], v[160:163]
 ds_read_b64_tr_b16 v[40:41], v6 offset:4096
 v_mul_f32 v120, v104, v120
 v_mfma_f32_16x16x32_bf16 v[160:163], v[20:23], a[224:227], v[160:163]
 s_waitcnt lgkmcnt(3)
 v_exp_f32 v83, v83
 v_mfma_f32_16x16x32_bf16 v[160:163], v[24:27], a[240:243], v[160:163]
 ds_read_b64_tr_b16 v[42:43], v6 offset:4608
 v_mul_f32 v121, v105, v121
 v_mfma_f32_16x16x32_bf16 v[160:163], v[28:31], v[224:227], v[160:163]
 buffer_load_dwordx4 v5, s[4:7], s28 offen lds
 v_mfma_f32_16x16x32_bf16 v[160:163], v[32:35], v[240:243], v[160:163]
 ds_read_b64_tr_b16 v[44:45], v6 offset:8192
 v_mul_f32 v122, v106, v122
 v_mfma_f32_16x16x32_bf16 v[164:167], v[64:67], a[148:151], v[164:167]
 v_mul_f32 v123, v107, v123
 v_add_f32 v80, 1.0, v80
 v_mfma_f32_16x16x32_bf16 v[164:167], v[68:71], a[164:167], v[164:167]
 ds_read_b64_tr_b16 v[46:47], v6 offset:8704
 v_add_f32 v81, 1.0, v81
 v_mfma_f32_16x16x32_bf16 v[164:167], v[72:75], a[180:183], v[164:167]
 v_rcp_f32 v80, v80
 v_mfma_f32_16x16x32_bf16 v[164:167], v[76:79], a[196:199], v[164:167]
 ds_read_b64_tr_b16 v[48:49], v6 offset:12288
 v_add_f32 v82, 1.0, v82
 v_mfma_f32_16x16x32_bf16 v[164:167], v[16:19], a[212:215], v[164:167]
 v_rcp_f32 v81, v81
 v_mfma_f32_16x16x32_bf16 v[164:167], v[20:23], a[228:231], v[164:167]
 ds_read_b64_tr_b16 v[50:51], v6 offset:12800
 v_add_f32 v83, 1.0, v83
 v_mfma_f32_16x16x32_bf16 v[164:167], v[24:27], a[244:247], v[164:167]
 v_rcp_f32 v82, v82
 v_mfma_f32_16x16x32_bf16 v[164:167], v[28:31], v[228:231], v[164:167]
 ds_read_b64_tr_b16 v[52:53], v6 offset:16384
 v_mul_f32 v120, v120, v80
 v_mfma_f32_16x16x32_bf16 v[164:167], v[32:35], v[244:247], v[164:167]
 s_add_u32 s28, s24, 1769472
 v_rcp_f32 v83, v83
 v_mfma_f32_16x16x32_bf16 v[168:171], v[64:67], a[152:155], v[168:171]
 ds_read_b64_tr_b16 v[54:55], v6 offset:16896
 s_add_u32 m0, s82, 6144
 v_mfma_f32_16x16x32_bf16 v[168:171], v[68:71], a[168:171], v[168:171]
 buffer_load_dwordx4 v5, s[4:7], s28 offen lds
 v_mfma_f32_16x16x32_bf16 v[168:171], v[72:75], a[184:187], v[168:171]
 ds_read_b64_tr_b16 v[56:57], v6 offset:20480
 v_mul_f32 v121, v121, v81
 v_mfma_f32_16x16x32_bf16 v[168:171], v[76:79], a[200:203], v[168:171]
 v_mul_f32 v122, v122, v82
 v_mul_f32 v123, v123, v83
 v_mfma_f32_16x16x32_bf16 v[168:171], v[16:19], a[216:219], v[168:171]
 ds_read_b64_tr_b16 v[58:59], v6 offset:20992
 v_cvt_pk_bf16_f32 v88, v120, v121
 v_mfma_f32_16x16x32_bf16 v[168:171], v[20:23], a[232:235], v[168:171]
 v_cvt_pk_bf16_f32 v89, v122, v123
 v_mul_f32 v84, v136, v136
 v_mfma_f32_16x16x32_bf16 v[168:171], v[24:27], a[248:251], v[168:171]
 ds_read_b64_tr_b16 v[60:61], v6 offset:24576
 v_mul_f32 v85, v137, v137
 v_mfma_f32_16x16x32_bf16 v[168:171], v[28:31], v[232:235], v[168:171]
 v_mul_f32 v86, v138, v138
 v_mul_f32 v87, v139, v139
 v_mfma_f32_16x16x32_bf16 v[168:171], v[32:35], v[248:251], v[168:171]
 ds_read_b64_tr_b16 v[62:63], v6 offset:25088
 v_fma_f32 v84, v84, s30, v9
 v_mfma_f32_16x16x32_bf16 v[172:175], v[64:67], a[156:159], v[172:175]
 v_fma_f32 v85, v85, s30, v9
 v_fma_f32 v86, v86, s30, v9
 v_mfma_f32_16x16x32_bf16 v[172:175], v[68:71], a[172:175], v[172:175]
 ds_read_b64_tr_b16 v[64:65], v6 offset:28672
 v_fma_f32 v87, v87, s30, v9
 v_mfma_f32_16x16x32_bf16 v[172:175], v[72:75], a[188:191], v[172:175]
 v_mul_f32 v84, v84, v136
 v_mul_f32 v85, v85, v137
 v_mfma_f32_16x16x32_bf16 v[172:175], v[76:79], a[204:207], v[172:175]
 ds_read_b64_tr_b16 v[66:67], v6 offset:29184
 v_mul_f32 v86, v86, v138
 v_mfma_f32_16x16x32_bf16 v[172:175], v[16:19], a[220:223], v[172:175]
 v_exp_f32 v84, v84
 v_mfma_f32_16x16x32_bf16 v[172:175], v[20:23], a[236:239], v[172:175]
 ds_read_b64_tr_b16 v[68:69], v6 offset:32768
 v_mul_f32 v87, v87, v139
 v_mfma_f32_16x16x32_bf16 v[172:175], v[24:27], a[252:255], v[172:175]
 s_add_u32 s28, s24, 2359296
 v_exp_f32 v85, v85
 v_mfma_f32_16x16x32_bf16 v[172:175], v[28:31], v[236:239], v[172:175]
 ds_read_b64_tr_b16 v[70:71], v6 offset:33280
 s_add_u32 m0, s82, 8192
 v_mfma_f32_16x16x32_bf16 v[172:175], v[32:35], v[252:255], v[172:175]
 s_waitcnt lgkmcnt(12)
 v_exp_f32 v86, v86
 v_mfma_f32_16x16x32_bf16 v[176:179], v[36:39], a[144:147], v[176:179]
 ds_read_b64_tr_b16 v[72:73], v7 offset:0
 v_mul_f32 v152, v136, v152
 v_mfma_f32_16x16x32_bf16 v[176:179], v[40:43], a[160:163], v[176:179]
 buffer_load_dwordx4 v5, s[4:7], s28 offen lds
 v_mfma_f32_16x16x32_bf16 v[176:179], v[44:47], a[176:179], v[176:179]
 ds_read_b64_tr_b16 v[74:75], v7 offset:512
 s_waitcnt lgkmcnt(8)
 v_mfma_f32_16x16x32_bf16 v[176:179], v[48:51], a[192:195], v[176:179]
 v_exp_f32 v87, v87
 v_mfma_f32_16x16x32_bf16 v[176:179], v[52:55], a[208:211], v[176:179]
 ds_read_b64_tr_b16 v[76:77], v7 offset:4096
 v_mul_f32 v153, v137, v153
 v_mfma_f32_16x16x32_bf16 v[176:179], v[56:59], a[224:227], v[176:179]
 s_waitcnt lgkmcnt(3)
 v_mul_f32 v154, v138, v154
 v_mul_f32 v155, v139, v155
 v_mfma_f32_16x16x32_bf16 v[176:179], v[60:63], a[240:243], v[176:179]
 ds_read_b64_tr_b16 v[78:79], v7 offset:4608
 v_add_f32 v84, 1.0, v84
 v_mfma_f32_16x16x32_bf16 v[176:179], v[64:67], v[224:227], v[176:179]
 s_add_u32 s36, s26, 296960
 v_rcp_f32 v84, v84
 v_mfma_f32_16x16x32_bf16 v[176:179], v[68:71], v[240:243], v[176:179]
 ds_read_b64_tr_b16 v[16:17], v7 offset:8192
 v_add_f32 v85, 1.0, v85
 v_mfma_f32_16x16x32_bf16 v[180:183], v[36:39], a[148:151], v[180:183]
 v_rcp_f32 v85, v85
 v_mfma_f32_16x16x32_bf16 v[180:183], v[40:43], a[164:167], v[180:183]
 ds_read_b64_tr_b16 v[18:19], v7 offset:8704
 v_add_f32 v86, 1.0, v86
 v_mfma_f32_16x16x32_bf16 v[180:183], v[44:47], a[180:183], v[180:183]
 v_rcp_f32 v86, v86
 v_mfma_f32_16x16x32_bf16 v[180:183], v[48:51], a[196:199], v[180:183]
 ds_read_b64_tr_b16 v[20:21], v7 offset:12288
 v_add_f32 v87, 1.0, v87
 v_mfma_f32_16x16x32_bf16 v[180:183], v[52:55], a[212:215], v[180:183]
 v_rcp_f32 v87, v87
 v_mfma_f32_16x16x32_bf16 v[180:183], v[56:59], a[228:231], v[180:183]
 ds_read_b64_tr_b16 v[22:23], v7 offset:12800
 v_mul_f32 v152, v152, v84
 v_mfma_f32_16x16x32_bf16 v[180:183], v[60:63], a[244:247], v[180:183]
 v_mul_f32 v153, v153, v85
 v_mul_f32 v154, v154, v86
 v_mfma_f32_16x16x32_bf16 v[180:183], v[64:67], v[228:231], v[180:183]
 ds_read_b64_tr_b16 v[24:25], v7 offset:16384
 v_mul_f32 v155, v155, v87
 v_mfma_f32_16x16x32_bf16 v[180:183], v[68:71], v[244:247], v[180:183]
 v_cvt_pk_bf16_f32 v90, v152, v153
 v_cvt_pk_bf16_f32 v91, v154, v155
 v_mfma_f32_16x16x32_bf16 v[184:187], v[36:39], a[152:155], v[184:187]
 ds_read_b64_tr_b16 v[26:27], v7 offset:16896
 v_mul_f32 v80, v108, v108
 v_mfma_f32_16x16x32_bf16 v[184:187], v[40:43], a[168:171], v[184:187]
 buffer_store_dwordx4 v[88:91], v1, s[12:15], s36 offen sc1
 v_mfma_f32_16x16x32_bf16 v[184:187], v[44:47], a[184:187], v[184:187]
 ds_read_b64_tr_b16 v[28:29], v7 offset:20480
 s_add_u32 s28, s24, 2949120
 v_mfma_f32_16x16x32_bf16 v[184:187], v[48:51], a[200:203], v[184:187]
 s_add_u32 m0, s82, 10240
 v_mul_f32 v81, v109, v109
 v_mul_f32 v82, v110, v110
 v_mfma_f32_16x16x32_bf16 v[184:187], v[52:55], a[216:219], v[184:187]
 ds_read_b64_tr_b16 v[30:31], v7 offset:20992
 v_mul_f32 v83, v111, v111
 v_mfma_f32_16x16x32_bf16 v[184:187], v[56:59], a[232:235], v[184:187]
 buffer_load_dwordx4 v5, s[4:7], s28 offen lds
 v_mfma_f32_16x16x32_bf16 v[184:187], v[60:63], a[248:251], v[184:187]
 ds_read_b64_tr_b16 v[32:33], v7 offset:24576
 s_waitcnt vmcnt(10)
 v_mfma_f32_16x16x32_bf16 v[184:187], v[64:67], v[232:235], v[184:187]
 v_lshrrev_b32 v8, 4, v0
 v_fma_f32 v80, v80, s30, v9
 v_mfma_f32_16x16x32_bf16 v[184:187], v[68:71], v[248:251], v[184:187]
 ds_read_b64_tr_b16 v[34:35], v7 offset:25088
 v_lshrrev_b32 v4, 1, v8
 v_mfma_f32_16x16x32_bf16 v[188:191], v[36:39], a[156:159], v[188:191]
 v_lshlrev_b32 v4, 4, v4
 v_fma_f32 v81, v81, s30, v9
 v_mfma_f32_16x16x32_bf16 v[188:191], v[40:43], a[172:175], v[188:191]
 ds_read_b64_tr_b16 v[36:37], v7 offset:28672
 v_and_b32 v8, 1, v8
 v_mfma_f32_16x16x32_bf16 v[188:191], v[44:47], a[188:191], v[188:191]
 v_lshl_add_u32 v4, v8, 2, v4
 v_fma_f32 v82, v82, s30, v9
 v_mfma_f32_16x16x32_bf16 v[188:191], v[48:51], a[204:207], v[188:191]
 ds_read_b64_tr_b16 v[38:39], v7 offset:29184
 v_bfe_u32 v8, v0, 2, 2
 v_mfma_f32_16x16x32_bf16 v[188:191], v[52:55], a[220:223], v[188:191]
 v_add_u32 v4, v4, v8
 v_fma_f32 v83, v83, s30, v9
 v_mfma_f32_16x16x32_bf16 v[188:191], v[56:59], a[236:239], v[188:191]
 ds_read_b64_tr_b16 v[40:41], v7 offset:32768
 v_lshlrev_b32 v4, 5, v4
 v_mfma_f32_16x16x32_bf16 v[188:191], v[60:63], a[252:255], v[188:191]
 v_and_b32 v8, 3, v0
 v_mul_f32 v80, v80, v108
 v_mfma_f32_16x16x32_bf16 v[188:191], v[64:67], v[236:239], v[188:191]
 ds_read_b64_tr_b16 v[42:43], v7 offset:33280
 v_lshl_add_u32 v8, v8, 3, v4
 v_mfma_f32_16x16x32_bf16 v[188:191], v[68:71], v[252:255], v[188:191]
 s_waitcnt lgkmcnt(12)
 v_add_u32 v7, 36864, v7
 v_lshlrev_b32 v4, 3, v0
 v_mfma_f32_16x16x32_bf16 v[192:195], v[72:75], a[144:147], v[192:195]
 ds_read_b64_tr_b16 v[44:45], v7 offset:0
 v_mul_f32 v81, v81, v109
 v_mfma_f32_16x16x32_bf16 v[192:195], v[76:79], a[160:163], v[192:195]
 v_exp_f32 v80, v80
 v_mfma_f32_16x16x32_bf16 v[192:195], v[16:19], a[176:179], v[192:195]
 ds_read_b64_tr_b16 v[46:47], v7 offset:512
 s_waitcnt lgkmcnt(8)
 v_mfma_f32_16x16x32_bf16 v[192:195], v[20:23], a[192:195], v[192:195]
 v_exp_f32 v81, v81
 v_mfma_f32_16x16x32_bf16 v[192:195], v[24:27], a[208:211], v[192:195]
 ds_read_b64_tr_b16 v[48:49], v7 offset:4096
 s_add_u32 s28, s24, 3538944
 v_mfma_f32_16x16x32_bf16 v[192:195], v[28:31], a[224:227], v[192:195]
 s_add_u32 m0, s82, 12288
 s_waitcnt lgkmcnt(3)
 v_mul_f32 v82, v82, v110
 v_mfma_f32_16x16x32_bf16 v[192:195], v[32:35], a[240:243], v[192:195]
 ds_read_b64_tr_b16 v[50:51], v7 offset:4608
 v_mul_f32 v83, v83, v111
 v_mfma_f32_16x16x32_bf16 v[192:195], v[36:39], v[224:227], v[192:195]
 buffer_load_dwordx4 v5, s[4:7], s28 offen lds
 v_mfma_f32_16x16x32_bf16 v[192:195], v[40:43], v[240:243], v[192:195]
 ds_read_b64_tr_b16 v[52:53], v7 offset:8192
 v_mul_f32 v124, v108, v124
 v_mfma_f32_16x16x32_bf16 v[196:199], v[72:75], a[148:151], v[196:199]
 v_exp_f32 v82, v82
 v_mfma_f32_16x16x32_bf16 v[196:199], v[76:79], a[164:167], v[196:199]
 ds_read_b64_tr_b16 v[54:55], v7 offset:8704
 v_mul_f32 v125, v109, v125
 v_mfma_f32_16x16x32_bf16 v[196:199], v[16:19], a[180:183], v[196:199]
 v_exp_f32 v83, v83
 v_mfma_f32_16x16x32_bf16 v[196:199], v[20:23], a[196:199], v[196:199]
 ds_read_b64_tr_b16 v[56:57], v7 offset:12288
 v_mul_f32 v126, v110, v126
 v_mfma_f32_16x16x32_bf16 v[196:199], v[24:27], a[212:215], v[196:199]
 v_mul_f32 v127, v111, v127
 v_add_f32 v80, 1.0, v80
 v_mfma_f32_16x16x32_bf16 v[196:199], v[28:31], a[228:231], v[196:199]
 ds_read_b64_tr_b16 v[58:59], v7 offset:12800
 v_add_f32 v81, 1.0, v81
 v_mfma_f32_16x16x32_bf16 v[196:199], v[32:35], a[244:247], v[196:199]
 v_rcp_f32 v80, v80
 v_mfma_f32_16x16x32_bf16 v[196:199], v[36:39], v[228:231], v[196:199]
 ds_read_b64_tr_b16 v[60:61], v7 offset:16384
 v_add_f32 v82, 1.0, v82
 v_mfma_f32_16x16x32_bf16 v[196:199], v[40:43], v[244:247], v[196:199]
 v_rcp_f32 v81, v81
 v_mfma_f32_16x16x32_bf16 v[200:203], v[72:75], a[152:155], v[200:203]
 ds_read_b64_tr_b16 v[62:63], v7 offset:16896
 v_add_f32 v83, 1.0, v83
 v_mfma_f32_16x16x32_bf16 v[200:203], v[76:79], a[168:171], v[200:203]
 v_rcp_f32 v82, v82
 v_mfma_f32_16x16x32_bf16 v[200:203], v[16:19], a[184:187], v[200:203]
 ds_read_b64_tr_b16 v[64:65], v7 offset:20480
 v_mul_f32 v124, v124, v80
 v_mfma_f32_16x16x32_bf16 v[200:203], v[20:23], a[200:203], v[200:203]
 v_rcp_f32 v83, v83
 v_mfma_f32_16x16x32_bf16 v[200:203], v[24:27], a[216:219], v[200:203]
 ds_read_b64_tr_b16 v[66:67], v7 offset:20992
 v_mul_f32 v125, v125, v81
 v_mfma_f32_16x16x32_bf16 v[200:203], v[28:31], a[232:235], v[200:203]
 v_mul_f32 v126, v126, v82
 v_mul_f32 v127, v127, v83
 v_mfma_f32_16x16x32_bf16 v[200:203], v[32:35], a[248:251], v[200:203]
 ds_read_b64_tr_b16 v[68:69], v7 offset:24576
 s_add_u32 s28, s24, 4128768
 v_mfma_f32_16x16x32_bf16 v[200:203], v[36:39], v[232:235], v[200:203]
 s_add_u32 m0, s82, 14336
 v_cvt_pk_bf16_f32 v92, v124, v125
 v_cvt_pk_bf16_f32 v93, v126, v127
 v_mfma_f32_16x16x32_bf16 v[200:203], v[40:43], v[248:251], v[200:203]
 ds_read_b64_tr_b16 v[70:71], v7 offset:25088
 v_mul_f32 v84, v140, v140
 v_mfma_f32_16x16x32_bf16 v[204:207], v[72:75], a[156:159], v[204:207]
 buffer_load_dwordx4 v5, s[4:7], s28 offen lds
 v_mfma_f32_16x16x32_bf16 v[204:207], v[76:79], a[172:175], v[204:207]
 ds_read_b64_tr_b16 v[72:73], v7 offset:28672
 v_mul_f32 v85, v141, v141
 v_mfma_f32_16x16x32_bf16 v[204:207], v[16:19], a[188:191], v[204:207]
 v_mul_f32 v86, v142, v142
 v_mul_f32 v87, v143, v143
 v_mfma_f32_16x16x32_bf16 v[204:207], v[20:23], a[204:207], v[204:207]
 ds_read_b64_tr_b16 v[74:75], v7 offset:29184
 v_fma_f32 v84, v84, s30, v9
 v_mfma_f32_16x16x32_bf16 v[204:207], v[24:27], a[220:223], v[204:207]
 v_fma_f32 v85, v85, s30, v9
 v_fma_f32 v86, v86, s30, v9
 v_mfma_f32_16x16x32_bf16 v[204:207], v[28:31], a[236:239], v[204:207]
 ds_read_b64_tr_b16 v[76:77], v7 offset:32768
 v_fma_f32 v87, v87, s30, v9
 v_mfma_f32_16x16x32_bf16 v[204:207], v[32:35], a[252:255], v[204:207]
 v_mul_f32 v84, v84, v140
 v_mul_f32 v85, v85, v141
 v_mfma_f32_16x16x32_bf16 v[204:207], v[36:39], v[236:239], v[204:207]
 ds_read_b64_tr_b16 v[78:79], v7 offset:33280
 v_mul_f32 v86, v86, v142
 v_mfma_f32_16x16x32_bf16 v[204:207], v[40:43], v[252:255], v[204:207]
 s_waitcnt lgkmcnt(12)
 v_exp_f32 v84, v84
 v_mfma_f32_16x16x32_bf16 v[208:211], v[44:47], a[144:147], v[208:211]
 v_exp_f32 v85, v85
 v_mfma_f32_16x16x32_bf16 v[208:211], v[48:51], a[160:163], v[208:211]
 v_exp_f32 v86, v86
 v_mfma_f32_16x16x32_bf16 v[208:211], v[52:55], a[176:179], v[208:211]
 s_waitcnt lgkmcnt(6)
 s_waitcnt lgkmcnt(0)
 s_waitcnt vmcnt(4)
 s_barrier
 v_mfma_f32_16x16x32_bf16 v[208:211], v[56:59], a[192:195], v[208:211]
 ds_read_b64_tr_b16 v[16:17], v8 offset:0
 v_mul_f32 v87, v87, v143
 v_mfma_f32_16x16x32_bf16 v[208:211], v[60:63], a[208:211], v[208:211]
 ds_read_b64_tr_b16 v[18:19], v8 offset:256
 v_mul_f32 v156, v140, v156
 v_mfma_f32_16x16x32_bf16 v[208:211], v[64:67], a[224:227], v[208:211]
 v_exp_f32 v87, v87
 v_mfma_f32_16x16x32_bf16 v[208:211], v[68:71], a[240:243], v[208:211]
 ds_read_b64_tr_b16 v[20:21], v8 offset:1024
 v_mul_f32 v157, v141, v157
 v_mfma_f32_16x16x32_bf16 v[208:211], v[72:75], v[224:227], v[208:211]
 v_mul_f32 v158, v142, v158
 v_mul_f32 v159, v143, v159
 v_mfma_f32_16x16x32_bf16 v[208:211], v[76:79], v[240:243], v[208:211]
 ds_read_b64_tr_b16 v[22:23], v8 offset:1280
 s_add_u32 s28, s24, 4718592
 v_mfma_f32_16x16x32_bf16 v[212:215], v[44:47], a[148:151], v[212:215]
 s_add_u32 m0, s82, 16384
 v_add_f32 v84, 1.0, v84
 v_add_f32 v85, 1.0, v85
 v_mfma_f32_16x16x32_bf16 v[212:215], v[48:51], a[164:167], v[212:215]
 ds_read_b64_tr_b16 v[24:25], v8 offset:2048
 v_add_f32 v86, 1.0, v86
 v_mfma_f32_16x16x32_bf16 v[212:215], v[52:55], a[180:183], v[212:215]
 ds_read_b64_tr_b16 v[26:27], v8 offset:2304
 v_add_f32 v87, 1.0, v87
 v_mfma_f32_16x16x32_bf16 v[212:215], v[56:59], a[196:199], v[212:215]
 buffer_load_dwordx4 v5, s[4:7], s28 offen lds
 v_mfma_f32_16x16x32_bf16 v[212:215], v[60:63], a[212:215], v[212:215]
 ds_read_b64_tr_b16 v[28:29], v8 offset:3072
 v_mfma_f32_16x16x32_bf16 v[212:215], v[64:67], a[228:231], v[212:215]
 s_add_u32 s37, s26, 444416
 v_rcp_f32 v84, v84
 v_mfma_f32_16x16x32_bf16 v[212:215], v[68:71], a[244:247], v[212:215]
 ds_read_b64_tr_b16 v[30:31], v8 offset:3328
 v_mul_f32 v156, v156, v84
 v_mfma_f32_16x16x32_bf16 v[212:215], v[72:75], v[228:231], v[212:215]
 v_rcp_f32 v85, v85
 v_mfma_f32_16x16x32_bf16 v[212:215], v[76:79], v[244:247], v[212:215]
 ds_read_b64_tr_b16 v[32:33], v8 offset:4096
 v_mul_f32 v157, v157, v85
 v_mfma_f32_16x16x32_bf16 v[216:219], v[44:47], a[152:155], v[216:219]
 v_rcp_f32 v86, v86
 v_mfma_f32_16x16x32_bf16 v[216:219], v[48:51], a[168:171], v[216:219]
 ds_read_b64_tr_b16 v[34:35], v8 offset:4352
 v_mul_f32 v158, v158, v86
 v_mfma_f32_16x16x32_bf16 v[216:219], v[52:55], a[184:187], v[216:219]
 ds_read_b64_tr_b16 v[36:37], v8 offset:5120
 v_cvt_pk_bf16_f32 v94, v156, v157
 v_mfma_f32_16x16x32_bf16 v[216:219], v[56:59], a[200:203], v[216:219]
 v_rcp_f32 v87, v87
 v_mfma_f32_16x16x32_bf16 v[216:219], v[60:63], a[216:219], v[216:219]
 ds_read_b64_tr_b16 v[38:39], v8 offset:5376
 v_mul_f32 v159, v159, v87
 v_mfma_f32_16x16x32_bf16 v[216:219], v[64:67], a[232:235], v[216:219]
 v_cvt_pk_bf16_f32 v95, v158, v159
 v_mfma_f32_16x16x32_bf16 v[216:219], v[68:71], a[248:251], v[216:219]
 ds_read_b64_tr_b16 v[40:41], v8 offset:6144
 v_mfma_f32_16x16x32_bf16 v[216:219], v[72:75], v[232:235], v[216:219]
 buffer_store_dwordx4 v[92:95], v1, s[12:15], s37 offen sc1
 v_mfma_f32_16x16x32_bf16 v[216:219], v[76:79], v[248:251], v[216:219]
 ds_read_b64_tr_b16 v[42:43], v8 offset:6400
 v_mfma_f32_16x16x32_bf16 v[220:223], v[44:47], a[156:159], v[220:223]
 v_mfma_f32_16x16x32_bf16 v[220:223], v[48:51], a[172:175], v[220:223]
 ds_read_b64_tr_b16 v[44:45], v8 offset:7168
 v_mfma_f32_16x16x32_bf16 v[220:223], v[52:55], a[188:191], v[220:223]
 ds_read_b64_tr_b16 v[46:47], v8 offset:7424
 v_mfma_f32_16x16x32_bf16 v[220:223], v[56:59], a[204:207], v[220:223]
 v_mfma_f32_16x16x32_bf16 v[220:223], v[60:63], a[220:223], v[220:223]
 ds_read_b64_tr_b16 v[48:49], v8 offset:8192
 v_mfma_f32_16x16x32_bf16 v[220:223], v[64:67], a[236:239], v[220:223]
 v_mfma_f32_16x16x32_bf16 v[220:223], v[68:71], a[252:255], v[220:223]
 ds_read_b64_tr_b16 v[50:51], v8 offset:8448
 v_mfma_f32_16x16x32_bf16 v[220:223], v[72:75], v[236:239], v[220:223]
 v_mfma_f32_16x16x32_bf16 v[220:223], v[76:79], v[252:255], v[220:223]
 s_waitcnt lgkmcnt(12)
 v_mfma_f32_16x16x32_bf16 v[96:99], v[16:19], a[0:3], 0
 ds_read_b64_tr_b16 v[52:53], v8 offset:18432
 s_mov_b32 s42, 42594944
 v_mfma_f32_16x16x32_bf16 v[96:99], v[20:23], a[16:19], v[96:99]
 buffer_load_dwordx4 v[128:131], v1, s[12:15], s42 offen offset:0 sc1
 v_mul_f32 v80, v160, v160
 v_mfma_f32_16x16x32_bf16 v[96:99], v[24:27], a[32:35], v[96:99]
 ds_read_b64_tr_b16 v[54:55], v8 offset:18688
 s_waitcnt lgkmcnt(8)
 v_mfma_f32_16x16x32_bf16 v[96:99], v[28:31], a[48:51], v[96:99]
 v_mul_f32 v81, v161, v161
 v_mul_f32 v82, v162, v162
 v_mfma_f32_16x16x32_bf16 v[96:99], v[32:35], a[64:67], v[96:99]
 ds_read_b64_tr_b16 v[56:57], v8 offset:19456
 v_mul_f32 v83, v163, v163
 v_mfma_f32_16x16x32_bf16 v[96:99], v[36:39], a[80:83], v[96:99]
 s_waitcnt lgkmcnt(3)
 v_fma_f32 v80, v80, s30, v9
 v_fma_f32 v81, v81, s30, v9
 v_mfma_f32_16x16x32_bf16 v[96:99], v[40:43], a[96:99], v[96:99]
 ds_read_b64_tr_b16 v[58:59], v8 offset:19712
 v_fma_f32 v82, v82, s30, v9
 v_mfma_f32_16x16x32_bf16 v[96:99], v[44:47], a[112:115], v[96:99]
 v_fma_f32 v83, v83, s30, v9
 v_mul_f32 v80, v80, v160
 v_mfma_f32_16x16x32_bf16 v[96:99], v[48:51], a[128:131], v[96:99]
 ds_read_b64_tr_b16 v[60:61], v8 offset:20480
 v_mul_f32 v81, v81, v161
 v_mfma_f32_16x16x32_bf16 v[100:103], v[16:19], a[4:7], 0
 v_exp_f32 v80, v80
 v_mfma_f32_16x16x32_bf16 v[100:103], v[20:23], a[20:23], v[100:103]
 ds_read_b64_tr_b16 v[62:63], v8 offset:20736
 s_and_b32 s44, s2, 7
 v_mfma_f32_16x16x32_bf16 v[100:103], v[24:27], a[36:39], v[100:103]
 s_mul_i32 s44, s44, 25
 v_exp_f32 v81, v81
 v_mfma_f32_16x16x32_bf16 v[100:103], v[28:31], a[52:55], v[100:103]
 ds_read_b64_tr_b16 v[64:65], v8 offset:21504
 s_lshr_b32 s45, s2, 3
 v_mfma_f32_16x16x32_bf16 v[100:103], v[32:35], a[68:71], v[100:103]
 s_min_u32 s45, s45, 24
 v_mul_f32 v82, v82, v162
 v_mul_f32 v83, v83, v163
 v_mfma_f32_16x16x32_bf16 v[100:103], v[36:39], a[84:87], v[100:103]
 ds_read_b64_tr_b16 v[66:67], v8 offset:21760
 s_add_u32 s44, s44, s45
 v_mfma_f32_16x16x32_bf16 v[100:103], v[40:43], a[100:103], v[100:103]
 s_mul_i32 s44, s44, 32768
 v_exp_f32 v82, v82
 v_mfma_f32_16x16x32_bf16 v[100:103], v[44:47], a[116:119], v[100:103]
 ds_read_b64_tr_b16 v[68:69], v8 offset:22528
 s_lshl_b32 s45, s20, 13
 v_mfma_f32_16x16x32_bf16 v[100:103], v[48:51], a[132:135], v[100:103]
 s_add_u32 s44, s44, s45
 v_exp_f32 v83, v83
 v_mfma_f32_16x16x32_bf16 v[104:107], v[16:19], a[8:11], 0
 ds_read_b64_tr_b16 v[70:71], v8 offset:22784
 s_add_u32 s33, s44, 33575552
 v_mfma_f32_16x16x32_bf16 v[104:107], v[20:23], a[24:27], v[104:107]
 v_mul_f32 v176, v160, v176
 v_mul_f32 v177, v161, v177
 v_mfma_f32_16x16x32_bf16 v[104:107], v[24:27], a[40:43], v[104:107]
 ds_read_b64_tr_b16 v[72:73], v8 offset:23552
 v_mul_f32 v178, v162, v178
 v_mfma_f32_16x16x32_bf16 v[104:107], v[28:31], a[56:59], v[104:107]
 v_mul_f32 v179, v163, v179
 v_add_f32 v80, 1.0, v80
 v_mfma_f32_16x16x32_bf16 v[104:107], v[32:35], a[72:75], v[104:107]
 ds_read_b64_tr_b16 v[74:75], v8 offset:23808
 v_add_f32 v81, 1.0, v81
 v_mfma_f32_16x16x32_bf16 v[104:107], v[36:39], a[88:91], v[104:107]
 v_rcp_f32 v80, v80
 v_mfma_f32_16x16x32_bf16 v[104:107], v[40:43], a[104:107], v[104:107]
 ds_read_b64_tr_b16 v[76:77], v8 offset:24576
 v_add_f32 v82, 1.0, v82
 v_mfma_f32_16x16x32_bf16 v[104:107], v[44:47], a[120:123], v[104:107]
 v_rcp_f32 v81, v81
 v_mfma_f32_16x16x32_bf16 v[104:107], v[48:51], a[136:139], v[104:107]
 ds_read_b64_tr_b16 v[78:79], v8 offset:24832
 v_add_f32 v83, 1.0, v83
 v_mfma_f32_16x16x32_bf16 v[108:111], v[16:19], a[12:15], 0
 v_rcp_f32 v82, v82
 v_mfma_f32_16x16x32_bf16 v[108:111], v[20:23], a[28:31], v[108:111]
 ds_read_b64_tr_b16 v[16:17], v8 offset:25600
 v_mul_f32 v176, v176, v80
 v_mfma_f32_16x16x32_bf16 v[108:111], v[24:27], a[44:47], v[108:111]
 v_rcp_f32 v83, v83
 v_mfma_f32_16x16x32_bf16 v[108:111], v[28:31], a[60:63], v[108:111]
 ds_read_b64_tr_b16 v[18:19], v8 offset:25856
 s_add_u32 s57, s51, 0
 v_mfma_f32_16x16x32_bf16 v[108:111], v[32:35], a[76:79], v[108:111]
 s_add_u32 m0, s53, 36864
 v_mul_f32 v177, v177, v81
 v_mul_f32 v178, v178, v82
 v_mfma_f32_16x16x32_bf16 v[108:111], v[36:39], a[92:95], v[108:111]
 ds_read_b64_tr_b16 v[20:21], v8 offset:26624
 v_mul_f32 v179, v179, v83
 v_mfma_f32_16x16x32_bf16 v[108:111], v[40:43], a[108:111], v[108:111]
 buffer_load_dwordx4 v2, s[16:19], s57 offen lds
 v_mfma_f32_16x16x32_bf16 v[108:111], v[44:47], a[124:127], v[108:111]
 ds_read_b64_tr_b16 v[22:23], v8 offset:26880
 s_waitcnt vmcnt(3)
 s_barrier
 v_mfma_f32_16x16x32_bf16 v[108:111], v[48:51], a[140:143], v[108:111]
 s_waitcnt lgkmcnt(12)
 v_cvt_pk_bf16_f32 v88, v176, v177
 v_cvt_pk_bf16_f32 v89, v178, v179
 v_mfma_f32_16x16x32_bf16 v[112:115], v[52:55], a[0:3], 0
 ds_read_b64_tr_b16 v[24:25], v8 offset:9216
 v_mul_f32 v84, v192, v192
 v_mfma_f32_16x16x32_bf16 v[112:115], v[56:59], a[16:19], v[112:115]
 s_add_u32 m0, s53, 37888
 v_mul_f32 v85, v193, v193
 v_mul_f32 v86, v194, v194
 v_mfma_f32_16x16x32_bf16 v[112:115], v[60:63], a[32:35], v[112:115]
 ds_read_b64_tr_b16 v[26:27], v8 offset:9472
 s_waitcnt lgkmcnt(8)
 v_mfma_f32_16x16x32_bf16 v[112:115], v[64:67], a[48:51], v[112:115]
 buffer_load_dwordx4 v3, s[16:19], s57 offen lds
 v_mfma_f32_16x16x32_bf16 v[112:115], v[68:71], a[64:67], v[112:115]
 ds_read_b64_tr_b16 v[28:29], v8 offset:10240
 v_mul_f32 v87, v195, v195
 v_mfma_f32_16x16x32_bf16 v[112:115], v[72:75], a[80:83], v[112:115]
 s_waitcnt lgkmcnt(3)
 v_fma_f32 v84, v84, s30, v9
 v_fma_f32 v85, v85, s30, v9
 v_mfma_f32_16x16x32_bf16 v[112:115], v[76:79], a[96:99], v[112:115]
 ds_read_b64_tr_b16 v[30:31], v8 offset:10496
 v_fma_f32 v86, v86, s30, v9
 v_mfma_f32_16x16x32_bf16 v[112:115], v[16:19], a[112:115], v[112:115]
 v_fma_f32 v87, v87, s30, v9
 v_mul_f32 v84, v84, v192
 v_mfma_f32_16x16x32_bf16 v[112:115], v[20:23], a[128:131], v[112:115]
 ds_read_b64_tr_b16 v[32:33], v8 offset:11264
 v_mul_f32 v85, v85, v193
 v_mfma_f32_16x16x32_bf16 v[116:119], v[52:55], a[4:7], 0
 s_add_u32 m0, s53, 38912
 v_exp_f32 v84, v84
 v_mfma_f32_16x16x32_bf16 v[116:119], v[56:59], a[20:23], v[116:119]
 ds_read_b64_tr_b16 v[34:35], v8 offset:11520
 v_mul_f32 v86, v86, v194
 v_mfma_f32_16x16x32_bf16 v[116:119], v[60:63], a[36:39], v[116:119]
 buffer_load_dwordx4 v10, s[16:19], s57 offen lds
 v_mfma_f32_16x16x32_bf16 v[116:119], v[64:67], a[52:55], v[116:119]
 ds_read_b64_tr_b16 v[36:37], v8 offset:12288
 v_mul_f32 v87, v87, v195
 v_mfma_f32_16x16x32_bf16 v[116:119], v[68:71], a[68:71], v[116:119]
 v_exp_f32 v85, v85
 v_mfma_f32_16x16x32_bf16 v[116:119], v[72:75], a[84:87], v[116:119]
 ds_read_b64_tr_b16 v[38:39], v8 offset:12544
 v_mul_f32 v208, v192, v208
 v_mfma_f32_16x16x32_bf16 v[116:119], v[76:79], a[100:103], v[116:119]
 v_exp_f32 v86, v86
 v_mfma_f32_16x16x32_bf16 v[116:119], v[16:19], a[116:119], v[116:119]
 ds_read_b64_tr_b16 v[40:41], v8 offset:13312
 s_add_u32 m0, s53, 39936
 v_mfma_f32_16x16x32_bf16 v[116:119], v[20:23], a[132:135], v[116:119]
 buffer_load_dwordx4 v11, s[16:19], s57 offen lds
 v_mfma_f32_16x16x32_bf16 v[120:123], v[52:55], a[8:11], 0
 ds_read_b64_tr_b16 v[42:43], v8 offset:13568
 v_mul_f32 v209, v193, v209
 v_mfma_f32_16x16x32_bf16 v[120:123], v[56:59], a[24:27], v[120:123]
 v_exp_f32 v87, v87
 v_mfma_f32_16x16x32_bf16 v[120:123], v[60:63], a[40:43], v[120:123]
 ds_read_b64_tr_b16 v[44:45], v8 offset:14336
 v_mul_f32 v210, v194, v210
 v_mfma_f32_16x16x32_bf16 v[120:123], v[64:67], a[56:59], v[120:123]
 v_mul_f32 v211, v195, v211
 v_add_f32 v84, 1.0, v84
 v_mfma_f32_16x16x32_bf16 v[120:123], v[68:71], a[72:75], v[120:123]
 ds_read_b64_tr_b16 v[46:47], v8 offset:14592
 v_add_f32 v85, 1.0, v85
 v_mfma_f32_16x16x32_bf16 v[120:123], v[72:75], a[88:91], v[120:123]
 s_add_u32 s36, s26, 3072
 v_rcp_f32 v84, v84
 v_mfma_f32_16x16x32_bf16 v[120:123], v[76:79], a[104:107], v[120:123]
 ds_read_b64_tr_b16 v[48:49], v8 offset:15360
 s_add_u32 m0, s53, 40960
 v_mfma_f32_16x16x32_bf16 v[120:123], v[16:19], a[120:123], v[120:123]
 buffer_load_dwordx4 v12, s[16:19], s57 offen lds
 v_mfma_f32_16x16x32_bf16 v[120:123], v[20:23], a[136:139], v[120:123]
 ds_read_b64_tr_b16 v[50:51], v8 offset:15616
 v_add_f32 v86, 1.0, v86
 v_mfma_f32_16x16x32_bf16 v[124:127], v[52:55], a[12:15], 0
 v_rcp_f32 v85, v85
 v_mfma_f32_16x16x32_bf16 v[124:127], v[56:59], a[28:31], v[124:127]
 ds_read_b64_tr_b16 v[52:53], v8 offset:16384
 v_add_f32 v87, 1.0, v87
 v_mfma_f32_16x16x32_bf16 v[124:127], v[60:63], a[44:47], v[124:127]
 v_rcp_f32 v86, v86
 v_mfma_f32_16x16x32_bf16 v[124:127], v[64:67], a[60:63], v[124:127]
 ds_read_b64_tr_b16 v[54:55], v8 offset:16640
 v_mul_f32 v208, v208, v84
 v_mfma_f32_16x16x32_bf16 v[124:127], v[68:71], a[76:79], v[124:127]
 s_add_u32 m0, s53, 41984
 v_rcp_f32 v87, v87
 v_mfma_f32_16x16x32_bf16 v[124:127], v[72:75], a[92:95], v[124:127]
 ds_read_b64_tr_b16 v[56:57], v8 offset:17408
 v_mul_f32 v209, v209, v85
 v_mfma_f32_16x16x32_bf16 v[124:127], v[76:79], a[108:111], v[124:127]
 buffer_load_dwordx4 v13, s[16:19], s57 offen lds
 v_mfma_f32_16x16x32_bf16 v[124:127], v[16:19], a[124:127], v[124:127]
 ds_read_b64_tr_b16 v[58:59], v8 offset:17664
 v_mul_f32 v210, v210, v86
 v_mfma_f32_16x16x32_bf16 v[124:127], v[20:23], a[140:143], v[124:127]
 s_waitcnt lgkmcnt(12)
 v_mul_f32 v211, v211, v87
 v_cvt_pk_bf16_f32 v90, v208, v209
 v_mfma_f32_16x16x32_bf16 v[96:99], v[24:27], a[144:147], v[96:99]
 ds_read_b64_tr_b16 v[60:61], v8 offset:27648
 v_cvt_pk_bf16_f32 v91, v210, v211
 v_mfma_f32_16x16x32_bf16 v[96:99], v[28:31], a[160:163], v[96:99]
 buffer_store_dwordx4 v[88:91], v1, s[12:15], s36 offen sc1
 v_mfma_f32_16x16x32_bf16 v[96:99], v[32:35], a[176:179], v[96:99]
 ds_read_b64_tr_b16 v[62:63], v8 offset:27904
 s_waitcnt lgkmcnt(8)
 v_mfma_f32_16x16x32_bf16 v[96:99], v[36:39], a[192:195], v[96:99]
 s_add_u32 m0, s53, 43008
 v_mul_f32 v80, v164, v164
 v_mul_f32 v81, v165, v165
 v_mfma_f32_16x16x32_bf16 v[96:99], v[40:43], a[208:211], v[96:99]
 ds_read_b64_tr_b16 v[64:65], v8 offset:28672
 v_mfma_f32_16x16x32_bf16 v[96:99], v[44:47], a[224:227], v[96:99]
 s_waitcnt lgkmcnt(3)
 v_mul_f32 v82, v166, v166
 v_mul_f32 v83, v167, v167
 v_mfma_f32_16x16x32_bf16 v[96:99], v[48:51], a[240:243], v[96:99]
 ds_read_b64_tr_b16 v[66:67], v8 offset:28928
 v_fma_f32 v80, v80, s30, v9
 v_mfma_f32_16x16x32_bf16 v[96:99], v[52:55], v[224:227], v[96:99]
 buffer_load_dwordx4 v14, s[16:19], s57 offen lds
 v_mfma_f32_16x16x32_bf16 v[96:99], v[56:59], v[240:243], v[96:99]
 ds_read_b64_tr_b16 v[68:69], v8 offset:29696
 s_waitcnt vmcnt(8)
 v_xor_b32 v128, s60, v128
 v_xor_b32 v129, s60, v129
 v_xor_b32 v130, s60, v130
 v_xor_b32 v131, s60, v131
 v_or3_b32 v128, v128, v129, v130
 v_or_b32 v128, v128, v131
 v_cmp_eq_u32_e64 s[62:63], 0, v128
 s_nop 0
 s_cmp_eq_u64 s[62:63], exec
 s_cbranch_scc0 L_poll1
L_back1:
 v_mfma_f32_16x16x32_bf16 v[100:103], v[24:27], a[148:151], v[100:103]
 s_add_u32 s45, s33, 0
 v_fma_f32 v81, v81, s30, v9
 v_fma_f32 v82, v82, s30, v9
 v_mfma_f32_16x16x32_bf16 v[100:103], v[28:31], a[164:167], v[100:103]
 ds_read_b64_tr_b16 v[70:71], v8 offset:29952
 v_fma_f32 v83, v83, s30, v9
 v_mfma_f32_16x16x32_bf16 v[100:103], v[32:35], a[180:183], v[100:103]
 buffer_load_dwordx4 v[128:131], v1, s[12:15], s45 offen sc1
 v_mul_f32 v80, v80, v164
 v_mfma_f32_16x16x32_bf16 v[100:103], v[36:39], a[196:199], v[100:103]
 ds_read_b64_tr_b16 v[72:73], v8 offset:30720
 s_add_u32 m0, s53, 44032
 v_mfma_f32_16x16x32_bf16 v[100:103], v[40:43], a[212:215], v[100:103]
 buffer_load_dwordx4 v15, s[16:19], s57 offen lds
 v_mfma_f32_16x16x32_bf16 v[100:103], v[44:47], a[228:231], v[100:103]
 ds_read_b64_tr_b16 v[74:75], v8 offset:30976
 s_add_u32 s45, s33, 1024
 v_mfma_f32_16x16x32_bf16 v[100:103], v[48:51], a[244:247], v[100:103]
 buffer_load_dwordx4 v[132:135], v1, s[12:15], s45 offen sc1
 v_mul_f32 v81, v81, v165
 v_mfma_f32_16x16x32_bf16 v[100:103], v[52:55], v[228:231], v[100:103]
 ds_read_b64_tr_b16 v[76:77], v8 offset:31744
 v_mul_f32 v82, v82, v166
 v_mfma_f32_16x16x32_bf16 v[100:103], v[56:59], v[244:247], v[100:103]
 v_exp_f32 v80, v80
 v_mfma_f32_16x16x32_bf16 v[104:107], v[24:27], a[152:155], v[104:107]
 ds_read_b64_tr_b16 v[78:79], v8 offset:32000
 v_mul_f32 v83, v83, v167
 v_mfma_f32_16x16x32_bf16 v[104:107], v[28:31], a[168:171], v[104:107]
 v_exp_f32 v81, v81
 v_mfma_f32_16x16x32_bf16 v[104:107], v[32:35], a[184:187], v[104:107]
 ds_read_b64_tr_b16 v[16:17], v8 offset:32768
 s_add_u32 s45, s33, 2048
 v_mfma_f32_16x16x32_bf16 v[104:107], v[36:39], a[200:203], v[104:107]
 buffer_load_dwordx4 v[136:139], v1, s[12:15], s45 offen sc1
 v_mul_f32 v180, v164, v180
 v_mfma_f32_16x16x32_bf16 v[104:107], v[40:43], a[216:219], v[104:107]
 ds_read_b64_tr_b16 v[18:19], v8 offset:33024
 v_mul_f32 v181, v165, v181
 v_mfma_f32_16x16x32_bf16 v[104:107], v[44:47], a[232:235], v[104:107]
 v_exp_f32 v82, v82
 v_mfma_f32_16x16x32_bf16 v[104:107], v[48:51], a[248:251], v[104:107]
 ds_read_b64_tr_b16 v[20:21], v8 offset:33792
 v_mul_f32 v182, v166, v182
 v_mfma_f32_16x16x32_bf16 v[104:107], v[52:55], v[232:235], v[104:107]
 v_exp_f32 v83, v83
 v_mfma_f32_16x16x32_bf16 v[104:107], v[56:59], v[248:251], v[104:107]
 ds_read_b64_tr_b16 v[22:23], v8 offset:34048
 s_add_u32 s45, s33, 3072
 v_mfma_f32_16x16x32_bf16 v[108:111], v[24:27], a[156:159], v[108:111]
 buffer_load_dwordx4 v[140:143], v1, s[12:15], s45 offen sc1
 v_mul_f32 v183, v167, v183
 v_mfma_f32_16x16x32_bf16 v[108:111], v[28:31], a[172:175], v[108:111]
 ds_read_b64_tr_b16 v[24:25], v8 offset:34816
 v_add_f32 v80, 1.0, v80
 v_mfma_f32_16x16x32_bf16 v[108:111], v[32:35], a[188:191], v[108:111]
 v_rcp_f32 v80, v80
 v_mfma_f32_16x16x32_bf16 v[108:111], v[36:39], a[204:207], v[108:111]
 ds_read_b64_tr_b16 v[26:27], v8 offset:35072
 v_add_f32 v81, 1.0, v81
 v_mfma_f32_16x16x32_bf16 v[108:111], v[40:43], a[220:223], v[108:111]
 v_rcp_f32 v81, v81
 v_mfma_f32_16x16x32_bf16 v[108:111], v[44:47], a[236:239], v[108:111]
 ds_read_b64_tr_b16 v[28:29], v8 offset:35840
 s_add_u32 s45, s33, 4096
 v_mfma_f32_16x16x32_bf16 v[108:111], v[48:51], a[252:255], v[108:111]
 buffer_load_dwordx4 v[144:147], v1, s[12:15], s45 offen sc1
 v_add_f32 v82, 1.0, v82
 v_mfma_f32_16x16x32_bf16 v[108:111], v[52:55], v[236:239], v[108:111]
 ds_read_b64_tr_b16 v[30:31], v8 offset:36096
 v_add_f32 v83, 1.0, v83
 v_mfma_f32_16x16x32_bf16 v[108:111], v[56:59], v[252:255], v[108:111]
 s_waitcnt lgkmcnt(12)
 v_rcp_f32 v82, v82
 v_mfma_f32_16x16x32_bf16 v[112:115], v[60:63], a[144:147], v[112:115]
 v_rcp_f32 v83, v83
 v_mfma_f32_16x16x32_bf16 v[112:115], v[64:67], a[160:163], v[112:115]
 v_mul_f32 v180, v180, v80
 v_mul_f32 v181, v181, v81
 v_mfma_f32_16x16x32_bf16 v[112:115], v[68:71], a[176:179], v[112:115]
 s_add_u32 s45, s33, 5120
 s_waitcnt lgkmcnt(6)
 v_mul_f32 v182, v182, v82
 v_mfma_f32_16x16x32_bf16 v[112:115], v[72:75], a[192:195], v[112:115]
 buffer_load_dwordx4 v[148:151], v1, s[12:15], s45 offen sc1
 v_mul_f32 v183, v183, v83
 v_mfma_f32_16x16x32_bf16 v[112:115], v[76:79], a[208:211], v[112:115]
 v_cvt_pk_bf16_f32 v92, v180, v181
 v_cvt_pk_bf16_f32 v93, v182, v183
 v_mfma_f32_16x16x32_bf16 v[112:115], v[16:19], a[224:227], v[112:115]
 s_waitcnt lgkmcnt(0)
 v_mul_f32 v84, v196, v196
 v_mul_f32 v85, v197, v197
 v_mfma_f32_16x16x32_bf16 v[112:115], v[20:23], a[240:243], v[112:115]
 v_mul_f32 v86, v198, v198
 v_mul_f32 v87, v199, v199
 v_mfma_f32_16x16x32_bf16 v[112:115], v[24:27], v[224:227], v[112:115]
 v_fma_f32 v84, v84, s30, v9
 v_fma_f32 v85, v85, s30, v9
 v_mfma_f32_16x16x32_bf16 v[112:115], v[28:31], v[240:243], v[112:115]
 s_add_u32 s45, s33, 6144
 v_fma_f32 v86, v86, s30, v9
 v_fma_f32 v87, v87, s30, v9
 v_mfma_f32_16x16x32_bf16 v[116:119], v[60:63], a[148:151], v[116:119]
 buffer_load_dwordx4 v[152:155], v1, s[12:15], s45 offen sc1
 v_mul_f32 v84, v84, v196
 v_mfma_f32_16x16x32_bf16 v[116:119], v[64:67], a[164:167], v[116:119]
 v_exp_f32 v84, v84
 v_mfma_f32_16x16x32_bf16 v[116:119], v[68:71], a[180:183], v[116:119]
 v_mul_f32 v85, v85, v197
 v_mul_f32 v86, v86, v198
 v_mfma_f32_16x16x32_bf16 v[116:119], v[72:75], a[196:199], v[116:119]
 v_exp_f32 v85, v85
 v_mfma_f32_16x16x32_bf16 v[116:119], v[76:79], a[212:215], v[116:119]
 v_exp_f32 v86, v86
 v_mfma_f32_16x16x32_bf16 v[116:119], v[16:19], a[228:231], v[116:119]
 s_add_u32 s45, s33, 7168
 v_mul_f32 v87, v87, v199
 v_mul_f32 v212, v196, v212
 v_mfma_f32_16x16x32_bf16 v[116:119], v[20:23], a[244:247], v[116:119]
 buffer_load_dwordx4 v[156:159], v1, s[12:15], s45 offen sc1
 v_mul_f32 v213, v197, v213
 v_mfma_f32_16x16x32_bf16 v[116:119], v[24:27], v[228:231], v[116:119]
 s_barrier
 v_mul_f32 v214, v198, v214
 v_mfma_f32_16x16x32_bf16 v[116:119], v[28:31], v[244:247], v[116:119]
 s_add_u32 s43, s31, 4096
 v_mov_b32 v5, s60
 s_cmp_eq_u32 s20, 0
 s_cselect_b32 s77, s43, 0x7ff00000
 s_mov_b64 exec, 1
 buffer_store_dword v5, v1, s[12:15], s77 offen offset:0 sc1
 s_mov_b64 exec, -1
 v_exp_f32 v87, v87
 v_mfma_f32_16x16x32_bf16 v[120:123], v[60:63], a[152:155], v[120:123]
 v_mul_f32 v215, v199, v215
 v_add_f32 v84, 1.0, v84
 v_mfma_f32_16x16x32_bf16 v[120:123], v[64:67], a[168:171], v[120:123]
 s_add_u32 s37, s26, 150528
 v_rcp_f32 v84, v84
 v_mfma_f32_16x16x32_bf16 v[120:123], v[68:71], a[184:187], v[120:123]
 v_add_f32 v85, 1.0, v85
 v_add_f32 v86, 1.0, v86
 v_mfma_f32_16x16x32_bf16 v[120:123], v[72:75], a[200:203], v[120:123]
 v_rcp_f32 v85, v85
 v_mfma_f32_16x16x32_bf16 v[120:123], v[76:79], a[216:219], v[120:123]
 v_rcp_f32 v86, v86
 v_mfma_f32_16x16x32_bf16 v[120:123], v[16:19], a[232:235], v[120:123]
 v_add_f32 v87, 1.0, v87
 v_mul_f32 v212, v212, v84
 v_mfma_f32_16x16x32_bf16 v[120:123], v[20:23], a[248:251], v[120:123]
 v_rcp_f32 v87, v87
 v_mfma_f32_16x16x32_bf16 v[120:123], v[24:27], v[232:235], v[120:123]
 v_mul_f32 v213, v213, v85
 v_mul_f32 v214, v214, v86
 v_mfma_f32_16x16x32_bf16 v[120:123], v[28:31], v[248:251], v[120:123]
 v_mul_f32 v215, v215, v87
 v_cvt_pk_bf16_f32 v94, v212, v213
 v_mfma_f32_16x16x32_bf16 v[124:127], v[60:63], a[156:159], v[124:127]
 v_cvt_pk_bf16_f32 v95, v214, v215
 v_mul_f32 v80, v168, v168
 v_mfma_f32_16x16x32_bf16 v[124:127], v[64:67], a[172:175], v[124:127]
 buffer_store_dwordx4 v[92:95], v1, s[12:15], s37 offen sc1
 v_mfma_f32_16x16x32_bf16 v[124:127], v[68:71], a[188:191], v[124:127]
 v_mul_f32 v81, v169, v169
 v_mul_f32 v82, v170, v170
 v_mfma_f32_16x16x32_bf16 v[124:127], v[72:75], a[204:207], v[124:127]
 v_mul_f32 v83, v171, v171
 v_fma_f32 v80, v80, s30, v9
 v_mfma_f32_16x16x32_bf16 v[124:127], v[76:79], a[220:223], v[124:127]
 v_fma_f32 v81, v81, s30, v9
 v_fma_f32 v82, v82, s30, v9
 v_mfma_f32_16x16x32_bf16 v[124:127], v[16:19], a[236:239], v[124:127]
 v_fma_f32 v83, v83, s30, v9
 v_mul_f32 v80, v80, v168
 v_mfma_f32_16x16x32_bf16 v[124:127], v[20:23], a[252:255], v[124:127]
 v_exp_f32 v80, v80
 v_mfma_f32_16x16x32_bf16 v[124:127], v[24:27], v[236:239], v[124:127]
 v_mul_f32 v81, v81, v169
 v_mul_f32 v82, v82, v170
 v_mfma_f32_16x16x32_bf16 v[124:127], v[28:31], v[252:255], v[124:127]
 v_exp_f32 v81, v81
 v_and_b32 v16, 15, v0
 v_lshrrev_b32 v17, 4, v0
 v_lshrrev_b32 v18, 2, v16
 v_lshl_add_u32 v18, v17, 2, v18
 v_mul_u32_u24 v18, 288, v18
 v_and_b32 v19, 3, v0
 v_lshl_add_u32 v6, v19, 3, v18
 v_mul_u32_u24 v18, 304, v16
 v_lshl_add_u32 v18, v17, 3, v18
 s_and_b32 s46, s20, 1
 s_mul_i32 s46, s46, 9728
 s_cmp_ge_u32 s20, 2
 s_cselect_b32 s59, 4294930432, 0
 s_add_u32 s46, s46, s59
 s_add_u32 s46, s46, 110592
 v_add_u32 v7, s46, v18
 v_lshlrev_b32 v8, 3, v0
 v_add_u32 v16, 512, v0
 v_mul_u32_u24 v17, 3641, v16
 v_lshrrev_b32 v17, 16, v17
 v_mul_u32_u24 v18, 18, v17
 v_sub_u32 v18, v16, v18
 v_mul_u32_u24 v19, 1152, v17
 v_lshl_add_u32 v5, v18, 4, v19
 s_add_u32 s57, s51, 0
 s_add_u32 m0, s53, 45056
 s_nop 0
 buffer_load_dwordx4 v5, s[16:19], s57 offen lds
 s_add_u32 s57, s51, 663552
 s_add_u32 m0, s53, 81920
 s_nop 0
 buffer_load_dwordx4 v5, s[16:19], s57 offen lds
 s_add_u32 s57, s51, 36864
 s_add_u32 m0, s53, 118784
 s_nop 0
 buffer_load_dwordx4 v5, s[16:19], s57 offen lds
 v_and_b32 v225, 7, v0
 v_lshlrev_b32 v225, 2, v225
 buffer_load_dword v224, v225, s[12:15], s32 offen offset:0 sc1
 v_bfe_u32 v226, v0, 3, 1
 v_mul_u32_u24 v226, 147456, v226
 v_and_b32 v227, 7, v0
 v_lshl_add_u32 v226, v227, 7, v226
 v_bfe_u32 v227, v0, 4, 1
 v_mul_u32_u24 v227, 18432, v227
 v_add_u32 v226, v226, v227
 v_lshrrev_b32 v227, 5, v0
 v_lshl_add_u32 v226, v227, 10, v226
 v_lshlrev_b32 v244, 4, v0
 v_mul_f32 v83, v83, v171
 v_add_u32 v244, 147456, v244
 v_exp_f32 v82, v82
 ds_read_b128 v[16:19], v244 offset:0
 v_exp_f32 v83, v83
 ds_read_b128 v[20:23], v244 offset:1024
 v_mul_f32 v184, v168, v184
 ds_read_b128 v[24:27], v244 offset:2048
 v_mul_f32 v185, v169, v185
 ds_read_b128 v[28:31], v244 offset:3072
 v_mul_f32 v186, v170, v186
 s_add_u32 s57, s51, 663552
 s_add_u32 m0, s53, 73728
 s_nop 0
 buffer_load_dwordx4 v2, s[16:19], s57 offen lds
 s_waitcnt lgkmcnt(0)
 v_mul_f32 v36, 0x35638e39, v28
 v_mul_f32 v187, v171, v187
 v_mul_f32 v32, 0x35638e39, v24
 v_add_f32 v80, 1.0, v80
 v_mul_f32 v37, 0x35638e39, v29
 v_add_f32 v81, 1.0, v81
 v_mul_f32 v33, 0x35638e39, v25
 v_add_f32 v82, 1.0, v82
 v_mul_f32 v38, 0x35638e39, v30
 v_add_f32 v83, 1.0, v83
 v_mul_f32 v34, 0x35638e39, v26
 v_rcp_f32 v80, v80
 v_mul_f32 v39, 0x35638e39, v31
 v_rcp_f32 v81, v81
 v_mul_f32 v35, 0x35638e39, v27
 v_rcp_f32 v82, v82
 v_and_b32 v244, 15, v0
 v_rcp_f32 v83, v83
 v_lshrrev_b32 v245, 4, v0
 v_mul_f32 v184, v184, v80
 s_add_u32 m0, s53, 74752
 s_nop 0
 buffer_load_dwordx4 v3, s[16:19], s57 offen lds
 v_lshlrev_b32 v248, 6, v244
 v_mul_f32 v185, v185, v81
 v_lshl_add_u32 v248, v245, 4, v248
 v_mul_f32 v186, v186, v82
 s_mul_i32 s46, s20, 1040
 v_mul_f32 v187, v187, v83
 s_add_u32 s47, s46, 0
 v_cvt_pk_bf16_f32 v88, v184, v185
 v_add_u32 v40, s47, v248
 v_cvt_pk_bf16_f32 v89, v186, v187
 s_lshl_b32 s45, s20, 10
 v_mul_f32 v84, v200, v200
 s_add_u32 s45, s45, 24960
 v_mul_f32 v85, v201, v201
 v_add_u32 v44, s45, v248
 v_mul_f32 v86, v202, v202
 v_lshlrev_b32 v249, 8, v245
 v_mul_f32 v87, v203, v203
 v_lshl_add_u32 v249, v244, 2, v249
 v_fma_f32 v84, v84, s30, v9
 s_add_u32 m0, s53, 75776
 s_nop 0
 buffer_load_dwordx4 v10, s[16:19], s57 offen lds
 v_add_u32 v41, s45, v249
 v_fma_f32 v85, v85, s30, v9
 v_add_u32 v42, s47, v249
 v_fma_f32 v86, v86, s30, v9
 v_and_b32 v248, 7, v0
 v_fma_f32 v87, v87, s30, v9
 v_mul_u32_u24 v248, 2080, v248
 v_mul_f32 v84, v84, v200
 v_lshrrev_b32 v249, 3, v0
 v_mul_f32 v85, v85, v201
 v_lshl_add_u32 v248, v249, 2, v248
 v_mul_f32 v86, v86, v202
 s_lshl_b32 s46, s20, 8
 v_mul_f32 v87, v87, v203
 s_add_u32 s46, s46, 0
 v_exp_f32 v84, v84
 v_add_u32 v43, s46, v248
 v_exp_f32 v85, v85
 s_mul_i32 s46, s20, 192
 v_exp_f32 v86, v86
 s_add_u32 m0, s53, 76800
 s_nop 0
 buffer_load_dwordx4 v11, s[16:19], s57 offen lds
 s_add_u32 s46, s46, 0
 v_exp_f32 v87, v87
 v_add_u32 v248, s46, v0
 v_mul_f32 v216, v200, v216
 v_mul_u32_u24 v249, 21846, v248
 v_mul_f32 v217, v201, v217
 v_lshrrev_b32 v249, 16, v249
 v_mul_f32 v218, v202, v218
 v_mul_u32_u24 v250, 3, v249
 v_mul_f32 v219, v203, v219
 v_sub_u32 v250, v248, v250
 v_add_f32 v84, 1.0, v84
 v_mul_u32_u24 v250, 4160, v250
 v_add_f32 v85, 1.0, v85
 v_lshl_add_u32 v250, v249, 2, v250
 v_add_f32 v86, 1.0, v86
 v_add_u32 v45, 0, v250
 v_add_f32 v87, 1.0, v87
 s_mul_i32 s46, s20, 192
 v_rcp_f32 v84, v84
 s_add_u32 m0, s53, 77824
 s_nop 0
 buffer_load_dwordx4 v12, s[16:19], s57 offen lds
 s_add_u32 s46, s46, 64
 v_rcp_f32 v85, v85
 v_add_u32 v248, s46, v0
 v_rcp_f32 v86, v86
 v_mul_u32_u24 v249, 21846, v248
 v_rcp_f32 v87, v87
 v_lshrrev_b32 v249, 16, v249
 v_mul_f32 v216, v216, v84
 v_mul_u32_u24 v250, 3, v249
 v_mul_f32 v217, v217, v85
 v_sub_u32 v250, v248, v250
 v_mul_f32 v218, v218, v86
 v_mul_u32_u24 v250, 4160, v250
 v_mul_f32 v219, v219, v87
 v_lshl_add_u32 v250, v249, 2, v250
 v_cvt_pk_bf16_f32 v90, v216, v217
 v_add_u32 v46, 0, v250
 v_cvt_pk_bf16_f32 v91, v218, v219
 s_mul_i32 s46, s20, 192
 s_add_u32 s36, s26, 297984
 s_add_u32 m0, s53, 78848
 s_nop 0
 buffer_load_dwordx4 v13, s[16:19], s57 offen lds
 s_add_u32 s46, s46, 128
 v_mul_f32 v80, v172, v172
 v_add_u32 v248, s46, v0
 buffer_store_dwordx4 v[88:91], v1, s[12:15], s36 offen sc1
 v_mul_u32_u24 v249, 21846, v248
 v_mul_f32 v81, v173, v173
 v_lshrrev_b32 v249, 16, v249
 v_mul_f32 v82, v174, v174
 v_mul_u32_u24 v250, 3, v249
 v_mul_f32 v83, v175, v175
 v_sub_u32 v250, v248, v250
 v_fma_f32 v80, v80, s30, v9
 v_mul_u32_u24 v250, 4160, v250
 v_fma_f32 v81, v81, s30, v9
 v_lshl_add_u32 v250, v249, 2, v250
 v_fma_f32 v82, v82, s30, v9
 v_add_u32 v47, 0, v250
 v_fma_f32 v83, v83, s30, v9
 s_barrier
 v_mul_f32 v80, v80, v172
 s_add_u32 m0, s53, 79872
 s_nop 0
 buffer_load_dwordx4 v14, s[16:19], s57 offen lds
 s_mov_b32 s46, 0x3f3f3f3f
 v_mul_f32 v81, v81, v173
 s_mov_b32 s47, 0x3f3f3f3f
 v_mul_f32 v82, v82, v174
 s_waitcnt vmcnt(14)
 s_mov_b64 exec, s[46:47]
 ds_write_b32 v43, v128 offset:0
 ds_write_b32 v43, v129 offset:12480
 ds_write_b32 v43, v130 offset:1040
 ds_write_b32 v43, v131 offset:13520
 ds_write_b32 v43, v132 offset:32
 ds_write_b32 v43, v133 offset:12512
 ds_write_b32 v43, v134 offset:1072
 ds_write_b32 v43, v135 offset:13552
 ds_write_b32 v43, v136 offset:64
 ds_write_b32 v43, v137 offset:12544
 ds_write_b32 v43, v138 offset:1104
 ds_write_b32 v43, v139 offset:13584
 ds_write_b32 v43, v140 offset:96
 ds_write_b32 v43, v141 offset:12576
 ds_write_b32 v43, v142 offset:1136
 ds_write_b32 v43, v143 offset:13616
 ds_write_b32 v43, v144 offset:128
 ds_write_b32 v43, v145 offset:12608
 ds_write_b32 v43, v146 offset:1168
 ds_write_b32 v43, v147 offset:13648
 ds_write_b32 v43, v148 offset:160
 ds_write_b32 v43, v149 offset:12640
 ds_write_b32 v43, v150 offset:1200
 ds_write_b32 v43, v151 offset:13680
 ds_write_b32 v43, v152 offset:192
 ds_write_b32 v43, v153 offset:12672
 ds_write_b32 v43, v154 offset:1232
 ds_write_b32 v43, v155 offset:13712
 ds_write_b32 v43, v156 offset:224
 ds_write_b32 v43, v157 offset:12704
 ds_write_b32 v43, v158 offset:1264
 ds_write_b32 v43, v159 offset:13744
 s_mov_b64 exec, -1
 v_mul_f32 v83, v83, v175
 s_waitcnt lgkmcnt(0)
 s_barrier
 v_exp_f32 v80, v80
 s_waitcnt vmcnt(8)
 v_cmp_eq_u32_e64 s[62:63], s60, v224
 s_nop 0
 s_cmp_eq_u64 s[62:63], exec
 s_cbranch_scc0 L_poll2
L_back2:
 ds_read_b128 v[48:51], v40 offset:0
 v_exp_f32 v81, v81
 s_add_u32 m0, s53, 80896
 s_nop 0
 buffer_load_dwordx4 v15, s[16:19], s57 offen lds
 ds_read_b128 v[52:55], v40 offset:4160
 v_exp_f32 v82, v82
 ds_read_b128 v[56:59], v40 offset:8320
 v_exp_f32 v83, v83
 ds_read_b128 v[60:63], v40 offset:12480
 v_mul_f32 v188, v172, v188
 ds_read_b128 v[64:67], v40 offset:16640
 v_mul_f32 v189, v173, v189
 ds_read_b128 v[68:71], v40 offset:20800
 v_mul_f32 v190, v174, v190
 s_waitcnt lgkmcnt(5)
 v_mfma_f32_16x16x32_bf16 v[128:131], v[48:51], v[16:19], 0
 v_mul_f32 v191, v175, v191
 v_mfma_f32_16x16x32_bf16 v[140:143], v[48:51], v[20:23], 0
 v_add_f32 v80, 1.0, v80
 s_waitcnt lgkmcnt(4)
 v_mfma_f32_16x16x32_bf16 v[132:135], v[52:55], v[16:19], 0
 v_add_f32 v81, 1.0, v81
 v_mfma_f32_16x16x32_bf16 v[144:147], v[52:55], v[20:23], 0
 v_add_f32 v82, 1.0, v82
 s_waitcnt lgkmcnt(3)
 v_mfma_f32_16x16x32_bf16 v[136:139], v[56:59], v[16:19], 0
 v_add_f32 v83, 1.0, v83
 s_add_u32 s57, s51, 36864
 s_add_u32 m0, s53, 110592
 s_nop 0
 buffer_load_dwordx4 v2, s[16:19], s57 offen lds
 v_mfma_f32_16x16x32_bf16 v[148:151], v[56:59], v[20:23], 0
 v_rcp_f32 v80, v80
 v_mul_f32 v244, v140, v28
 v_rcp_f32 v81, v81
 v_mul_f32 v140, v140, v24
 v_rcp_f32 v82, v82
 v_fma_f32 v140, v128, v28, v140
 v_rcp_f32 v83, v83
 v_fma_f32 v128, v128, v24, -v244
 v_mul_f32 v188, v188, v80
 v_mul_f32 v245, v141, v29
 v_mul_f32 v189, v189, v81
 v_mul_f32 v141, v141, v25
 v_mul_f32 v190, v190, v82
 v_fma_f32 v141, v129, v29, v141
 v_mul_f32 v191, v191, v83
 v_fma_f32 v129, v129, v25, -v245
 v_cvt_pk_bf16_f32 v92, v188, v189
 v_mul_f32 v246, v142, v30
 v_cvt_pk_bf16_f32 v93, v190, v191
 s_add_u32 m0, s53, 111616
 s_nop 0
 buffer_load_dwordx4 v3, s[16:19], s57 offen lds
 v_mul_f32 v142, v142, v26
 v_mul_f32 v84, v204, v204
 v_fma_f32 v142, v130, v30, v142
 v_mul_f32 v85, v205, v205
 v_fma_f32 v130, v130, v26, -v246
 v_mul_f32 v86, v206, v206
 v_mul_f32 v247, v143, v31
 v_mul_f32 v87, v207, v207
 v_mul_f32 v143, v143, v27
 v_fma_f32 v84, v84, s30, v9
 v_fma_f32 v143, v131, v31, v143
 v_fma_f32 v85, v85, s30, v9
 v_fma_f32 v131, v131, v27, -v247
 v_fma_f32 v86, v86, s30, v9
 v_cvt_pk_bf16_f32 v232, v128, v140
 v_fma_f32 v87, v87, s30, v9
 v_cvt_pk_bf16_f32 v233, v129, v141
 v_mul_f32 v84, v84, v204
 v_cvt_pk_bf16_f32 v234, v130, v142
 v_mul_f32 v85, v85, v205
 s_add_u32 m0, s53, 112640
 s_nop 0
 buffer_load_dwordx4 v10, s[16:19], s57 offen lds
 v_cvt_pk_bf16_f32 v235, v131, v143
 v_mul_f32 v86, v86, v206
 v_mul_f32 v244, v144, v28
 v_mul_f32 v87, v87, v207
 v_mul_f32 v144, v144, v24
 v_exp_f32 v84, v84
 v_fma_f32 v144, v132, v28, v144
 v_exp_f32 v85, v85
 v_fma_f32 v132, v132, v24, -v244
 v_exp_f32 v86, v86
 v_mul_f32 v245, v145, v29
 v_exp_f32 v87, v87
 v_mul_f32 v145, v145, v25
 v_mul_f32 v220, v204, v220
 v_fma_f32 v145, v133, v29, v145
 v_mul_f32 v221, v205, v221
 v_fma_f32 v133, v133, v25, -v245
 v_mul_f32 v222, v206, v222
 v_mul_f32 v246, v146, v30
 v_mul_f32 v223, v207, v223
 s_add_u32 m0, s53, 113664
 s_nop 0
 buffer_load_dwordx4 v11, s[16:19], s57 offen lds
 v_mul_f32 v146, v146, v26
 v_add_f32 v84, 1.0, v84
 v_fma_f32 v146, v134, v30, v146
 v_add_f32 v85, 1.0, v85
 v_fma_f32 v134, v134, v26, -v246
 v_add_f32 v86, 1.0, v86
 v_mul_f32 v247, v147, v31
 v_add_f32 v87, 1.0, v87
 v_mul_f32 v147, v147, v27
 v_rcp_f32 v84, v84
 v_fma_f32 v147, v135, v31, v147
 v_rcp_f32 v85, v85
 v_fma_f32 v135, v135, v27, -v247
 v_rcp_f32 v86, v86
 v_cvt_pk_bf16_f32 v236, v132, v144
 v_rcp_f32 v87, v87
 v_cvt_pk_bf16_f32 v237, v133, v145
 v_mul_f32 v220, v220, v84
 v_cvt_pk_bf16_f32 v238, v134, v146
 v_mul_f32 v221, v221, v85
 s_add_u32 m0, s53, 114688
 s_nop 0
 buffer_load_dwordx4 v12, s[16:19], s57 offen lds
 v_cvt_pk_bf16_f32 v239, v135, v147
 v_mul_f32 v222, v222, v86
 v_mul_f32 v244, v148, v28
 v_mul_f32 v223, v223, v87
 v_mul_f32 v148, v148, v24
 v_cvt_pk_bf16_f32 v94, v220, v221
 v_fma_f32 v148, v136, v28, v148
 v_cvt_pk_bf16_f32 v95, v222, v223
 v_fma_f32 v136, v136, v24, -v244
 s_add_u32 s37, s26, 445440
 v_mul_f32 v245, v149, v29
 v_mul_f32 v80, v96, v96
 v_mul_f32 v149, v149, v25
 buffer_store_dwordx4 v[92:95], v1, s[12:15], s37 offen sc1
 v_fma_f32 v149, v137, v29, v149
 v_mul_f32 v81, v97, v97
 v_fma_f32 v137, v137, v25, -v245
 v_mul_f32 v82, v98, v98
 v_mul_f32 v246, v150, v30
 v_mul_f32 v83, v99, v99
 s_add_u32 m0, s53, 115712
 s_nop 0
 buffer_load_dwordx4 v13, s[16:19], s57 offen lds
 v_mul_f32 v150, v150, v26
 v_fma_f32 v80, v80, s30, v9
 v_fma_f32 v150, v138, v30, v150
 v_fma_f32 v81, v81, s30, v9
 v_fma_f32 v138, v138, v26, -v246
 v_fma_f32 v82, v82, s30, v9
 v_mul_f32 v247, v151, v31
 v_fma_f32 v83, v83, s30, v9
 v_mul_f32 v151, v151, v27
 v_mul_f32 v80, v80, v96
 v_fma_f32 v151, v139, v31, v151
 v_mul_f32 v81, v81, v97
 v_fma_f32 v139, v139, v27, -v247
 v_mul_f32 v82, v82, v98
 v_cvt_pk_bf16_f32 v240, v136, v148
 v_mul_f32 v83, v83, v99
 v_cvt_pk_bf16_f32 v241, v137, v149
 v_exp_f32 v80, v80
 v_cvt_pk_bf16_f32 v242, v138, v150
 v_exp_f32 v81, v81
 s_add_u32 m0, s53, 116736
 s_nop 0
 buffer_load_dwordx4 v14, s[16:19], s57 offen lds
 v_cvt_pk_bf16_f32 v243, v139, v151
 v_exp_f32 v82, v82
 v_mfma_f32_16x16x32_bf16 v[128:131], v[16:19], v[232:235], 0
 v_exp_f32 v83, v83
 v_mfma_f32_16x16x32_bf16 v[140:143], v[20:23], v[232:235], 0
 v_mul_f32 v112, v96, v112
 v_mfma_f32_16x16x32_bf16 v[132:135], v[16:19], v[236:239], 0
 v_mul_f32 v113, v97, v113
 v_mfma_f32_16x16x32_bf16 v[144:147], v[20:23], v[236:239], 0
 v_mul_f32 v114, v98, v114
 v_mfma_f32_16x16x32_bf16 v[136:139], v[16:19], v[240:243], 0
 v_mul_f32 v115, v99, v115
 v_mfma_f32_16x16x32_bf16 v[148:151], v[20:23], v[240:243], 0
 v_add_f32 v80, 1.0, v80
 s_waitcnt lgkmcnt(2)
 v_lshlrev_b32 v244, 16, v60
 v_add_f32 v81, 1.0, v81
 v_and_b32 v245, 0xffff0000, v60
 v_add_f32 v82, 1.0, v82
 v_mul_f32 v252, v140, v245
 v_add_f32 v83, 1.0, v83
 s_add_u32 m0, s53, 117760
 s_nop 0
 buffer_load_dwordx4 v15, s[16:19], s57 offen lds
 v_mul_f32 v140, v140, v244
 v_rcp_f32 v80, v80
 v_fma_f32 v140, v128, v245, v140
 v_rcp_f32 v81, v81
 v_fma_f32 v128, v128, v244, -v252
 v_rcp_f32 v82, v82
 v_lshlrev_b32 v246, 16, v61
 v_rcp_f32 v83, v83
 v_and_b32 v247, 0xffff0000, v61
 v_mul_f32 v112, v112, v80
 v_mul_f32 v253, v141, v247
 v_mul_f32 v113, v113, v81
 v_mul_f32 v141, v141, v246
 v_mul_f32 v114, v114, v82
 v_fma_f32 v141, v129, v247, v141
 v_mul_f32 v115, v115, v83
 v_fma_f32 v129, v129, v246, -v253
 v_cvt_pk_bf16_f32 v88, v112, v113
 v_lshlrev_b32 v248, 16, v62
 v_cvt_pk_bf16_f32 v89, v114, v115
 v_and_b32 v249, 0xffff0000, v62
 s_add_u32 s36, s27, 0
 v_mul_f32 v254, v142, v249
 v_mul_f32 v84, v100, v100
 v_mul_f32 v142, v142, v248
 buffer_store_dwordx2 v[88:89], v4, s[12:15], s36 offen sc1
 v_fma_f32 v142, v130, v249, v142
 v_mul_f32 v85, v101, v101
 v_fma_f32 v130, v130, v248, -v254
 v_mul_f32 v86, v102, v102
 v_lshlrev_b32 v250, 16, v63
 v_mul_f32 v87, v103, v103
 v_and_b32 v251, 0xffff0000, v63
 v_fma_f32 v84, v84, s30, v9
 v_mul_f32 v255, v143, v251
 v_fma_f32 v85, v85, s30, v9
 v_mul_f32 v143, v143, v250
 v_fma_f32 v86, v86, s30, v9
 v_fma_f32 v143, v131, v251, v143
 v_fma_f32 v87, v87, s30, v9
 v_fma_f32 v131, v131, v250, -v255
 v_mul_f32 v84, v84, v100
 v_cvt_pk_bf16_f32 v232, v128, -v140
 v_mul_f32 v85, v85, v101
 v_cvt_pk_bf16_f32 v233, v129, -v141
 v_mul_f32 v86, v86, v102
 v_cvt_pk_bf16_f32 v234, v130, -v142
 v_mul_f32 v87, v87, v103
 v_cvt_pk_bf16_f32 v235, v131, -v143
 v_exp_f32 v84, v84
 s_waitcnt lgkmcnt(1)
 v_lshlrev_b32 v244, 16, v64
 v_exp_f32 v85, v85
 v_and_b32 v245, 0xffff0000, v64
 v_exp_f32 v86, v86
 v_mul_f32 v252, v144, v245
 v_exp_f32 v87, v87
 v_mul_f32 v144, v144, v244
 v_mul_f32 v116, v100, v116
 v_fma_f32 v144, v132, v245, v144
 v_mul_f32 v117, v101, v117
 v_fma_f32 v132, v132, v244, -v252
 v_mul_f32 v118, v102, v118
 v_lshlrev_b32 v246, 16, v65
 v_mul_f32 v119, v103, v119
 v_and_b32 v247, 0xffff0000, v65
 v_add_f32 v84, 1.0, v84
 v_mul_f32 v253, v145, v247
 v_add_f32 v85, 1.0, v85
 v_mul_f32 v145, v145, v246
 v_add_f32 v86, 1.0, v86
 v_fma_f32 v145, v133, v247, v145
 v_add_f32 v87, 1.0, v87
 v_fma_f32 v133, v133, v246, -v253
 v_rcp_f32 v84, v84
 v_lshlrev_b32 v248, 16, v66
 v_rcp_f32 v85, v85
 v_and_b32 v249, 0xffff0000, v66
 v_rcp_f32 v86, v86
 v_mul_f32 v254, v146, v249
 v_rcp_f32 v87, v87
 s_add_u32 s58, s54, 0
 buffer_load_dwordx4 a[0:3], v1, s[12:15], s58 offen sc1
 v_mul_f32 v146, v146, v248
 v_mul_f32 v116, v116, v84
 v_fma_f32 v146, v134, v249, v146
 v_mul_f32 v117, v117, v85
 v_fma_f32 v134, v134, v248, -v254
 v_mul_f32 v118, v118, v86
 v_lshlrev_b32 v250, 16, v67
 v_mul_f32 v119, v119, v87
 v_and_b32 v251, 0xffff0000, v67
 v_cvt_pk_bf16_f32 v92, v116, v117
 v_mul_f32 v255, v147, v251
 v_cvt_pk_bf16_f32 v93, v118, v119
 v_mul_f32 v147, v147, v250
 s_add_u32 s37, s27, 16384
 v_fma_f32 v147, v135, v251, v147
 v_mul_f32 v80, v104, v104
 v_fma_f32 v135, v135, v250, -v255
 buffer_store_dwordx2 v[92:93], v4, s[12:15], s37 offen sc1
 v_cvt_pk_bf16_f32 v236, v132, -v144
 v_mul_f32 v81, v105, v105
 v_cvt_pk_bf16_f32 v237, v133, -v145
 v_mul_f32 v82, v106, v106
 v_cvt_pk_bf16_f32 v238, v134, -v146
 v_mul_f32 v83, v107, v107
 s_add_u32 s58, s54, 147456
 buffer_load_dwordx4 a[4:7], v1, s[12:15], s58 offen sc1
 v_cvt_pk_bf16_f32 v239, v135, -v147
 v_fma_f32 v80, v80, s30, v9
 s_waitcnt lgkmcnt(0)
 v_lshlrev_b32 v244, 16, v68
 v_fma_f32 v81, v81, s30, v9
 v_and_b32 v245, 0xffff0000, v68
 v_fma_f32 v82, v82, s30, v9
 v_mul_f32 v252, v148, v245
 v_fma_f32 v83, v83, s30, v9
 v_mul_f32 v148, v148, v244
 v_mul_f32 v80, v80, v104
 v_fma_f32 v148, v136, v245, v148
 v_mul_f32 v81, v81, v105
 v_fma_f32 v136, v136, v244, -v252
 v_mul_f32 v82, v82, v106
 v_lshlrev_b32 v246, 16, v69
 v_mul_f32 v83, v83, v107
 v_and_b32 v247, 0xffff0000, v69
 v_exp_f32 v80, v80
 v_mul_f32 v253, v149, v247
 v_exp_f32 v81, v81
 v_mul_f32 v149, v149, v246
 v_exp_f32 v82, v82
 v_fma_f32 v149, v137, v247, v149
 v_exp_f32 v83, v83
 s_add_u32 s58, s54, 4096
 buffer_load_dwordx4 a[8:11], v1, s[12:15], s58 offen sc1
 v_fma_f32 v137, v137, v246, -v253
 v_mul_f32 v120, v104, v120
 v_lshlrev_b32 v248, 16, v70
 v_mul_f32 v121, v105, v121
 v_and_b32 v249, 0xffff0000, v70
 v_mul_f32 v122, v106, v122
 v_mul_f32 v254, v150, v249
 v_mul_f32 v123, v107, v123
 v_mul_f32 v150, v150, v248
 v_add_f32 v80, 1.0, v80
 v_fma_f32 v150, v138, v249, v150
 v_add_f32 v81, 1.0, v81
 v_fma_f32 v138, v138, v248, -v254
 v_add_f32 v82, 1.0, v82
 v_lshlrev_b32 v250, 16, v71
 v_add_f32 v83, 1.0, v83
 v_and_b32 v251, 0xffff0000, v71
 v_rcp_f32 v80, v80
 v_mul_f32 v255, v151, v251
 v_rcp_f32 v81, v81
 v_mul_f32 v151, v151, v250
 v_rcp_f32 v82, v82
 v_fma_f32 v151, v139, v251, v151
 v_rcp_f32 v83, v83
 s_add_u32 s58, s54, 151552
 buffer_load_dwordx4 a[12:15], v1, s[12:15], s58 offen sc1
 v_fma_f32 v139, v139, v250, -v255
 v_mul_f32 v120, v120, v80
 v_cvt_pk_bf16_f32 v240, v136, -v148
 v_mul_f32 v121, v121, v81
 v_cvt_pk_bf16_f32 v241, v137, -v149
 v_mul_f32 v122, v122, v82
 v_cvt_pk_bf16_f32 v242, v138, -v150
 v_mul_f32 v123, v123, v83
 v_cvt_pk_bf16_f32 v243, v139, -v151
 v_cvt_pk_bf16_f32 v88, v120, v121
 v_mfma_f32_16x16x32_bf16 v[128:131], v[16:19], v[232:235], 0
 v_cvt_pk_bf16_f32 v89, v122, v123
 v_mfma_f32_16x16x32_bf16 v[140:143], v[20:23], v[232:235], 0
 s_add_u32 s36, s27, 32768
 v_mfma_f32_16x16x32_bf16 v[132:135], v[16:19], v[236:239], 0
 v_mul_f32 v84, v108, v108
 v_mfma_f32_16x16x32_bf16 v[144:147], v[20:23], v[236:239], 0
 buffer_store_dwordx2 v[88:89], v4, s[12:15], s36 offen sc1
 v_mfma_f32_16x16x32_bf16 v[136:139], v[16:19], v[240:243], 0
 v_mul_f32 v85, v109, v109
 v_mfma_f32_16x16x32_bf16 v[148:151], v[20:23], v[240:243], 0
 v_mul_f32 v86, v110, v110
 v_mul_f32 v244, v140, v36
 v_mul_f32 v87, v111, v111
 s_add_u32 s58, s54, 8192
 buffer_load_dwordx4 a[16:19], v1, s[12:15], s58 offen sc1
 v_mul_f32 v140, v140, v32
 v_fma_f32 v84, v84, s30, v9
 v_fma_f32 v140, v128, v36, v140
 v_fma_f32 v85, v85, s30, v9
 v_fma_f32 v128, v128, v32, -v244
 v_fma_f32 v86, v86, s30, v9
 v_mul_f32 v245, v141, v37
 v_fma_f32 v87, v87, s30, v9
 v_mul_f32 v141, v141, v33
 v_mul_f32 v84, v84, v108
 v_fma_f32 v141, v129, v37, v141
 v_mul_f32 v85, v85, v109
 v_fma_f32 v129, v129, v33, -v245
 v_mul_f32 v86, v86, v110
 v_mul_f32 v246, v142, v38
 v_mul_f32 v87, v87, v111
 v_mul_f32 v142, v142, v34
 v_exp_f32 v84, v84
 v_fma_f32 v142, v130, v38, v142
 v_exp_f32 v85, v85
 v_fma_f32 v130, v130, v34, -v246
 v_exp_f32 v86, v86
 v_mul_f32 v247, v143, v39
 v_exp_f32 v87, v87
 s_add_u32 s58, s54, 155648
 buffer_load_dwordx4 a[20:23], v1, s[12:15], s58 offen sc1
 v_mul_f32 v143, v143, v35
 v_mul_f32 v124, v108, v124
 v_fma_f32 v143, v131, v39, v143
 v_mul_f32 v125, v109, v125
 v_fma_f32 v131, v131, v35, -v247
 v_mul_f32 v126, v110, v126
 v_cvt_pk_bf16_f32 v232, v128, v140
 v_mul_f32 v127, v111, v127
 ds_write_b32 v42, v232 offset:12480
 v_add_f32 v84, 1.0, v84
 v_cvt_pk_bf16_f32 v233, v129, v141
 v_add_f32 v85, 1.0, v85
 ds_write_b32 v42, v233 offset:12544
 v_add_f32 v86, 1.0, v86
 v_cvt_pk_bf16_f32 v234, v130, v142
 v_add_f32 v87, 1.0, v87
 ds_write_b32 v42, v234 offset:12608
 v_rcp_f32 v84, v84
 v_cvt_pk_bf16_f32 v235, v131, v143
 v_rcp_f32 v85, v85
 ds_write_b32 v42, v235 offset:12672
 v_rcp_f32 v86, v86
 v_mul_f32 v244, v144, v36
 v_rcp_f32 v87, v87
 s_add_u32 s58, s54, 12288
 buffer_load_dwordx4 a[24:27], v1, s[12:15], s58 offen sc1
 v_mul_f32 v144, v144, v32
 v_mul_f32 v124, v124, v84
 v_fma_f32 v144, v132, v36, v144
 v_mul_f32 v125, v125, v85
 v_fma_f32 v132, v132, v32, -v244
 v_mul_f32 v126, v126, v86
 v_mul_f32 v245, v145, v37
 v_mul_f32 v127, v127, v87
 v_mul_f32 v145, v145, v33
 v_cvt_pk_bf16_f32 v92, v124, v125
 v_fma_f32 v145, v133, v37, v145
 v_cvt_pk_bf16_f32 v93, v126, v127
 v_fma_f32 v133, v133, v33, -v245
 s_add_u32 s37, s27, 49152
 v_mul_f32 v246, v146, v38
 buffer_store_dwordx2 v[92:93], v4, s[12:15], s37 offen sc1
 v_mul_f32 v146, v146, v34
 v_fma_f32 v146, v134, v38, v146
 v_fma_f32 v134, v134, v34, -v246
 v_mul_f32 v247, v147, v39
 s_add_u32 s58, s54, 159744
 buffer_load_dwordx4 a[28:31], v1, s[12:15], s58 offen sc1
 v_mul_f32 v147, v147, v35
 v_fma_f32 v147, v135, v39, v147
 v_fma_f32 v135, v135, v35, -v247
 v_cvt_pk_bf16_f32 v236, v132, v144
 ds_write_b32 v42, v236 offset:16640
 v_cvt_pk_bf16_f32 v237, v133, v145
 ds_write_b32 v42, v237 offset:16704
 v_cvt_pk_bf16_f32 v238, v134, v146
 ds_write_b32 v42, v238 offset:16768
 v_cvt_pk_bf16_f32 v239, v135, v147
 ds_write_b32 v42, v239 offset:16832
 v_mul_f32 v244, v148, v36
 s_add_u32 s58, s54, 18432
 buffer_load_dwordx4 a[32:35], v1, s[12:15], s58 offen sc1
 v_mul_f32 v148, v148, v32
 v_fma_f32 v148, v136, v36, v148
 v_fma_f32 v136, v136, v32, -v244
 v_mul_f32 v245, v149, v37
 v_mul_f32 v149, v149, v33
 v_fma_f32 v149, v137, v37, v149
 v_fma_f32 v137, v137, v33, -v245
 v_mul_f32 v246, v150, v38
 v_mul_f32 v150, v150, v34
 v_fma_f32 v150, v138, v38, v150
 v_fma_f32 v138, v138, v34, -v246
 v_mul_f32 v247, v151, v39
 s_add_u32 s58, s54, 165888
 buffer_load_dwordx4 a[36:39], v1, s[12:15], s58 offen sc1
 v_mul_f32 v151, v151, v35
 v_fma_f32 v151, v139, v39, v151
 v_fma_f32 v139, v139, v35, -v247
 v_cvt_pk_bf16_f32 v240, v136, v148
 ds_write_b32 v42, v240 offset:20800
 v_cvt_pk_bf16_f32 v241, v137, v149
 ds_write_b32 v42, v241 offset:20864
 v_cvt_pk_bf16_f32 v242, v138, v150
 ds_write_b32 v42, v242 offset:20928
 v_cvt_pk_bf16_f32 v243, v139, v151
 ds_write_b32 v42, v243 offset:20992
 s_waitcnt lgkmcnt(0)
 ds_read_b128 v[48:51], v40 offset:12480
 ds_read_b128 v[52:55], v40 offset:16640
 ds_read_b128 v[56:59], v40 offset:20800
 s_waitcnt lgkmcnt(2)
 v_mfma_f32_16x16x32_bf16 v[128:131], v[48:51], v[16:19], 0
 v_mfma_f32_16x16x32_bf16 v[140:143], v[48:51], v[20:23], 0
 s_waitcnt lgkmcnt(1)
 v_mfma_f32_16x16x32_bf16 v[132:135], v[52:55], v[16:19], 0
 v_mfma_f32_16x16x32_bf16 v[144:147], v[52:55], v[20:23], 0
 s_waitcnt lgkmcnt(0)
 v_mfma_f32_16x16x32_bf16 v[136:139], v[56:59], v[16:19], 0
 v_mfma_f32_16x16x32_bf16 v[148:151], v[56:59], v[20:23], 0
 s_nop 1
 v_cvt_pk_bf16_f32 v232, v128, -v140
 ds_write_b32 v42, v232 offset:0
 v_cvt_pk_bf16_f32 v233, v129, -v141
 s_add_u32 s58, s54, 22528
 buffer_load_dwordx4 a[40:43], v1, s[12:15], s58 offen sc1
 ds_write_b32 v42, v233 offset:64
 v_cvt_pk_bf16_f32 v234, v130, -v142
 ds_write_b32 v42, v234 offset:128
 v_cvt_pk_bf16_f32 v235, v131, -v143
 ds_write_b32 v42, v235 offset:192
 v_cvt_pk_bf16_f32 v236, v132, -v144
 ds_write_b32 v42, v236 offset:4160
 v_cvt_pk_bf16_f32 v237, v133, -v145
 ds_write_b32 v42, v237 offset:4224
 v_cvt_pk_bf16_f32 v238, v134, -v146
 ds_write_b32 v42, v238 offset:4288
 v_cvt_pk_bf16_f32 v239, v135, -v147
 s_add_u32 s58, s54, 169984
 buffer_load_dwordx4 a[44:47], v1, s[12:15], s58 offen sc1
 ds_write_b32 v42, v239 offset:4352
 v_cvt_pk_bf16_f32 v240, v136, -v148
 ds_write_b32 v42, v240 offset:8320
 v_cvt_pk_bf16_f32 v241, v137, -v149
 ds_write_b32 v42, v241 offset:8384
 v_cvt_pk_bf16_f32 v242, v138, -v150
 ds_write_b32 v42, v242 offset:8448
 v_cvt_pk_bf16_f32 v243, v139, -v151
 ds_write_b32 v42, v243 offset:8512
 s_waitcnt lgkmcnt(0)
 s_waitcnt vmcnt(5)
 s_barrier
 s_add_u32 s58, s54, 26624
 buffer_load_dwordx4 a[48:51], v1, s[12:15], s58 offen sc1
 s_add_u32 s43, s31, 8192
 v_mov_b32 v230, s60
 s_cmp_eq_u32 s20, 0
 s_cselect_b32 s77, s43, 0x7ff00000
 s_mov_b64 exec, 1
 buffer_store_dword v230, v1, s[12:15], s77 offen offset:0 sc1
 s_mov_b64 exec, -1
 s_and_b32 s46, s2, 7
 s_mul_i32 s46, s46, 25
 s_lshr_b32 s47, s2, 3
 s_add_u32 s46, s46, s47
 s_mul_i32 s46, s46, 12288
 s_add_u32 s58, s54, 174080
 buffer_load_dwordx4 a[52:55], v1, s[12:15], s58 offen sc1
 s_mul_i32 s47, s20, 3072
 s_add_u32 s46, s46, s47
 s_add_u32 s46, s46, 40129152
 s_cmp_lt_u32 s2, 200
 s_cselect_b32 s46, s46, 0x7ff00000
 ds_read_b32 v244, v45 offset:0
 ds_read_b32 v245, v45 offset:1040
 ds_read_b32 v246, v45 offset:2080
 ds_read_b32 v247, v45 offset:3120
 ds_read_b32 v248, v46 offset:0
 ds_read_b32 v249, v46 offset:1040
 ds_read_b32 v250, v46 offset:2080
 s_add_u32 s58, s54, 30720
 buffer_load_dwordx4 a[56:59], v1, s[12:15], s58 offen sc1
 ds_read_b32 v251, v46 offset:3120
 ds_read_b32 v252, v47 offset:0
 ds_read_b32 v253, v47 offset:1040
 ds_read_b32 v254, v47 offset:2080
 ds_read_b32 v255, v47 offset:3120
 s_waitcnt lgkmcnt(8)
 buffer_store_dwordx4 v[244:247], v1, s[12:15], s46 offen offset:0 sc1
 s_waitcnt lgkmcnt(4)
 buffer_store_dwordx4 v[248:251], v1, s[12:15], s46 offen offset:1024 sc1
 s_waitcnt lgkmcnt(0)
 buffer_store_dwordx4 v[252:255], v1, s[12:15], s46 offen offset:2048 sc1
 s_add_u32 s58, s54, 178176
 buffer_load_dwordx4 a[60:63], v1, s[12:15], s58 offen sc1
 s_add_u32 s42, s32, 4096
 buffer_load_dword v229, v225, s[12:15], s42 offen offset:0 sc1
 v_add_u32 v6, 36864, v6
 s_barrier
 ds_read_b64_tr_b16 v[32:33], v6 offset:0
 ds_read_b64_tr_b16 v[34:35], v6 offset:4608
 ds_read_b64_tr_b16 v[36:37], v6 offset:9216
 ds_read_b64_tr_b16 v[38:39], v6 offset:13824
 ds_read_b64_tr_b16 v[40:41], v6 offset:18432
 ds_read_b64_tr_b16 v[42:43], v6 offset:23040
 ds_read_b64_tr_b16 v[44:45], v6 offset:27648
 ds_read_b64_tr_b16 v[46:47], v6 offset:32256
 ds_read_b64_tr_b16 v[48:49], v6 offset:32
 ds_read_b64_tr_b16 v[50:51], v6 offset:4640
 ds_read_b64_tr_b16 v[52:53], v6 offset:9248
 ds_read_b64_tr_b16 v[54:55], v6 offset:13856
 ds_read_b64_tr_b16 v[56:57], v6 offset:18464
 ds_read_b64_tr_b16 v[58:59], v6 offset:23072
 ds_read_b64_tr_b16 v[60:61], v6 offset:27680
 ds_read_b64_tr_b16 v[62:63], v6 offset:32288
 s_waitcnt lgkmcnt(14)
 v_mfma_f32_16x16x32_bf16 v[96:99], v[32:35], a[0:3], 0
 ds_read_b64_tr_b16 v[64:65], v6 offset:64
 v_and_b32 v81, 7, v0
 s_waitcnt lgkmcnt(13)
 v_mfma_f32_16x16x32_bf16 v[96:99], v[36:39], a[8:11], v[96:99]
 s_add_u32 s57, s51, 700416
 ds_read_b64_tr_b16 v[66:67], v6 offset:4672
 v_lshlrev_b32 v81, 2, v81
 s_waitcnt lgkmcnt(12)
 v_mfma_f32_16x16x32_bf16 v[96:99], v[40:43], a[16:19], v[96:99]
 s_add_u32 m0, s53, 0
 ds_read_b64_tr_b16 v[68:69], v6 offset:9280
 v_bfe_u32 v92, v0, 3, 1
 s_waitcnt lgkmcnt(11)
 v_mfma_f32_16x16x32_bf16 v[96:99], v[44:47], a[24:27], v[96:99]
 ds_read_b64_tr_b16 v[70:71], v6 offset:13888
 buffer_load_dwordx4 v2, s[16:19], s57 offen lds
 v_mul_u32_u24 v92, 147456, v92
 v_mfma_f32_16x16x32_bf16 v[100:103], v[32:35], a[4:7], 0
 s_add_u32 s58, s54, 1024
 ds_read_b64_tr_b16 v[72:73], v6 offset:18496
 v_and_b32 v93, 7, v0
 v_mfma_f32_16x16x32_bf16 v[100:103], v[36:39], a[12:15], v[100:103]
 ds_read_b64_tr_b16 v[74:75], v6 offset:23104
 buffer_load_dwordx4 a[64:67], v1, s[12:15], s58 offen sc1
 v_lshl_add_u32 v92, v93, 7, v92
 v_mfma_f32_16x16x32_bf16 v[100:103], v[40:43], a[20:23], v[100:103]
 ds_read_b64_tr_b16 v[76:77], v6 offset:27712
 v_bfe_u32 v93, v0, 4, 1
 s_waitcnt vmcnt(15)
 v_mfma_f32_16x16x32_bf16 v[100:103], v[44:47], a[28:31], v[100:103]
 ds_read_b64_tr_b16 v[78:79], v6 offset:32320
 s_waitcnt lgkmcnt(8)
 v_mul_u32_u24 v93, 18432, v93
 v_mfma_f32_16x16x32_bf16 v[104:107], v[48:51], a[0:3], 0
 s_add_u32 m0, s53, 1024
 ds_read_b64_tr_b16 v[32:33], v6 offset:96
 v_add_u32 v92, v92, v93
 v_mfma_f32_16x16x32_bf16 v[104:107], v[52:55], a[8:11], v[104:107]
 ds_read_b64_tr_b16 v[34:35], v6 offset:4704
 buffer_load_dwordx4 v3, s[16:19], s57 offen lds
 v_lshrrev_b32 v93, 5, v0
 v_mfma_f32_16x16x32_bf16 v[104:107], v[56:59], a[16:19], v[104:107]
 s_add_u32 s58, s54, 148480
 ds_read_b64_tr_b16 v[36:37], v6 offset:9312
 v_lshl_add_u32 v92, v93, 10, v92
 v_mfma_f32_16x16x32_bf16 v[104:107], v[60:63], a[24:27], v[104:107]
 ds_read_b64_tr_b16 v[38:39], v6 offset:13920
 buffer_load_dwordx4 a[68:71], v1, s[12:15], s58 offen sc1
 v_bfe_u32 v93, v0, 3, 1
 v_mfma_f32_16x16x32_bf16 v[108:111], v[48:51], a[4:7], 0
 ds_read_b64_tr_b16 v[40:41], v6 offset:18528
 v_lshlrev_b32 v93, 14, v93
 v_mfma_f32_16x16x32_bf16 v[108:111], v[52:55], a[12:15], v[108:111]
 s_add_u32 m0, s53, 2048
 ds_read_b64_tr_b16 v[42:43], v6 offset:23136
 v_and_b32 v94, 7, v0
 v_mfma_f32_16x16x32_bf16 v[108:111], v[56:59], a[20:23], v[108:111]
 ds_read_b64_tr_b16 v[44:45], v6 offset:27744
 buffer_load_dwordx4 v10, s[16:19], s57 offen lds
 v_lshl_add_u32 v93, v94, 7, v93
 v_mfma_f32_16x16x32_bf16 v[108:111], v[60:63], a[28:31], v[108:111]
 ds_read_b64_tr_b16 v[46:47], v6 offset:32352
 s_waitcnt lgkmcnt(8)
 v_mfma_f32_16x16x32_bf16 v[112:115], v[64:67], a[0:3], 0
 ds_read_b64_tr_b16 v[48:49], v6 offset:128
 v_mfma_f32_16x16x32_bf16 v[112:115], v[68:71], a[8:11], v[112:115]
 s_add_u32 s58, s54, 5120
 ds_read_b64_tr_b16 v[50:51], v6 offset:4736
 v_mfma_f32_16x16x32_bf16 v[112:115], v[72:75], a[16:19], v[112:115]
 ds_read_b64_tr_b16 v[52:53], v6 offset:9344
 buffer_load_dwordx4 a[72:75], v1, s[12:15], s58 offen sc1
 v_mfma_f32_16x16x32_bf16 v[112:115], v[76:79], a[24:27], v[112:115]
 s_add_u32 m0, s53, 3072
 ds_read_b64_tr_b16 v[54:55], v6 offset:13952
 v_mfma_f32_16x16x32_bf16 v[116:119], v[64:67], a[4:7], 0
 ds_read_b64_tr_b16 v[56:57], v6 offset:18560
 buffer_load_dwordx4 v11, s[16:19], s57 offen lds
 v_mfma_f32_16x16x32_bf16 v[116:119], v[68:71], a[12:15], v[116:119]
 ds_read_b64_tr_b16 v[58:59], v6 offset:23168
 v_mfma_f32_16x16x32_bf16 v[116:119], v[72:75], a[20:23], v[116:119]
 ds_read_b64_tr_b16 v[60:61], v6 offset:27776
 v_mfma_f32_16x16x32_bf16 v[116:119], v[76:79], a[28:31], v[116:119]
 ds_read_b64_tr_b16 v[62:63], v6 offset:32384
 s_waitcnt lgkmcnt(8)
 v_mfma_f32_16x16x32_bf16 v[120:123], v[32:35], a[0:3], 0
 s_add_u32 s58, s54, 152576
 ds_read_b64_tr_b16 v[64:65], v6 offset:160
 v_mfma_f32_16x16x32_bf16 v[120:123], v[36:39], a[8:11], v[120:123]
 ds_read_b64_tr_b16 v[66:67], v6 offset:4768
 buffer_load_dwordx4 a[76:79], v1, s[12:15], s58 offen sc1
 v_mfma_f32_16x16x32_bf16 v[120:123], v[40:43], a[16:19], v[120:123]
 s_add_u32 m0, s53, 4096
 ds_read_b64_tr_b16 v[68:69], v6 offset:9376
 v_mfma_f32_16x16x32_bf16 v[120:123], v[44:47], a[24:27], v[120:123]
 ds_read_b64_tr_b16 v[70:71], v6 offset:13984
 buffer_load_dwordx4 v12, s[16:19], s57 offen lds
 v_mfma_f32_16x16x32_bf16 v[124:127], v[32:35], a[4:7], 0
 ds_read_b64_tr_b16 v[72:73], v6 offset:18592
 v_mfma_f32_16x16x32_bf16 v[124:127], v[36:39], a[12:15], v[124:127]
 ds_read_b64_tr_b16 v[74:75], v6 offset:23200
 v_mfma_f32_16x16x32_bf16 v[124:127], v[40:43], a[20:23], v[124:127]
 ds_read_b64_tr_b16 v[76:77], v6 offset:27808
 v_mfma_f32_16x16x32_bf16 v[124:127], v[44:47], a[28:31], v[124:127]
 ds_read_b64_tr_b16 v[78:79], v6 offset:32416
 s_waitcnt lgkmcnt(8)
 v_mfma_f32_16x16x32_bf16 v[128:131], v[48:51], a[0:3], 0
 s_add_u32 s58, s54, 9216
 ds_read_b64_tr_b16 v[32:33], v6 offset:192
 v_mfma_f32_16x16x32_bf16 v[128:131], v[52:55], a[8:11], v[128:131]
 ds_read_b64_tr_b16 v[34:35], v6 offset:4800
 buffer_load_dwordx4 a[80:83], v1, s[12:15], s58 offen sc1
 v_mfma_f32_16x16x32_bf16 v[128:131], v[56:59], a[16:19], v[128:131]
 s_add_u32 m0, s53, 5120
 ds_read_b64_tr_b16 v[36:37], v6 offset:9408
 v_mfma_f32_16x16x32_bf16 v[128:131], v[60:63], a[24:27], v[128:131]
 ds_read_b64_tr_b16 v[38:39], v6 offset:14016
 buffer_load_dwordx4 v13, s[16:19], s57 offen lds
 v_mfma_f32_16x16x32_bf16 v[132:135], v[48:51], a[4:7], 0
 ds_read_b64_tr_b16 v[40:41], v6 offset:18624
 v_mfma_f32_16x16x32_bf16 v[132:135], v[52:55], a[12:15], v[132:135]
 ds_read_b64_tr_b16 v[42:43], v6 offset:23232
 v_mfma_f32_16x16x32_bf16 v[132:135], v[56:59], a[20:23], v[132:135]
 s_add_u32 m0, s53, 6144
 ds_read_b64_tr_b16 v[44:45], v6 offset:27840
 v_mfma_f32_16x16x32_bf16 v[132:135], v[60:63], a[28:31], v[132:135]
 ds_read_b64_tr_b16 v[46:47], v6 offset:32448
 s_waitcnt lgkmcnt(8)
 v_mfma_f32_16x16x32_bf16 v[136:139], v[64:67], a[0:3], 0
 ds_read_b64_tr_b16 v[48:49], v6 offset:224
 buffer_load_dwordx4 v14, s[16:19], s57 offen lds
 v_mfma_f32_16x16x32_bf16 v[136:139], v[68:71], a[8:11], v[136:139]
 s_add_u32 s58, s54, 156672
 ds_read_b64_tr_b16 v[50:51], v6 offset:4832
 v_mfma_f32_16x16x32_bf16 v[136:139], v[72:75], a[16:19], v[136:139]
 ds_read_b64_tr_b16 v[52:53], v6 offset:9440
 buffer_load_dwordx4 a[84:87], v1, s[12:15], s58 offen sc1
 v_mfma_f32_16x16x32_bf16 v[136:139], v[76:79], a[24:27], v[136:139]
 ds_read_b64_tr_b16 v[54:55], v6 offset:14048
 v_mfma_f32_16x16x32_bf16 v[140:143], v[64:67], a[4:7], 0
 s_add_u32 m0, s53, 7168
 ds_read_b64_tr_b16 v[56:57], v6 offset:18656
 v_mfma_f32_16x16x32_bf16 v[140:143], v[68:71], a[12:15], v[140:143]
 ds_read_b64_tr_b16 v[58:59], v6 offset:23264
 buffer_load_dwordx4 v15, s[16:19], s57 offen lds
 v_mfma_f32_16x16x32_bf16 v[140:143], v[72:75], a[20:23], v[140:143]
 s_add_u32 s58, s54, 13312
 ds_read_b64_tr_b16 v[60:61], v6 offset:27872
 v_mfma_f32_16x16x32_bf16 v[140:143], v[76:79], a[28:31], v[140:143]
 ds_read_b64_tr_b16 v[62:63], v6 offset:32480
 s_waitcnt lgkmcnt(8)
 v_mfma_f32_16x16x32_bf16 v[144:147], v[32:35], a[0:3], 0
 ds_read_b64_tr_b16 v[64:65], v6 offset:256
 buffer_load_dwordx4 a[88:91], v1, s[12:15], s58 offen sc1
 v_mfma_f32_16x16x32_bf16 v[144:147], v[36:39], a[8:11], v[144:147]
 ds_read_b64_tr_b16 v[66:67], v6 offset:4864
 v_mfma_f32_16x16x32_bf16 v[144:147], v[40:43], a[16:19], v[144:147]
 s_add_u32 m0, s53, 8192
 ds_read_b64_tr_b16 v[68:69], v6 offset:9472
 v_mfma_f32_16x16x32_bf16 v[144:147], v[44:47], a[24:27], v[144:147]
 ds_read_b64_tr_b16 v[70:71], v6 offset:14080
 buffer_load_dwordx4 v5, s[16:19], s57 offen lds
 v_mfma_f32_16x16x32_bf16 v[148:151], v[32:35], a[4:7], 0
 s_add_u32 s58, s54, 160768
 ds_read_b64_tr_b16 v[72:73], v6 offset:18688
 v_mfma_f32_16x16x32_bf16 v[148:151], v[36:39], a[12:15], v[148:151]
 ds_read_b64_tr_b16 v[74:75], v6 offset:23296
 buffer_load_dwordx4 a[92:95], v1, s[12:15], s58 offen sc1
 v_mfma_f32_16x16x32_bf16 v[148:151], v[40:43], a[20:23], v[148:151]
 ds_read_b64_tr_b16 v[76:77], v6 offset:27904
 v_mfma_f32_16x16x32_bf16 v[148:151], v[44:47], a[28:31], v[148:151]
 ds_read_b64_tr_b16 v[78:79], v6 offset:32512
 s_waitcnt lgkmcnt(8)
 v_mfma_f32_16x16x32_bf16 v[152:155], v[48:51], a[0:3], 0
 v_mfma_f32_16x16x32_bf16 v[152:155], v[52:55], a[8:11], v[152:155]
 v_mfma_f32_16x16x32_bf16 v[152:155], v[56:59], a[16:19], v[152:155]
 v_mfma_f32_16x16x32_bf16 v[152:155], v[60:63], a[24:27], v[152:155]
 v_mfma_f32_16x16x32_bf16 v[156:159], v[48:51], a[4:7], 0
 v_add_u32 v6, 36864, v6
 v_mfma_f32_16x16x32_bf16 v[156:159], v[52:55], a[12:15], v[156:159]
 s_waitcnt lgkmcnt(0)
 s_barrier
 v_mfma_f32_16x16x32_bf16 v[156:159], v[56:59], a[20:23], v[156:159]
 ds_read_b64_tr_b16 v[32:33], v6 offset:0
 ds_read_b64_tr_b16 v[34:35], v6 offset:4608
 v_mfma_f32_16x16x32_bf16 v[156:159], v[60:63], a[28:31], v[156:159]
 ds_read_b64_tr_b16 v[36:37], v6 offset:9216
 ds_read_b64_tr_b16 v[38:39], v6 offset:13824
 v_mfma_f32_16x16x32_bf16 v[160:163], v[64:67], a[0:3], 0
 ds_read_b64_tr_b16 v[40:41], v6 offset:18432
 ds_read_b64_tr_b16 v[42:43], v6 offset:23040
 v_mfma_f32_16x16x32_bf16 v[160:163], v[68:71], a[8:11], v[160:163]
 ds_read_b64_tr_b16 v[44:45], v6 offset:27648
 ds_read_b64_tr_b16 v[46:47], v6 offset:32256
 v_mfma_f32_16x16x32_bf16 v[160:163], v[72:75], a[16:19], v[160:163]
 ds_read_b64_tr_b16 v[48:49], v6 offset:32
 ds_read_b64_tr_b16 v[50:51], v6 offset:4640
 v_mfma_f32_16x16x32_bf16 v[160:163], v[76:79], a[24:27], v[160:163]
 ds_read_b64_tr_b16 v[52:53], v6 offset:9248
 ds_read_b64_tr_b16 v[54:55], v6 offset:13856
 v_mfma_f32_16x16x32_bf16 v[164:167], v[64:67], a[4:7], 0
 ds_read_b64_tr_b16 v[56:57], v6 offset:18464
 ds_read_b64_tr_b16 v[58:59], v6 offset:23072
 v_mfma_f32_16x16x32_bf16 v[164:167], v[68:71], a[12:15], v[164:167]
 ds_read_b64_tr_b16 v[60:61], v6 offset:27680
 ds_read_b64_tr_b16 v[62:63], v6 offset:32288
 v_mfma_f32_16x16x32_bf16 v[164:167], v[72:75], a[20:23], v[164:167]
 v_mfma_f32_16x16x32_bf16 v[164:167], v[76:79], a[28:31], v[164:167]
 s_waitcnt lgkmcnt(8)
 s_waitcnt vmcnt(29)
 v_mfma_f32_16x16x32_bf16 v[96:99], v[32:35], a[32:35], v[96:99]
 ds_read_b64_tr_b16 v[64:65], v6 offset:64
 s_waitcnt vmcnt(27)
 v_mfma_f32_16x16x32_bf16 v[96:99], v[36:39], a[40:43], v[96:99]
 s_add_u32 s57, s51, 73728
 ds_read_b64_tr_b16 v[66:67], v6 offset:4672
 s_waitcnt vmcnt(25)
 v_mfma_f32_16x16x32_bf16 v[96:99], v[40:43], a[48:51], v[96:99]
 s_add_u32 m0, s53, 36864
 ds_read_b64_tr_b16 v[68:69], v6 offset:9280
 s_lshl_b32 s46, s20, 6
 s_waitcnt vmcnt(22)
 v_mfma_f32_16x16x32_bf16 v[96:99], v[44:47], a[56:59], v[96:99]
 ds_read_b64_tr_b16 v[70:71], v6 offset:13888
 buffer_load_dwordx4 v2, s[16:19], s57 offen lds
 v_add_u32 v212, s46, v0
 v_mfma_f32_16x16x32_bf16 v[100:103], v[32:35], a[36:39], v[100:103]
 s_add_u32 s58, s54, 19456
 ds_read_b64_tr_b16 v[72:73], v6 offset:18496
 v_and_b32 v213, 7, v212
 v_mfma_f32_16x16x32_bf16 v[100:103], v[36:39], a[44:47], v[100:103]
 ds_read_b64_tr_b16 v[74:75], v6 offset:23104
 buffer_load_dwordx4 a[96:99], v1, s[12:15], s58 offen sc1
 v_lshrrev_b32 v214, 3, v212
 v_mfma_f32_16x16x32_bf16 v[100:103], v[40:43], a[52:55], v[100:103]
 ds_read_b64_tr_b16 v[76:77], v6 offset:27712
 v_mul_u32_u24 v216, 384, v214
 s_waitcnt vmcnt(20)
 v_mfma_f32_16x16x32_bf16 v[100:103], v[44:47], a[60:63], v[100:103]
 ds_read_b64_tr_b16 v[78:79], v6 offset:32320
 s_waitcnt lgkmcnt(8)
 v_lshl_add_u32 v216, v213, 2, v216
 v_mfma_f32_16x16x32_bf16 v[104:107], v[48:51], a[32:35], v[104:107]
 s_add_u32 m0, s53, 37888
 ds_read_b64_tr_b16 v[32:33], v6 offset:96
 v_add_u32 v216, 0, v216
 v_mfma_f32_16x16x32_bf16 v[104:107], v[52:55], a[40:43], v[104:107]
 ds_read_b64_tr_b16 v[34:35], v6 offset:4704
 buffer_load_dwordx4 v3, s[16:19], s57 offen lds
 v_mov_b32 v217, 9728
 v_mfma_f32_16x16x32_bf16 v[104:107], v[56:59], a[48:51], v[104:107]
 s_add_u32 s58, s54, 166912
 ds_read_b64_tr_b16 v[36:37], v6 offset:9312
 v_cmp_gt_u32 vcc, 200, v212
 v_mfma_f32_16x16x32_bf16 v[104:107], v[60:63], a[56:59], v[104:107]
 ds_read_b64_tr_b16 v[38:39], v6 offset:13920
 buffer_load_dwordx4 a[100:103], v1, s[12:15], s58 offen sc1
 v_cndmask_b32 v177, v217, v216, vcc
 v_mfma_f32_16x16x32_bf16 v[108:111], v[48:51], a[36:39], v[108:111]
 ds_read_b64_tr_b16 v[40:41], v6 offset:18528
 s_lshl_b32 s46, s20, 6
 v_mfma_f32_16x16x32_bf16 v[108:111], v[52:55], a[44:47], v[108:111]
 s_add_u32 m0, s53, 38912
 ds_read_b64_tr_b16 v[42:43], v6 offset:23136
 v_mfma_f32_16x16x32_bf16 v[108:111], v[56:59], a[52:55], v[108:111]
 ds_read_b64_tr_b16 v[44:45], v6 offset:27744
 buffer_load_dwordx4 v10, s[16:19], s57 offen lds
 s_add_u32 s46, s46, 0
 v_mfma_f32_16x16x32_bf16 v[108:111], v[60:63], a[60:63], v[108:111]
 ds_read_b64_tr_b16 v[46:47], v6 offset:32352
 s_waitcnt lgkmcnt(8)
 v_add_u32 v212, s46, v0
 v_mfma_f32_16x16x32_bf16 v[112:115], v[64:67], a[32:35], v[112:115]
 ds_read_b64_tr_b16 v[48:49], v6 offset:128
 v_mul_u32_u24 v213, 911, v212
 v_mfma_f32_16x16x32_bf16 v[112:115], v[68:71], a[40:43], v[112:115]
 s_add_u32 s58, s54, 23552
 ds_read_b64_tr_b16 v[50:51], v6 offset:4736
 v_lshrrev_b32 v213, 16, v213
 v_mfma_f32_16x16x32_bf16 v[112:115], v[72:75], a[48:51], v[112:115]
 ds_read_b64_tr_b16 v[52:53], v6 offset:9344
 buffer_load_dwordx4 a[104:107], v1, s[12:15], s58 offen sc1
 v_mul_u32_u24 v214, 72, v213
 v_mfma_f32_16x16x32_bf16 v[112:115], v[76:79], a[56:59], v[112:115]
 s_add_u32 m0, s53, 39936
 ds_read_b64_tr_b16 v[54:55], v6 offset:13952
 v_sub_u32 v214, v212, v214
 v_mfma_f32_16x16x32_bf16 v[116:119], v[64:67], a[36:39], v[116:119]
 ds_read_b64_tr_b16 v[56:57], v6 offset:18560
 buffer_load_dwordx4 v11, s[16:19], s57 offen lds
 v_mul_u32_u24 v215, 3641, v214
 v_mfma_f32_16x16x32_bf16 v[116:119], v[68:71], a[44:47], v[116:119]
 ds_read_b64_tr_b16 v[58:59], v6 offset:23168
 v_lshrrev_b32 v215, 16, v215
 v_mfma_f32_16x16x32_bf16 v[116:119], v[72:75], a[52:55], v[116:119]
 ds_read_b64_tr_b16 v[60:61], v6 offset:27776
 v_mul_u32_u24 v216, 18, v215
 v_mfma_f32_16x16x32_bf16 v[116:119], v[76:79], a[60:63], v[116:119]
 ds_read_b64_tr_b16 v[62:63], v6 offset:32384
 s_waitcnt lgkmcnt(8)
 v_sub_u32 v216, v214, v216
 v_mfma_f32_16x16x32_bf16 v[120:123], v[32:35], a[32:35], v[120:123]
 s_add_u32 s58, s54, 171008
 ds_read_b64_tr_b16 v[64:65], v6 offset:160
 v_mfma_f32_16x16x32_bf16 v[120:123], v[36:39], a[40:43], v[120:123]
 ds_read_b64_tr_b16 v[66:67], v6 offset:4768
 buffer_load_dwordx4 a[108:111], v1, s[12:15], s58 offen sc1
 v_lshlrev_b32 v217, 8, v213
 v_mfma_f32_16x16x32_bf16 v[120:123], v[40:43], a[48:51], v[120:123]
 s_add_u32 m0, s53, 40960
 ds_read_b64_tr_b16 v[68:69], v6 offset:9376
 v_add_u32 v217, s3, v217
 v_mfma_f32_16x16x32_bf16 v[120:123], v[44:47], a[56:59], v[120:123]
 ds_read_b64_tr_b16 v[70:71], v6 offset:13984
 buffer_load_dwordx4 v12, s[16:19], s57 offen lds
 s_lshr_b32 s47, s3, 4
 v_mfma_f32_16x16x32_bf16 v[124:127], v[32:35], a[36:39], v[124:127]
 ds_read_b64_tr_b16 v[72:73], v6 offset:18592
 s_lshl_b32 s47, s47, 7
 v_mfma_f32_16x16x32_bf16 v[124:127], v[36:39], a[44:47], v[124:127]
 ds_read_b64_tr_b16 v[74:75], v6 offset:23200
 s_and_b32 s48, s3, 15
 v_mfma_f32_16x16x32_bf16 v[124:127], v[40:43], a[52:55], v[124:127]
 ds_read_b64_tr_b16 v[76:77], v6 offset:27808
 s_add_u32 s47, s47, s48
 v_mfma_f32_16x16x32_bf16 v[124:127], v[44:47], a[60:63], v[124:127]
 ds_read_b64_tr_b16 v[78:79], v6 offset:32416
 s_waitcnt lgkmcnt(8)
 v_lshlrev_b32 v218, 4, v213
 v_mfma_f32_16x16x32_bf16 v[128:131], v[48:51], a[32:35], v[128:131]
 s_add_u32 s58, s54, 27648
 ds_read_b64_tr_b16 v[32:33], v6 offset:192
 v_add_u32 v218, s47, v218
 v_mfma_f32_16x16x32_bf16 v[128:131], v[52:55], a[40:43], v[128:131]
 ds_read_b64_tr_b16 v[34:35], v6 offset:4800
 buffer_load_dwordx4 a[112:115], v1, s[12:15], s58 offen sc1
 v_lshl_add_u32 v219, v215, 11, v218
 v_mfma_f32_16x16x32_bf16 v[128:131], v[56:59], a[48:51], v[128:131]
 s_add_u32 m0, s53, 41984
 ds_read_b64_tr_b16 v[36:37], v6 offset:9408
 v_lshlrev_b32 v220, 7, v219
 v_mfma_f32_16x16x32_bf16 v[128:131], v[60:63], a[56:59], v[128:131]
 ds_read_b64_tr_b16 v[38:39], v6 offset:14016
 buffer_load_dwordx4 v13, s[16:19], s57 offen lds
 v_mfma_f32_16x16x32_bf16 v[132:135], v[48:51], a[36:39], v[132:135]
 ds_read_b64_tr_b16 v[40:41], v6 offset:18624
 v_lshrrev_b32 v218, 3, v216
 v_mfma_f32_16x16x32_bf16 v[132:135], v[52:55], a[44:47], v[132:135]
 ds_read_b64_tr_b16 v[42:43], v6 offset:23232
 s_mov_b32 s47, 4201344
 v_mfma_f32_16x16x32_bf16 v[132:135], v[56:59], a[52:55], v[132:135]
 s_add_u32 m0, s53, 43008
 ds_read_b64_tr_b16 v[44:45], v6 offset:27840
 v_mul_lo_u32 v218, s47, v218
 v_mfma_f32_16x16x32_bf16 v[132:135], v[60:63], a[60:63], v[132:135]
 ds_read_b64_tr_b16 v[46:47], v6 offset:32448
 s_waitcnt lgkmcnt(8)
 v_add_u32 v220, v218, v220
 v_mfma_f32_16x16x32_bf16 v[136:139], v[64:67], a[32:35], v[136:139]
 ds_read_b64_tr_b16 v[48:49], v6 offset:224
 buffer_load_dwordx4 v14, s[16:19], s57 offen lds
 v_and_b32 v218, 7, v216
 v_mfma_f32_16x16x32_bf16 v[136:139], v[68:71], a[40:43], v[136:139]
 s_add_u32 s58, s54, 175104
 ds_read_b64_tr_b16 v[50:51], v6 offset:4832
 v_lshl_add_u32 v220, v218, 4, v220
 v_mfma_f32_16x16x32_bf16 v[136:139], v[72:75], a[48:51], v[136:139]
 ds_read_b64_tr_b16 v[52:53], v6 offset:9440
 buffer_load_dwordx4 a[116:119], v1, s[12:15], s58 offen sc1
 v_lshlrev_b32 v219, 5, v219
 v_mfma_f32_16x16x32_bf16 v[136:139], v[76:79], a[56:59], v[136:139]
 ds_read_b64_tr_b16 v[54:55], v6 offset:14048
 v_and_b32 v218, 1, v216
 v_mfma_f32_16x16x32_bf16 v[140:143], v[64:67], a[36:39], v[140:143]
 s_add_u32 m0, s53, 44032
 ds_read_b64_tr_b16 v[56:57], v6 offset:18656
 v_lshl_add_u32 v219, v218, 4, v219
 v_mfma_f32_16x16x32_bf16 v[140:143], v[68:71], a[44:47], v[140:143]
 ds_read_b64_tr_b16 v[58:59], v6 offset:23264
 buffer_load_dwordx4 v15, s[16:19], s57 offen lds
 v_add_u32 v219, 8402688, v219
 v_mfma_f32_16x16x32_bf16 v[140:143], v[72:75], a[52:55], v[140:143]
 s_add_u32 s58, s54, 31744
 ds_read_b64_tr_b16 v[60:61], v6 offset:27872
 v_cmp_lt_u32 vcc, 15, v216
 v_mfma_f32_16x16x32_bf16 v[140:143], v[76:79], a[60:63], v[140:143]
 ds_read_b64_tr_b16 v[62:63], v6 offset:32480
 s_waitcnt lgkmcnt(8)
 v_mfma_f32_16x16x32_bf16 v[144:147], v[32:35], a[32:35], v[144:147]
 ds_read_b64_tr_b16 v[64:65], v6 offset:256
 buffer_load_dwordx4 a[120:123], v1, s[12:15], s58 offen sc1
 v_cndmask_b32 v218, v220, v219, vcc
 v_mfma_f32_16x16x32_bf16 v[144:147], v[36:39], a[40:43], v[144:147]
 ds_read_b64_tr_b16 v[66:67], v6 offset:4864
 v_mul_u32_u24 v219, 1152, v217
 v_mfma_f32_16x16x32_bf16 v[144:147], v[40:43], a[48:51], v[144:147]
 s_add_u32 m0, s53, 45056
 ds_read_b64_tr_b16 v[68:69], v6 offset:9472
 v_lshl_add_u32 v219, v214, 4, v219
 v_mfma_f32_16x16x32_bf16 v[144:147], v[44:47], a[56:59], v[144:147]
 ds_read_b64_tr_b16 v[70:71], v6 offset:14080
 buffer_load_dwordx4 v5, s[16:19], s57 offen lds
 v_mul_u32_u24 v220, 2304, v213
 v_mfma_f32_16x16x32_bf16 v[148:151], v[32:35], a[36:39], v[148:151]
 s_add_u32 s58, s54, 179200
 ds_read_b64_tr_b16 v[72:73], v6 offset:18688
 v_lshl_add_u32 v220, v214, 5, v220
 v_mfma_f32_16x16x32_bf16 v[148:151], v[36:39], a[44:47], v[148:151]
 ds_read_b64_tr_b16 v[74:75], v6 offset:23296
 buffer_load_dwordx4 a[124:127], v1, s[12:15], s58 offen sc1
 v_add_u32 v205, 34816, v220
 v_mfma_f32_16x16x32_bf16 v[148:151], v[40:43], a[52:55], v[148:151]
 ds_read_b64_tr_b16 v[76:77], v6 offset:27904
 v_lshlrev_b32 v220, 2, v213
 v_mfma_f32_16x16x32_bf16 v[148:151], v[44:47], a[60:63], v[148:151]
 ds_read_b64_tr_b16 v[78:79], v6 offset:32512
 s_waitcnt lgkmcnt(8)
 v_add_u32 v208, 60000, v220
 v_mfma_f32_16x16x32_bf16 v[152:155], v[48:51], a[32:35], v[152:155]
 v_mov_b32 v199, v218
 v_mfma_f32_16x16x32_bf16 v[152:155], v[52:55], a[40:43], v[152:155]
 v_mov_b32 v202, v219
 v_mfma_f32_16x16x32_bf16 v[152:155], v[56:59], a[48:51], v[152:155]
 v_mfma_f32_16x16x32_bf16 v[152:155], v[60:63], a[56:59], v[152:155]
 s_lshl_b32 s46, s20, 6
 v_mfma_f32_16x16x32_bf16 v[156:159], v[48:51], a[36:39], v[156:159]
 s_waitcnt vmcnt(34)
 v_cmp_eq_u32_e64 s[62:63], s60, v229
 s_nop 0
 s_cmp_eq_u64 s[62:63], exec
 s_cbranch_scc0 L_poll3
L_back3:
 v_add_u32 v6, 36864, v6
 s_add_u32 s46, s46, 256
 v_mfma_f32_16x16x32_bf16 v[156:159], v[52:55], a[44:47], v[156:159]
 s_waitcnt lgkmcnt(0)
 s_barrier
 v_add_u32 v212, s46, v0
 v_mfma_f32_16x16x32_bf16 v[156:159], v[56:59], a[52:55], v[156:159]
 ds_read_b64_tr_b16 v[32:33], v6 offset:0
 ds_read_b64_tr_b16 v[34:35], v6 offset:4608
 s_lshl_b32 s43, s2, 2
 s_add_u32 s43, s43, 42611328
 v_mov_b32 v83, s60
 s_cmp_eq_u32 s20, 0
 s_cselect_b32 s77, s43, 0x7ff00000
 s_mov_b64 exec, 1
 buffer_store_dword v83, v1, s[12:15], s77 offen offset:0 sc1
 s_mov_b64 exec, -1
 v_mul_u32_u24 v213, 911, v212
 v_mfma_f32_16x16x32_bf16 v[156:159], v[60:63], a[60:63], v[156:159]
 ds_read_b64_tr_b16 v[36:37], v6 offset:9216
 ds_read_b64_tr_b16 v[38:39], v6 offset:13824
 v_lshrrev_b32 v213, 16, v213
 v_mfma_f32_16x16x32_bf16 v[160:163], v[64:67], a[32:35], v[160:163]
 ds_read_b64_tr_b16 v[40:41], v6 offset:18432
 ds_read_b64_tr_b16 v[42:43], v6 offset:23040
 v_mul_u32_u24 v214, 72, v213
 v_mfma_f32_16x16x32_bf16 v[160:163], v[68:71], a[40:43], v[160:163]
 ds_read_b64_tr_b16 v[44:45], v6 offset:27648
 ds_read_b64_tr_b16 v[46:47], v6 offset:32256
 v_sub_u32 v214, v212, v214
 v_mfma_f32_16x16x32_bf16 v[160:163], v[72:75], a[48:51], v[160:163]
 ds_read_b64_tr_b16 v[48:49], v6 offset:32
 ds_read_b64_tr_b16 v[50:51], v6 offset:4640
 v_mul_u32_u24 v215, 3641, v214
 v_mfma_f32_16x16x32_bf16 v[160:163], v[76:79], a[56:59], v[160:163]
 ds_read_b64_tr_b16 v[52:53], v6 offset:9248
 ds_read_b64_tr_b16 v[54:55], v6 offset:13856
 v_lshrrev_b32 v215, 16, v215
 v_mfma_f32_16x16x32_bf16 v[164:167], v[64:67], a[36:39], v[164:167]
 ds_read_b64_tr_b16 v[56:57], v6 offset:18464
 ds_read_b64_tr_b16 v[58:59], v6 offset:23072
 v_mul_u32_u24 v216, 18, v215
 v_mfma_f32_16x16x32_bf16 v[164:167], v[68:71], a[44:47], v[164:167]
 ds_read_b64_tr_b16 v[60:61], v6 offset:27680
 ds_read_b64_tr_b16 v[62:63], v6 offset:32288
 v_mfma_f32_16x16x32_bf16 v[164:167], v[72:75], a[52:55], v[164:167]
 v_mfma_f32_16x16x32_bf16 v[164:167], v[76:79], a[60:63], v[164:167]
 s_waitcnt lgkmcnt(8)
 s_waitcnt vmcnt(33)
 v_mfma_f32_16x16x32_bf16 v[96:99], v[32:35], a[64:67], v[96:99]
 ds_read_b64_tr_b16 v[64:65], v6 offset:64
 s_waitcnt vmcnt(29)
 v_mfma_f32_16x16x32_bf16 v[96:99], v[36:39], a[72:75], v[96:99]
 s_add_u32 s57, s51, 737280
 ds_read_b64_tr_b16 v[66:67], v6 offset:4672
 s_waitcnt vmcnt(25)
 v_mfma_f32_16x16x32_bf16 v[96:99], v[40:43], a[80:83], v[96:99]
 s_add_u32 m0, s53, 73728
 ds_read_b64_tr_b16 v[68:69], v6 offset:9280
 v_sub_u32 v216, v214, v216
 s_waitcnt vmcnt(20)
 v_mfma_f32_16x16x32_bf16 v[96:99], v[44:47], a[88:91], v[96:99]
 ds_read_b64_tr_b16 v[70:71], v6 offset:13888
 buffer_load_dwordx4 v2, s[16:19], s57 offen lds
 v_lshlrev_b32 v217, 8, v213
 v_mfma_f32_16x16x32_bf16 v[100:103], v[32:35], a[68:71], v[100:103]
 s_add_u32 s58, s54, 2048
 ds_read_b64_tr_b16 v[72:73], v6 offset:18496
 v_add_u32 v217, s3, v217
 v_mfma_f32_16x16x32_bf16 v[100:103], v[36:39], a[76:79], v[100:103]
 ds_read_b64_tr_b16 v[74:75], v6 offset:23104
 buffer_load_dwordx4 a[0:3], v1, s[12:15], s58 offen sc1
 s_lshr_b32 s47, s3, 4
 v_mfma_f32_16x16x32_bf16 v[100:103], v[40:43], a[84:87], v[100:103]
 ds_read_b64_tr_b16 v[76:77], v6 offset:27712
 s_lshl_b32 s47, s47, 7
 s_waitcnt vmcnt(20)
 v_mfma_f32_16x16x32_bf16 v[100:103], v[44:47], a[92:95], v[100:103]
 ds_read_b64_tr_b16 v[78:79], v6 offset:32320
 s_waitcnt lgkmcnt(8)
 s_and_b32 s48, s3, 15
 v_mfma_f32_16x16x32_bf16 v[104:107], v[48:51], a[64:67], v[104:107]
 s_add_u32 m0, s53, 74752
 ds_read_b64_tr_b16 v[32:33], v6 offset:96
 s_add_u32 s47, s47, s48
 v_mfma_f32_16x16x32_bf16 v[104:107], v[52:55], a[72:75], v[104:107]
 ds_read_b64_tr_b16 v[34:35], v6 offset:4704
 buffer_load_dwordx4 v3, s[16:19], s57 offen lds
 v_lshlrev_b32 v218, 4, v213
 v_mfma_f32_16x16x32_bf16 v[104:107], v[56:59], a[80:83], v[104:107]
 s_add_u32 s58, s54, 149504
 ds_read_b64_tr_b16 v[36:37], v6 offset:9312
 v_add_u32 v218, s47, v218
 v_mfma_f32_16x16x32_bf16 v[104:107], v[60:63], a[88:91], v[104:107]
 ds_read_b64_tr_b16 v[38:39], v6 offset:13920
 buffer_load_dwordx4 a[4:7], v1, s[12:15], s58 offen sc1
 v_lshl_add_u32 v219, v215, 11, v218
 v_mfma_f32_16x16x32_bf16 v[108:111], v[48:51], a[68:71], v[108:111]
 ds_read_b64_tr_b16 v[40:41], v6 offset:18528
 v_lshlrev_b32 v220, 7, v219
 v_mfma_f32_16x16x32_bf16 v[108:111], v[52:55], a[76:79], v[108:111]
 s_add_u32 m0, s53, 75776
 ds_read_b64_tr_b16 v[42:43], v6 offset:23136
 v_mfma_f32_16x16x32_bf16 v[108:111], v[56:59], a[84:87], v[108:111]
 ds_read_b64_tr_b16 v[44:45], v6 offset:27744
 buffer_load_dwordx4 v10, s[16:19], s57 offen lds
 v_lshrrev_b32 v218, 3, v216
 v_mfma_f32_16x16x32_bf16 v[108:111], v[60:63], a[92:95], v[108:111]
 ds_read_b64_tr_b16 v[46:47], v6 offset:32352
 s_waitcnt lgkmcnt(8)
 s_mov_b32 s47, 4201344
 v_mfma_f32_16x16x32_bf16 v[112:115], v[64:67], a[64:67], v[112:115]
 ds_read_b64_tr_b16 v[48:49], v6 offset:128
 v_mul_lo_u32 v218, s47, v218
 v_mfma_f32_16x16x32_bf16 v[112:115], v[68:71], a[72:75], v[112:115]
 s_add_u32 s58, s54, 6144
 ds_read_b64_tr_b16 v[50:51], v6 offset:4736
 v_add_u32 v220, v218, v220
 v_mfma_f32_16x16x32_bf16 v[112:115], v[72:75], a[80:83], v[112:115]
 ds_read_b64_tr_b16 v[52:53], v6 offset:9344
 buffer_load_dwordx4 a[8:11], v1, s[12:15], s58 offen sc1
 v_and_b32 v218, 7, v216
 v_mfma_f32_16x16x32_bf16 v[112:115], v[76:79], a[88:91], v[112:115]
 s_add_u32 m0, s53, 76800
 ds_read_b64_tr_b16 v[54:55], v6 offset:13952
 v_lshl_add_u32 v220, v218, 4, v220
 v_mfma_f32_16x16x32_bf16 v[116:119], v[64:67], a[68:71], v[116:119]
 ds_read_b64_tr_b16 v[56:57], v6 offset:18560
 buffer_load_dwordx4 v11, s[16:19], s57 offen lds
 v_lshlrev_b32 v219, 5, v219
 v_mfma_f32_16x16x32_bf16 v[116:119], v[68:71], a[76:79], v[116:119]
 ds_read_b64_tr_b16 v[58:59], v6 offset:23168
 v_and_b32 v218, 1, v216
 v_mfma_f32_16x16x32_bf16 v[116:119], v[72:75], a[84:87], v[116:119]
 ds_read_b64_tr_b16 v[60:61], v6 offset:27776
 v_lshl_add_u32 v219, v218, 4, v219
 v_mfma_f32_16x16x32_bf16 v[116:119], v[76:79], a[92:95], v[116:119]
 ds_read_b64_tr_b16 v[62:63], v6 offset:32384
 s_waitcnt lgkmcnt(8)
 v_add_u32 v219, 8402688, v219
 v_mfma_f32_16x16x32_bf16 v[120:123], v[32:35], a[64:67], v[120:123]
 s_add_u32 s58, s54, 153600
 ds_read_b64_tr_b16 v[64:65], v6 offset:160
 v_mfma_f32_16x16x32_bf16 v[120:123], v[36:39], a[72:75], v[120:123]
 ds_read_b64_tr_b16 v[66:67], v6 offset:4768
 buffer_load_dwordx4 a[12:15], v1, s[12:15], s58 offen sc1
 v_cmp_lt_u32 vcc, 15, v216
 v_mfma_f32_16x16x32_bf16 v[120:123], v[40:43], a[80:83], v[120:123]
 s_add_u32 m0, s53, 77824
 ds_read_b64_tr_b16 v[68:69], v6 offset:9376
 v_cndmask_b32 v218, v220, v219, vcc
 v_mfma_f32_16x16x32_bf16 v[120:123], v[44:47], a[88:91], v[120:123]
 ds_read_b64_tr_b16 v[70:71], v6 offset:13984
 buffer_load_dwordx4 v12, s[16:19], s57 offen lds
 v_mul_u32_u24 v219, 1152, v217
 v_mfma_f32_16x16x32_bf16 v[124:127], v[32:35], a[68:71], v[124:127]
 ds_read_b64_tr_b16 v[72:73], v6 offset:18592
 v_lshl_add_u32 v219, v214, 4, v219
 v_mfma_f32_16x16x32_bf16 v[124:127], v[36:39], a[76:79], v[124:127]
 ds_read_b64_tr_b16 v[74:75], v6 offset:23200
 v_mul_u32_u24 v220, 2304, v213
 v_mfma_f32_16x16x32_bf16 v[124:127], v[40:43], a[84:87], v[124:127]
 ds_read_b64_tr_b16 v[76:77], v6 offset:27808
 v_lshl_add_u32 v220, v214, 5, v220
 v_mfma_f32_16x16x32_bf16 v[124:127], v[44:47], a[92:95], v[124:127]
 ds_read_b64_tr_b16 v[78:79], v6 offset:32416
 s_waitcnt lgkmcnt(8)
 v_add_u32 v206, 34816, v220
 v_mfma_f32_16x16x32_bf16 v[128:131], v[48:51], a[64:67], v[128:131]
 s_add_u32 s58, s54, 10240
 ds_read_b64_tr_b16 v[32:33], v6 offset:192
 v_lshlrev_b32 v220, 2, v213
 v_mfma_f32_16x16x32_bf16 v[128:131], v[52:55], a[72:75], v[128:131]
 ds_read_b64_tr_b16 v[34:35], v6 offset:4800
 buffer_load_dwordx4 a[16:19], v1, s[12:15], s58 offen sc1
 v_add_u32 v209, 60000, v220
 v_mfma_f32_16x16x32_bf16 v[128:131], v[56:59], a[80:83], v[128:131]
 s_add_u32 m0, s53, 78848
 ds_read_b64_tr_b16 v[36:37], v6 offset:9408
 v_mov_b32 v200, v218
 v_mfma_f32_16x16x32_bf16 v[128:131], v[60:63], a[88:91], v[128:131]
 ds_read_b64_tr_b16 v[38:39], v6 offset:14016
 buffer_load_dwordx4 v13, s[16:19], s57 offen lds
 v_mfma_f32_16x16x32_bf16 v[132:135], v[48:51], a[68:71], v[132:135]
 ds_read_b64_tr_b16 v[40:41], v6 offset:18624
 v_mov_b32 v203, v219
 v_mfma_f32_16x16x32_bf16 v[132:135], v[52:55], a[76:79], v[132:135]
 ds_read_b64_tr_b16 v[42:43], v6 offset:23232
 s_lshl_b32 s46, s20, 6
 v_mfma_f32_16x16x32_bf16 v[132:135], v[56:59], a[84:87], v[132:135]
 s_add_u32 m0, s53, 79872
 ds_read_b64_tr_b16 v[44:45], v6 offset:27840
 s_add_u32 s46, s46, 512
 v_mfma_f32_16x16x32_bf16 v[132:135], v[60:63], a[92:95], v[132:135]
 ds_read_b64_tr_b16 v[46:47], v6 offset:32448
 s_waitcnt lgkmcnt(8)
 v_add_u32 v212, s46, v0
 v_mfma_f32_16x16x32_bf16 v[136:139], v[64:67], a[64:67], v[136:139]
 ds_read_b64_tr_b16 v[48:49], v6 offset:224
 buffer_load_dwordx4 v14, s[16:19], s57 offen lds
 v_mul_u32_u24 v213, 911, v212
 v_mfma_f32_16x16x32_bf16 v[136:139], v[68:71], a[72:75], v[136:139]
 s_add_u32 s58, s54, 157696
 ds_read_b64_tr_b16 v[50:51], v6 offset:4832
 v_lshrrev_b32 v213, 16, v213
 v_mfma_f32_16x16x32_bf16 v[136:139], v[72:75], a[80:83], v[136:139]
 ds_read_b64_tr_b16 v[52:53], v6 offset:9440
 buffer_load_dwordx4 a[20:23], v1, s[12:15], s58 offen sc1
 v_mul_u32_u24 v214, 72, v213
 v_mfma_f32_16x16x32_bf16 v[136:139], v[76:79], a[88:91], v[136:139]
 ds_read_b64_tr_b16 v[54:55], v6 offset:14048
 v_sub_u32 v214, v212, v214
 v_mfma_f32_16x16x32_bf16 v[140:143], v[64:67], a[68:71], v[140:143]
 s_add_u32 m0, s53, 80896
 ds_read_b64_tr_b16 v[56:57], v6 offset:18656
 v_mul_u32_u24 v215, 3641, v214
 v_mfma_f32_16x16x32_bf16 v[140:143], v[68:71], a[76:79], v[140:143]
 ds_read_b64_tr_b16 v[58:59], v6 offset:23264
 buffer_load_dwordx4 v15, s[16:19], s57 offen lds
 v_lshrrev_b32 v215, 16, v215
 v_mfma_f32_16x16x32_bf16 v[140:143], v[72:75], a[84:87], v[140:143]
 s_add_u32 s58, s54, 14336
 ds_read_b64_tr_b16 v[60:61], v6 offset:27872
 v_mul_u32_u24 v216, 18, v215
 v_mfma_f32_16x16x32_bf16 v[140:143], v[76:79], a[92:95], v[140:143]
 ds_read_b64_tr_b16 v[62:63], v6 offset:32480
 s_waitcnt lgkmcnt(8)
 v_mfma_f32_16x16x32_bf16 v[144:147], v[32:35], a[64:67], v[144:147]
 ds_read_b64_tr_b16 v[64:65], v6 offset:256
 buffer_load_dwordx4 a[24:27], v1, s[12:15], s58 offen sc1
 v_sub_u32 v216, v214, v216
 v_mfma_f32_16x16x32_bf16 v[144:147], v[36:39], a[72:75], v[144:147]
 ds_read_b64_tr_b16 v[66:67], v6 offset:4864
 v_lshlrev_b32 v217, 8, v213
 v_mfma_f32_16x16x32_bf16 v[144:147], v[40:43], a[80:83], v[144:147]
 s_add_u32 m0, s53, 81920
 ds_read_b64_tr_b16 v[68:69], v6 offset:9472
 v_add_u32 v217, s3, v217
 v_mfma_f32_16x16x32_bf16 v[144:147], v[44:47], a[88:91], v[144:147]
 ds_read_b64_tr_b16 v[70:71], v6 offset:14080
 buffer_load_dwordx4 v5, s[16:19], s57 offen lds
 s_lshr_b32 s47, s3, 4
 v_mfma_f32_16x16x32_bf16 v[148:151], v[32:35], a[68:71], v[148:151]
 s_add_u32 s58, s54, 161792
 ds_read_b64_tr_b16 v[72:73], v6 offset:18688
 s_lshl_b32 s47, s47, 7
 v_mfma_f32_16x16x32_bf16 v[148:151], v[36:39], a[76:79], v[148:151]
 ds_read_b64_tr_b16 v[74:75], v6 offset:23296
 buffer_load_dwordx4 a[28:31], v1, s[12:15], s58 offen sc1
 s_and_b32 s48, s3, 15
 v_mfma_f32_16x16x32_bf16 v[148:151], v[40:43], a[84:87], v[148:151]
 ds_read_b64_tr_b16 v[76:77], v6 offset:27904
 s_add_u32 s47, s47, s48
 v_mfma_f32_16x16x32_bf16 v[148:151], v[44:47], a[92:95], v[148:151]
 ds_read_b64_tr_b16 v[78:79], v6 offset:32512
 s_waitcnt lgkmcnt(8)
 v_lshlrev_b32 v218, 4, v213
 v_mfma_f32_16x16x32_bf16 v[152:155], v[48:51], a[64:67], v[152:155]
 v_add_u32 v218, s47, v218
 v_mfma_f32_16x16x32_bf16 v[152:155], v[52:55], a[72:75], v[152:155]
 v_lshl_add_u32 v219, v215, 11, v218
 v_mfma_f32_16x16x32_bf16 v[152:155], v[56:59], a[80:83], v[152:155]
 v_mfma_f32_16x16x32_bf16 v[152:155], v[60:63], a[88:91], v[152:155]
 v_lshlrev_b32 v220, 7, v219
 v_mfma_f32_16x16x32_bf16 v[156:159], v[48:51], a[68:71], v[156:159]
 v_subrev_u32 v6, 110592, v6
 v_lshrrev_b32 v218, 3, v216
 v_mfma_f32_16x16x32_bf16 v[156:159], v[52:55], a[76:79], v[156:159]
 s_waitcnt lgkmcnt(0)
 s_barrier
 s_mov_b32 s47, 4201344
 v_mfma_f32_16x16x32_bf16 v[156:159], v[56:59], a[84:87], v[156:159]
 ds_read_b64_tr_b16 v[32:33], v6 offset:0
 ds_read_b64_tr_b16 v[34:35], v6 offset:4608
 v_mul_lo_u32 v218, s47, v218
 v_mfma_f32_16x16x32_bf16 v[156:159], v[60:63], a[92:95], v[156:159]
 ds_read_b64_tr_b16 v[36:37], v6 offset:9216
 ds_read_b64_tr_b16 v[38:39], v6 offset:13824
 v_add_u32 v220, v218, v220
 v_mfma_f32_16x16x32_bf16 v[160:163], v[64:67], a[64:67], v[160:163]
 ds_read_b64_tr_b16 v[40:41], v6 offset:18432
 ds_read_b64_tr_b16 v[42:43], v6 offset:23040
 v_and_b32 v218, 7, v216
 v_mfma_f32_16x16x32_bf16 v[160:163], v[68:71], a[72:75], v[160:163]
 ds_read_b64_tr_b16 v[44:45], v6 offset:27648
 ds_read_b64_tr_b16 v[46:47], v6 offset:32256
 v_lshl_add_u32 v220, v218, 4, v220
 v_mfma_f32_16x16x32_bf16 v[160:163], v[72:75], a[80:83], v[160:163]
 ds_read_b64_tr_b16 v[48:49], v6 offset:32
 ds_read_b64_tr_b16 v[50:51], v6 offset:4640
 v_lshlrev_b32 v219, 5, v219
 v_mfma_f32_16x16x32_bf16 v[160:163], v[76:79], a[88:91], v[160:163]
 ds_read_b64_tr_b16 v[52:53], v6 offset:9248
 ds_read_b64_tr_b16 v[54:55], v6 offset:13856
 v_and_b32 v218, 1, v216
 v_mfma_f32_16x16x32_bf16 v[164:167], v[64:67], a[68:71], v[164:167]
 ds_read_b64_tr_b16 v[56:57], v6 offset:18464
 ds_read_b64_tr_b16 v[58:59], v6 offset:23072
 v_lshl_add_u32 v219, v218, 4, v219
 v_mfma_f32_16x16x32_bf16 v[164:167], v[68:71], a[76:79], v[164:167]
 ds_read_b64_tr_b16 v[60:61], v6 offset:27680
 ds_read_b64_tr_b16 v[62:63], v6 offset:32288
 v_mfma_f32_16x16x32_bf16 v[164:167], v[72:75], a[84:87], v[164:167]
 v_mfma_f32_16x16x32_bf16 v[164:167], v[76:79], a[92:95], v[164:167]
 s_waitcnt lgkmcnt(8)
 s_waitcnt vmcnt(33)
 v_mfma_f32_16x16x32_bf16 v[96:99], v[32:35], a[96:99], v[96:99]
 ds_read_b64_tr_b16 v[64:65], v6 offset:64
 s_waitcnt vmcnt(29)
 v_mfma_f32_16x16x32_bf16 v[96:99], v[36:39], a[104:107], v[96:99]
 s_add_u32 s57, s51, 110592
 ds_read_b64_tr_b16 v[66:67], v6 offset:4672
 s_waitcnt vmcnt(25)
 v_mfma_f32_16x16x32_bf16 v[96:99], v[40:43], a[112:115], v[96:99]
 s_add_u32 m0, s53, 110592
 ds_read_b64_tr_b16 v[68:69], v6 offset:9280
 v_add_u32 v219, 8402688, v219
 s_waitcnt vmcnt(20)
 v_mfma_f32_16x16x32_bf16 v[96:99], v[44:47], a[120:123], v[96:99]
 ds_read_b64_tr_b16 v[70:71], v6 offset:13888
 buffer_load_dwordx4 v2, s[16:19], s57 offen lds
 v_cmp_lt_u32 vcc, 15, v216
 v_mfma_f32_16x16x32_bf16 v[100:103], v[32:35], a[100:103], v[100:103]
 s_add_u32 s58, s54, 20480
 ds_read_b64_tr_b16 v[72:73], v6 offset:18496
 v_cndmask_b32 v218, v220, v219, vcc
 v_mfma_f32_16x16x32_bf16 v[100:103], v[36:39], a[108:111], v[100:103]
 ds_read_b64_tr_b16 v[74:75], v6 offset:23104
 buffer_load_dwordx4 a[32:35], v1, s[12:15], s58 offen sc1
 v_mul_u32_u24 v219, 1152, v217
 v_mfma_f32_16x16x32_bf16 v[100:103], v[40:43], a[116:119], v[100:103]
 s_add_u32 s42, s32, 8192
 ds_read_b64_tr_b16 v[76:77], v6 offset:27712
 v_lshl_add_u32 v219, v214, 4, v219
 s_waitcnt vmcnt(20)
 v_mfma_f32_16x16x32_bf16 v[100:103], v[44:47], a[124:127], v[100:103]
 ds_read_b64_tr_b16 v[78:79], v6 offset:32320
 s_waitcnt lgkmcnt(8)
 v_mul_u32_u24 v220, 2304, v213
 v_mfma_f32_16x16x32_bf16 v[104:107], v[48:51], a[96:99], v[104:107]
 ds_read_b64_tr_b16 v[32:33], v6 offset:96
 buffer_load_dword v80, v81, s[12:15], s42 offen offset:0 sc1
 v_lshl_add_u32 v220, v214, 5, v220
 v_mfma_f32_16x16x32_bf16 v[104:107], v[52:55], a[104:107], v[104:107]
 s_add_u32 m0, s53, 111616
 ds_read_b64_tr_b16 v[34:35], v6 offset:4704
 v_add_u32 v207, 34816, v220
 v_mfma_f32_16x16x32_bf16 v[104:107], v[56:59], a[112:115], v[104:107]
 ds_read_b64_tr_b16 v[36:37], v6 offset:9312
 buffer_load_dwordx4 v3, s[16:19], s57 offen lds
 v_lshlrev_b32 v220, 2, v213
 v_mfma_f32_16x16x32_bf16 v[104:107], v[60:63], a[120:123], v[104:107]
 s_add_u32 s58, s54, 167936
 ds_read_b64_tr_b16 v[38:39], v6 offset:13920
 v_add_u32 v210, 60000, v220
 v_mfma_f32_16x16x32_bf16 v[108:111], v[48:51], a[100:103], v[108:111]
 ds_read_b64_tr_b16 v[40:41], v6 offset:18528
 buffer_load_dwordx4 a[36:39], v1, s[12:15], s58 offen sc1
 v_cmp_gt_u32 vcc, 576, v212
 v_mfma_f32_16x16x32_bf16 v[108:111], v[52:55], a[108:111], v[108:111]
 s_add_u32 m0, s53, 112640
 ds_read_b64_tr_b16 v[42:43], v6 offset:23136
 v_mfma_f32_16x16x32_bf16 v[108:111], v[56:59], a[116:119], v[108:111]
 ds_read_b64_tr_b16 v[44:45], v6 offset:27744
 buffer_load_dwordx4 v10, s[16:19], s57 offen lds
 v_mov_b32 v220, 0x7ffffff0
 v_mfma_f32_16x16x32_bf16 v[108:111], v[60:63], a[124:127], v[108:111]
 ds_read_b64_tr_b16 v[46:47], v6 offset:32352
 s_waitcnt lgkmcnt(8)
 v_cndmask_b32 v218, v220, v218, vcc
 v_mfma_f32_16x16x32_bf16 v[112:115], v[64:67], a[96:99], v[112:115]
 ds_read_b64_tr_b16 v[48:49], v6 offset:128
 v_cndmask_b32 v219, v220, v219, vcc
 v_mfma_f32_16x16x32_bf16 v[112:115], v[68:71], a[104:107], v[112:115]
 s_add_u32 s58, s54, 24576
 ds_read_b64_tr_b16 v[50:51], v6 offset:4736
 v_mov_b32 v220, 34816
 v_mfma_f32_16x16x32_bf16 v[112:115], v[72:75], a[112:115], v[112:115]
 ds_read_b64_tr_b16 v[52:53], v6 offset:9344
 buffer_load_dwordx4 a[40:43], v1, s[12:15], s58 offen sc1
 v_cndmask_b32 v207, v220, v207, vcc
 v_mfma_f32_16x16x32_bf16 v[112:115], v[76:79], a[120:123], v[112:115]
 s_add_u32 m0, s53, 113664
 ds_read_b64_tr_b16 v[54:55], v6 offset:13952
 v_mov_b32 v220, 60000
 v_mfma_f32_16x16x32_bf16 v[116:119], v[64:67], a[100:103], v[116:119]
 ds_read_b64_tr_b16 v[56:57], v6 offset:18560
 buffer_load_dwordx4 v11, s[16:19], s57 offen lds
 v_cndmask_b32 v210, v220, v210, vcc
 v_mfma_f32_16x16x32_bf16 v[116:119], v[68:71], a[108:111], v[116:119]
 ds_read_b64_tr_b16 v[58:59], v6 offset:23168
 v_mov_b32 v201, v218
 v_mfma_f32_16x16x32_bf16 v[116:119], v[72:75], a[116:119], v[116:119]
 ds_read_b64_tr_b16 v[60:61], v6 offset:27776
 v_mov_b32 v204, v219
 v_mfma_f32_16x16x32_bf16 v[116:119], v[76:79], a[124:127], v[116:119]
 ds_read_b64_tr_b16 v[62:63], v6 offset:32384
 s_waitcnt lgkmcnt(8)
 v_and_b32 v212, 15, v0
 v_mfma_f32_16x16x32_bf16 v[120:123], v[32:35], a[96:99], v[120:123]
 s_add_u32 s58, s54, 172032
 ds_read_b64_tr_b16 v[64:65], v6 offset:160
 v_mfma_f32_16x16x32_bf16 v[120:123], v[36:39], a[104:107], v[120:123]
 ds_read_b64_tr_b16 v[66:67], v6 offset:4768
 buffer_load_dwordx4 a[44:47], v1, s[12:15], s58 offen sc1
 v_lshrrev_b32 v213, 4, v0
 v_mfma_f32_16x16x32_bf16 v[120:123], v[40:43], a[112:115], v[120:123]
 s_add_u32 m0, s53, 114688
 ds_read_b64_tr_b16 v[68:69], v6 offset:9376
 s_lshl_b32 s46, s20, 9
 v_mfma_f32_16x16x32_bf16 v[120:123], v[44:47], a[120:123], v[120:123]
 ds_read_b64_tr_b16 v[70:71], v6 offset:13984
 buffer_load_dwordx4 v12, s[16:19], s57 offen lds
 s_add_u32 s46, s46, 0
 v_mfma_f32_16x16x32_bf16 v[124:127], v[32:35], a[100:103], v[124:127]
 ds_read_b64_tr_b16 v[72:73], v6 offset:18592
 v_and_b32 v224, 1, v213
 v_mfma_f32_16x16x32_bf16 v[124:127], v[36:39], a[108:111], v[124:127]
 ds_read_b64_tr_b16 v[74:75], v6 offset:23200
 v_lshlrev_b32 v224, 4, v224
 v_mfma_f32_16x16x32_bf16 v[124:127], v[40:43], a[116:119], v[124:127]
 ds_read_b64_tr_b16 v[76:77], v6 offset:27808
 v_lshl_add_u32 v224, v212, 5, v224
 v_mfma_f32_16x16x32_bf16 v[124:127], v[44:47], a[124:127], v[124:127]
 ds_read_b64_tr_b16 v[78:79], v6 offset:32416
 s_waitcnt lgkmcnt(8)
 v_add_u32 v178, s46, v224
 v_mfma_f32_16x16x32_bf16 v[128:131], v[48:51], a[96:99], v[128:131]
 s_add_u32 s58, s54, 28672
 ds_read_b64_tr_b16 v[32:33], v6 offset:192
 s_mov_b32 s50, 0xffff
 v_mfma_f32_16x16x32_bf16 v[128:131], v[52:55], a[104:107], v[128:131]
 ds_read_b64_tr_b16 v[34:35], v6 offset:4800
 buffer_load_dwordx4 a[48:51], v1, s[12:15], s58 offen sc1
 s_lshl_b32 s46, s20, 4
 v_mfma_f32_16x16x32_bf16 v[128:131], v[56:59], a[112:115], v[128:131]
 s_add_u32 m0, s53, 115712
 ds_read_b64_tr_b16 v[36:37], v6 offset:9408
 s_add_u32 s46, s46, 0
 v_mfma_f32_16x16x32_bf16 v[128:131], v[60:63], a[120:123], v[128:131]
 ds_read_b64_tr_b16 v[38:39], v6 offset:14016
 buffer_load_dwordx4 v13, s[16:19], s57 offen lds
 v_mfma_f32_16x16x32_bf16 v[132:135], v[48:51], a[100:103], v[132:135]
 ds_read_b64_tr_b16 v[40:41], v6 offset:18624
 v_add_u32 v224, s46, v212
 v_mfma_f32_16x16x32_bf16 v[132:135], v[52:55], a[108:111], v[132:135]
 ds_read_b64_tr_b16 v[42:43], v6 offset:23232
 v_mov_b32 v225, 700
 v_mfma_f32_16x16x32_bf16 v[132:135], v[56:59], a[116:119], v[132:135]
 s_add_u32 m0, s53, 116736
 ds_read_b64_tr_b16 v[44:45], v6 offset:27840
 v_cmp_ge_u32 vcc, 288, v224
 v_mfma_f32_16x16x32_bf16 v[132:135], v[60:63], a[124:127], v[132:135]
 ds_read_b64_tr_b16 v[46:47], v6 offset:32448
 s_waitcnt lgkmcnt(8)
 v_cndmask_b32 v226, v225, v224, vcc
 v_mfma_f32_16x16x32_bf16 v[136:139], v[64:67], a[96:99], v[136:139]
 ds_read_b64_tr_b16 v[48:49], v6 offset:224
 buffer_load_dwordx4 v14, s[16:19], s57 offen lds
 v_sub_u32 v227, 576, v224
 v_mfma_f32_16x16x32_bf16 v[136:139], v[68:71], a[104:107], v[136:139]
 s_add_u32 s58, s54, 176128
 ds_read_b64_tr_b16 v[50:51], v6 offset:4832
 v_add_u32 v228, -1, v224
 v_mfma_f32_16x16x32_bf16 v[136:139], v[72:75], a[112:115], v[136:139]
 ds_read_b64_tr_b16 v[52:53], v6 offset:9440
 buffer_load_dwordx4 a[52:55], v1, s[12:15], s58 offen sc1
 v_cmp_gt_u32 vcc, 287, v228
 v_mfma_f32_16x16x32_bf16 v[136:139], v[76:79], a[120:123], v[136:139]
 ds_read_b64_tr_b16 v[54:55], v6 offset:14048
 v_cndmask_b32 v227, v225, v227, vcc
 v_mfma_f32_16x16x32_bf16 v[140:143], v[64:67], a[100:103], v[140:143]
 s_add_u32 m0, s53, 117760
 ds_read_b64_tr_b16 v[56:57], v6 offset:18656
 v_mul_u32_u24 v229, 3072, v213
 v_mfma_f32_16x16x32_bf16 v[140:143], v[68:71], a[108:111], v[140:143]
 ds_read_b64_tr_b16 v[58:59], v6 offset:23264
 buffer_load_dwordx4 v15, s[16:19], s57 offen lds
 v_lshl_add_u32 v226, v226, 1, v229
 v_mfma_f32_16x16x32_bf16 v[140:143], v[72:75], a[116:119], v[140:143]
 s_add_u32 s58, s54, 32768
 ds_read_b64_tr_b16 v[60:61], v6 offset:27872
 v_add_u32 v179, 10240, v226
 v_mfma_f32_16x16x32_bf16 v[140:143], v[76:79], a[124:127], v[140:143]
 ds_read_b64_tr_b16 v[62:63], v6 offset:32480
 s_waitcnt lgkmcnt(8)
 v_mfma_f32_16x16x32_bf16 v[144:147], v[32:35], a[96:99], v[144:147]
 ds_read_b64_tr_b16 v[64:65], v6 offset:256
 buffer_load_dwordx4 a[56:59], v1, s[12:15], s58 offen sc1
 v_lshl_add_u32 v227, v227, 1, v229
 v_mfma_f32_16x16x32_bf16 v[144:147], v[36:39], a[104:107], v[144:147]
 ds_read_b64_tr_b16 v[66:67], v6 offset:4864
 v_add_u32 v184, 10240, v227
 v_mfma_f32_16x16x32_bf16 v[144:147], v[40:43], a[112:115], v[144:147]
 s_add_u32 m0, s53, 118784
 ds_read_b64_tr_b16 v[68:69], v6 offset:9472
 v_mov_b32 v189, -1
 v_mfma_f32_16x16x32_bf16 v[144:147], v[44:47], a[120:123], v[144:147]
 ds_read_b64_tr_b16 v[70:71], v6 offset:14080
 buffer_load_dwordx4 v5, s[16:19], s57 offen lds
 v_mov_b32 v228, s50
 v_mfma_f32_16x16x32_bf16 v[148:151], v[32:35], a[100:103], v[148:151]
 s_add_u32 s58, s54, 180224
 ds_read_b64_tr_b16 v[72:73], v6 offset:18688
 v_cmp_eq_u32 vcc, 0, v224
 v_mfma_f32_16x16x32_bf16 v[148:151], v[36:39], a[108:111], v[148:151]
 ds_read_b64_tr_b16 v[74:75], v6 offset:23296
 buffer_load_dwordx4 a[60:63], v1, s[12:15], s58 offen sc1
 v_cndmask_b32 v189, v189, v228, vcc
 v_mfma_f32_16x16x32_bf16 v[148:151], v[40:43], a[116:119], v[148:151]
 ds_read_b64_tr_b16 v[76:77], v6 offset:27904
 v_cmp_eq_u32 vcc, 288, v224
 v_mfma_f32_16x16x32_bf16 v[148:151], v[44:47], a[124:127], v[148:151]
 ds_read_b64_tr_b16 v[78:79], v6 offset:32512
 s_waitcnt lgkmcnt(8)
 v_cndmask_b32 v189, v189, v228, vcc
 v_mfma_f32_16x16x32_bf16 v[152:155], v[48:51], a[96:99], v[152:155]
 s_lshl_b32 s46, s20, 4
 v_mfma_f32_16x16x32_bf16 v[152:155], v[52:55], a[104:107], v[152:155]
 s_add_u32 s46, s46, 64
 v_mfma_f32_16x16x32_bf16 v[152:155], v[56:59], a[112:115], v[152:155]
 v_mfma_f32_16x16x32_bf16 v[152:155], v[60:63], a[120:123], v[152:155]
 v_add_u32 v224, s46, v212
 v_mfma_f32_16x16x32_bf16 v[156:159], v[48:51], a[100:103], v[156:159]
 v_add_u32 v6, 36864, v6
 v_mov_b32 v225, 700
 v_mfma_f32_16x16x32_bf16 v[156:159], v[52:55], a[108:111], v[156:159]
 s_waitcnt lgkmcnt(0)
 s_barrier
 v_cmp_ge_u32 vcc, 288, v224
 v_mfma_f32_16x16x32_bf16 v[156:159], v[56:59], a[116:119], v[156:159]
 ds_read_b64_tr_b16 v[32:33], v6 offset:0
 ds_read_b64_tr_b16 v[34:35], v6 offset:4608
 v_cndmask_b32 v226, v225, v224, vcc
 v_mfma_f32_16x16x32_bf16 v[156:159], v[60:63], a[124:127], v[156:159]
 ds_read_b64_tr_b16 v[36:37], v6 offset:9216
 ds_read_b64_tr_b16 v[38:39], v6 offset:13824
 v_sub_u32 v227, 576, v224
 v_mfma_f32_16x16x32_bf16 v[160:163], v[64:67], a[96:99], v[160:163]
 ds_read_b64_tr_b16 v[40:41], v6 offset:18432
 ds_read_b64_tr_b16 v[42:43], v6 offset:23040
 v_add_u32 v228, -1, v224
 v_mfma_f32_16x16x32_bf16 v[160:163], v[68:71], a[104:107], v[160:163]
 ds_read_b64_tr_b16 v[44:45], v6 offset:27648
 ds_read_b64_tr_b16 v[46:47], v6 offset:32256
 v_cmp_gt_u32 vcc, 287, v228
 v_mfma_f32_16x16x32_bf16 v[160:163], v[72:75], a[112:115], v[160:163]
 ds_read_b64_tr_b16 v[48:49], v6 offset:32
 ds_read_b64_tr_b16 v[50:51], v6 offset:4640
 v_cndmask_b32 v227, v225, v227, vcc
 v_mfma_f32_16x16x32_bf16 v[160:163], v[76:79], a[120:123], v[160:163]
 ds_read_b64_tr_b16 v[52:53], v6 offset:9248
 ds_read_b64_tr_b16 v[54:55], v6 offset:13856
 v_mul_u32_u24 v229, 3072, v213
 v_mfma_f32_16x16x32_bf16 v[164:167], v[64:67], a[100:103], v[164:167]
 ds_read_b64_tr_b16 v[56:57], v6 offset:18464
 ds_read_b64_tr_b16 v[58:59], v6 offset:23072
 v_lshl_add_u32 v226, v226, 1, v229
 v_mfma_f32_16x16x32_bf16 v[164:167], v[68:71], a[108:111], v[164:167]
 ds_read_b64_tr_b16 v[60:61], v6 offset:27680
 ds_read_b64_tr_b16 v[62:63], v6 offset:32288
 v_mfma_f32_16x16x32_bf16 v[164:167], v[72:75], a[116:119], v[164:167]
 v_mfma_f32_16x16x32_bf16 v[164:167], v[76:79], a[124:127], v[164:167]
 s_waitcnt lgkmcnt(8)
 s_waitcnt vmcnt(33)
 v_mfma_f32_16x16x32_bf16 v[96:99], v[32:35], a[0:3], v[96:99]
 ds_read_b64_tr_b16 v[64:65], v6 offset:64
 s_waitcnt vmcnt(15)
 v_cmp_eq_u32_e64 s[62:63], s60, v80
 s_nop 0
 s_cmp_eq_u64 s[62:63], exec
 s_cbranch_scc0 L_poll4
L_back4:
 v_mfma_f32_16x16x32_bf16 v[96:99], v[36:39], a[8:11], v[96:99]
 s_add_u32 s57, s51, 774144
 ds_read_b64_tr_b16 v[66:67], v6 offset:4672
 v_mfma_f32_16x16x32_bf16 v[96:99], v[40:43], a[16:19], v[96:99]
 s_add_u32 m0, s53, 0
 ds_read_b64_tr_b16 v[68:69], v6 offset:9280
 v_add_u32 v180, 10240, v226
 v_mfma_f32_16x16x32_bf16 v[96:99], v[44:47], a[24:27], v[96:99]
 ds_read_b64_tr_b16 v[70:71], v6 offset:13888
 buffer_load_dwordx4 v2, s[16:19], s57 offen lds
 v_lshl_add_u32 v227, v227, 1, v229
 v_mfma_f32_16x16x32_bf16 v[100:103], v[32:35], a[4:7], v[100:103]
 ds_read_b64_tr_b16 v[72:73], v6 offset:18496
 v_add_u32 v185, 10240, v227
 v_mfma_f32_16x16x32_bf16 v[100:103], v[36:39], a[12:15], v[100:103]
 s_add_u32 s58, s54, 3072
 ds_read_b64_tr_b16 v[74:75], v6 offset:23104
 v_mov_b32 v190, -1
 v_mfma_f32_16x16x32_bf16 v[100:103], v[40:43], a[20:23], v[100:103]
 ds_read_b64_tr_b16 v[76:77], v6 offset:27712
 buffer_load_dwordx4 a[64:67], v1, s[12:15], s58 offen sc1
 v_mov_b32 v228, s50
 v_mfma_f32_16x16x32_bf16 v[100:103], v[44:47], a[28:31], v[100:103]
 ds_read_b64_tr_b16 v[78:79], v6 offset:32320
 s_waitcnt lgkmcnt(8)
 v_cmp_eq_u32 vcc, 0, v224
 v_mfma_f32_16x16x32_bf16 v[104:107], v[48:51], a[0:3], v[104:107]
 s_add_u32 m0, s53, 1024
 ds_read_b64_tr_b16 v[32:33], v6 offset:96
 v_cndmask_b32 v190, v190, v228, vcc
 v_mfma_f32_16x16x32_bf16 v[104:107], v[52:55], a[8:11], v[104:107]
 ds_read_b64_tr_b16 v[34:35], v6 offset:4704
 buffer_load_dwordx4 v3, s[16:19], s57 offen lds
 v_cmp_eq_u32 vcc, 288, v224
 v_mfma_f32_16x16x32_bf16 v[104:107], v[56:59], a[16:19], v[104:107]
 ds_read_b64_tr_b16 v[36:37], v6 offset:9312
 v_cndmask_b32 v190, v190, v228, vcc
 v_mfma_f32_16x16x32_bf16 v[104:107], v[60:63], a[24:27], v[104:107]
 s_add_u32 s58, s54, 150528
 ds_read_b64_tr_b16 v[38:39], v6 offset:13920
 s_lshl_b32 s46, s20, 4
 v_mfma_f32_16x16x32_bf16 v[108:111], v[48:51], a[4:7], v[108:111]
 ds_read_b64_tr_b16 v[40:41], v6 offset:18528
 buffer_load_dwordx4 a[68:71], v1, s[12:15], s58 offen sc1
 s_add_u32 s46, s46, 128
 v_mfma_f32_16x16x32_bf16 v[108:111], v[52:55], a[12:15], v[108:111]
 s_add_u32 m0, s53, 2048
 ds_read_b64_tr_b16 v[42:43], v6 offset:23136
 v_mfma_f32_16x16x32_bf16 v[108:111], v[56:59], a[20:23], v[108:111]
 ds_read_b64_tr_b16 v[44:45], v6 offset:27744
 buffer_load_dwordx4 v10, s[16:19], s57 offen lds
 v_add_u32 v224, s46, v212
 v_mfma_f32_16x16x32_bf16 v[108:111], v[60:63], a[28:31], v[108:111]
 ds_read_b64_tr_b16 v[46:47], v6 offset:32352
 s_waitcnt lgkmcnt(8)
 v_mov_b32 v225, 700
 v_mfma_f32_16x16x32_bf16 v[112:115], v[64:67], a[0:3], v[112:115]
 ds_read_b64_tr_b16 v[48:49], v6 offset:128
 v_cmp_ge_u32 vcc, 288, v224
 v_mfma_f32_16x16x32_bf16 v[112:115], v[68:71], a[8:11], v[112:115]
 ds_read_b64_tr_b16 v[50:51], v6 offset:4736
 v_cndmask_b32 v226, v225, v224, vcc
 v_mfma_f32_16x16x32_bf16 v[112:115], v[72:75], a[16:19], v[112:115]
 s_add_u32 s58, s54, 7168
 ds_read_b64_tr_b16 v[52:53], v6 offset:9344
 v_sub_u32 v227, 576, v224
 v_mfma_f32_16x16x32_bf16 v[112:115], v[76:79], a[24:27], v[112:115]
 ds_read_b64_tr_b16 v[54:55], v6 offset:13952
 buffer_load_dwordx4 a[72:75], v1, s[12:15], s58 offen sc1
 v_add_u32 v228, -1, v224
 v_mfma_f32_16x16x32_bf16 v[116:119], v[64:67], a[4:7], v[116:119]
 s_add_u32 m0, s53, 3072
 ds_read_b64_tr_b16 v[56:57], v6 offset:18560
 v_cmp_gt_u32 vcc, 287, v228
 v_mfma_f32_16x16x32_bf16 v[116:119], v[68:71], a[12:15], v[116:119]
 ds_read_b64_tr_b16 v[58:59], v6 offset:23168
 buffer_load_dwordx4 v11, s[16:19], s57 offen lds
 v_cndmask_b32 v227, v225, v227, vcc
 v_mfma_f32_16x16x32_bf16 v[116:119], v[72:75], a[20:23], v[116:119]
 ds_read_b64_tr_b16 v[60:61], v6 offset:27776
 v_mul_u32_u24 v229, 3072, v213
 v_mfma_f32_16x16x32_bf16 v[116:119], v[76:79], a[28:31], v[116:119]
 ds_read_b64_tr_b16 v[62:63], v6 offset:32384
 s_waitcnt lgkmcnt(8)
 v_lshl_add_u32 v226, v226, 1, v229
 v_mfma_f32_16x16x32_bf16 v[120:123], v[32:35], a[0:3], v[120:123]
 ds_read_b64_tr_b16 v[64:65], v6 offset:160
 v_mfma_f32_16x16x32_bf16 v[120:123], v[36:39], a[8:11], v[120:123]
 s_add_u32 m0, s53, 4096
 ds_read_b64_tr_b16 v[66:67], v6 offset:4768
 v_add_u32 v181, 10240, v226
 v_mfma_f32_16x16x32_bf16 v[120:123], v[40:43], a[16:19], v[120:123]
 ds_read_b64_tr_b16 v[68:69], v6 offset:9376
 buffer_load_dwordx4 v12, s[16:19], s57 offen lds
 v_lshl_add_u32 v227, v227, 1, v229
 v_mfma_f32_16x16x32_bf16 v[120:123], v[44:47], a[24:27], v[120:123]
 s_add_u32 s58, s54, 154624
 ds_read_b64_tr_b16 v[70:71], v6 offset:13984
 v_add_u32 v186, 10240, v227
 v_mfma_f32_16x16x32_bf16 v[124:127], v[32:35], a[4:7], v[124:127]
 ds_read_b64_tr_b16 v[72:73], v6 offset:18592
 buffer_load_dwordx4 a[76:79], v1, s[12:15], s58 offen sc1
 v_mov_b32 v191, -1
 v_mfma_f32_16x16x32_bf16 v[124:127], v[36:39], a[12:15], v[124:127]
 ds_read_b64_tr_b16 v[74:75], v6 offset:23200
 v_mov_b32 v228, s50
 v_mfma_f32_16x16x32_bf16 v[124:127], v[40:43], a[20:23], v[124:127]
 ds_read_b64_tr_b16 v[76:77], v6 offset:27808
 v_cmp_eq_u32 vcc, 0, v224
 v_mfma_f32_16x16x32_bf16 v[124:127], v[44:47], a[28:31], v[124:127]
 ds_read_b64_tr_b16 v[78:79], v6 offset:32416
 s_waitcnt lgkmcnt(8)
 v_cndmask_b32 v191, v191, v228, vcc
 v_mfma_f32_16x16x32_bf16 v[128:131], v[48:51], a[0:3], v[128:131]
 s_add_u32 m0, s53, 5120
 ds_read_b64_tr_b16 v[32:33], v6 offset:192
 v_cmp_eq_u32 vcc, 288, v224
 v_mfma_f32_16x16x32_bf16 v[128:131], v[52:55], a[8:11], v[128:131]
 ds_read_b64_tr_b16 v[34:35], v6 offset:4800
 buffer_load_dwordx4 v13, s[16:19], s57 offen lds
 v_cndmask_b32 v191, v191, v228, vcc
 v_mfma_f32_16x16x32_bf16 v[128:131], v[56:59], a[16:19], v[128:131]
 s_add_u32 s58, s54, 11264
 ds_read_b64_tr_b16 v[36:37], v6 offset:9408
 s_lshl_b32 s46, s20, 4
 v_mfma_f32_16x16x32_bf16 v[128:131], v[60:63], a[24:27], v[128:131]
 ds_read_b64_tr_b16 v[38:39], v6 offset:14016
 buffer_load_dwordx4 a[80:83], v1, s[12:15], s58 offen sc1
 v_mfma_f32_16x16x32_bf16 v[132:135], v[48:51], a[4:7], v[132:135]
 ds_read_b64_tr_b16 v[40:41], v6 offset:18624
 s_add_u32 s46, s46, 192
 v_mfma_f32_16x16x32_bf16 v[132:135], v[52:55], a[12:15], v[132:135]
 ds_read_b64_tr_b16 v[42:43], v6 offset:23232
 v_add_u32 v224, s46, v212
 v_mfma_f32_16x16x32_bf16 v[132:135], v[56:59], a[20:23], v[132:135]
 s_add_u32 m0, s53, 6144
 ds_read_b64_tr_b16 v[44:45], v6 offset:27840
 v_mov_b32 v225, 700
 v_mfma_f32_16x16x32_bf16 v[132:135], v[60:63], a[28:31], v[132:135]
 ds_read_b64_tr_b16 v[46:47], v6 offset:32448
 s_waitcnt lgkmcnt(8)
 v_cmp_ge_u32 vcc, 288, v224
 v_mfma_f32_16x16x32_bf16 v[136:139], v[64:67], a[0:3], v[136:139]
 ds_read_b64_tr_b16 v[48:49], v6 offset:224
 buffer_load_dwordx4 v14, s[16:19], s57 offen lds
 v_cndmask_b32 v226, v225, v224, vcc
 v_mfma_f32_16x16x32_bf16 v[136:139], v[68:71], a[8:11], v[136:139]
 s_add_u32 s58, s54, 158720
 ds_read_b64_tr_b16 v[50:51], v6 offset:4832
 v_sub_u32 v227, 576, v224
 v_mfma_f32_16x16x32_bf16 v[136:139], v[72:75], a[16:19], v[136:139]
 ds_read_b64_tr_b16 v[52:53], v6 offset:9440
 buffer_load_dwordx4 a[84:87], v1, s[12:15], s58 offen sc1
 v_add_u32 v228, -1, v224
 v_mfma_f32_16x16x32_bf16 v[136:139], v[76:79], a[24:27], v[136:139]
 ds_read_b64_tr_b16 v[54:55], v6 offset:14048
 v_cmp_gt_u32 vcc, 287, v228
 v_mfma_f32_16x16x32_bf16 v[140:143], v[64:67], a[4:7], v[140:143]
 s_add_u32 m0, s53, 7168
 ds_read_b64_tr_b16 v[56:57], v6 offset:18656
 v_cndmask_b32 v227, v225, v227, vcc
 v_mfma_f32_16x16x32_bf16 v[140:143], v[68:71], a[12:15], v[140:143]
 ds_read_b64_tr_b16 v[58:59], v6 offset:23264
 buffer_load_dwordx4 v15, s[16:19], s57 offen lds
 v_mul_u32_u24 v229, 3072, v213
 v_mfma_f32_16x16x32_bf16 v[140:143], v[72:75], a[20:23], v[140:143]
 s_add_u32 s58, s54, 15360
 ds_read_b64_tr_b16 v[60:61], v6 offset:27872
 v_lshl_add_u32 v226, v226, 1, v229
 v_mfma_f32_16x16x32_bf16 v[140:143], v[76:79], a[28:31], v[140:143]
 ds_read_b64_tr_b16 v[62:63], v6 offset:32480
 s_waitcnt lgkmcnt(8)
 v_mfma_f32_16x16x32_bf16 v[144:147], v[32:35], a[0:3], v[144:147]
 ds_read_b64_tr_b16 v[64:65], v6 offset:256
 buffer_load_dwordx4 a[88:91], v1, s[12:15], s58 offen sc1
 v_add_u32 v182, 10240, v226
 v_mfma_f32_16x16x32_bf16 v[144:147], v[36:39], a[8:11], v[144:147]
 ds_read_b64_tr_b16 v[66:67], v6 offset:4864
 v_lshl_add_u32 v227, v227, 1, v229
 v_mfma_f32_16x16x32_bf16 v[144:147], v[40:43], a[16:19], v[144:147]
 s_add_u32 m0, s53, 8192
 ds_read_b64_tr_b16 v[68:69], v6 offset:9472
 v_add_u32 v187, 10240, v227
 v_mfma_f32_16x16x32_bf16 v[144:147], v[44:47], a[24:27], v[144:147]
 ds_read_b64_tr_b16 v[70:71], v6 offset:14080
 buffer_load_dwordx4 v5, s[16:19], s57 offen lds
 v_mov_b32 v192, -1
 v_mfma_f32_16x16x32_bf16 v[148:151], v[32:35], a[4:7], v[148:151]
 s_add_u32 s58, s54, 162816
 ds_read_b64_tr_b16 v[72:73], v6 offset:18688
 v_mov_b32 v228, s50
 v_mfma_f32_16x16x32_bf16 v[148:151], v[36:39], a[12:15], v[148:151]
 ds_read_b64_tr_b16 v[74:75], v6 offset:23296
 buffer_load_dwordx4 a[92:95], v1, s[12:15], s58 offen sc1
 v_cmp_eq_u32 vcc, 0, v224
 v_mfma_f32_16x16x32_bf16 v[148:151], v[40:43], a[20:23], v[148:151]
 ds_read_b64_tr_b16 v[76:77], v6 offset:27904
 v_cndmask_b32 v192, v192, v228, vcc
 v_mfma_f32_16x16x32_bf16 v[148:151], v[44:47], a[28:31], v[148:151]
 ds_read_b64_tr_b16 v[78:79], v6 offset:32512
 s_waitcnt lgkmcnt(8)
 v_cmp_eq_u32 vcc, 288, v224
 v_mfma_f32_16x16x32_bf16 v[152:155], v[48:51], a[0:3], v[152:155]
 s_nop 0
 v_cndmask_b32 v192, v192, v228, vcc
 v_mfma_f32_16x16x32_bf16 v[152:155], v[52:55], a[8:11], v[152:155]
 s_lshl_b32 s46, s20, 4
 v_mfma_f32_16x16x32_bf16 v[152:155], v[56:59], a[16:19], v[152:155]
 v_mfma_f32_16x16x32_bf16 v[152:155], v[60:63], a[24:27], v[152:155]
 s_add_u32 s46, s46, 256
 v_mfma_f32_16x16x32_bf16 v[156:159], v[48:51], a[4:7], v[156:159]
 v_add_u32 v6, 36864, v6
 v_add_u32 v224, s46, v212
 v_mfma_f32_16x16x32_bf16 v[156:159], v[52:55], a[12:15], v[156:159]
 s_waitcnt lgkmcnt(0)
 s_barrier
 v_mov_b32 v225, 700
 v_mfma_f32_16x16x32_bf16 v[156:159], v[56:59], a[20:23], v[156:159]
 ds_read_b64_tr_b16 v[32:33], v6 offset:0
 ds_read_b64_tr_b16 v[34:35], v6 offset:4608
 v_cmp_ge_u32 vcc, 288, v224
 v_mfma_f32_16x16x32_bf16 v[156:159], v[60:63], a[28:31], v[156:159]
 ds_read_b64_tr_b16 v[36:37], v6 offset:9216
 ds_read_b64_tr_b16 v[38:39], v6 offset:13824
 v_cndmask_b32 v226, v225, v224, vcc
 v_mfma_f32_16x16x32_bf16 v[160:163], v[64:67], a[0:3], v[160:163]
 ds_read_b64_tr_b16 v[40:41], v6 offset:18432
 ds_read_b64_tr_b16 v[42:43], v6 offset:23040
 v_sub_u32 v227, 576, v224
 v_mfma_f32_16x16x32_bf16 v[160:163], v[68:71], a[8:11], v[160:163]
 ds_read_b64_tr_b16 v[44:45], v6 offset:27648
 ds_read_b64_tr_b16 v[46:47], v6 offset:32256
 v_add_u32 v228, -1, v224
 v_mfma_f32_16x16x32_bf16 v[160:163], v[72:75], a[16:19], v[160:163]
 ds_read_b64_tr_b16 v[48:49], v6 offset:32
 ds_read_b64_tr_b16 v[50:51], v6 offset:4640
 v_cmp_gt_u32 vcc, 287, v228
 v_mfma_f32_16x16x32_bf16 v[160:163], v[76:79], a[24:27], v[160:163]
 ds_read_b64_tr_b16 v[52:53], v6 offset:9248
 ds_read_b64_tr_b16 v[54:55], v6 offset:13856
 v_cndmask_b32 v227, v225, v227, vcc
 v_mfma_f32_16x16x32_bf16 v[164:167], v[64:67], a[4:7], v[164:167]
 ds_read_b64_tr_b16 v[56:57], v6 offset:18464
 ds_read_b64_tr_b16 v[58:59], v6 offset:23072
 v_mul_u32_u24 v229, 3072, v213
 v_mfma_f32_16x16x32_bf16 v[164:167], v[68:71], a[12:15], v[164:167]
 ds_read_b64_tr_b16 v[60:61], v6 offset:27680
 ds_read_b64_tr_b16 v[62:63], v6 offset:32288
 v_mfma_f32_16x16x32_bf16 v[164:167], v[72:75], a[20:23], v[164:167]
 v_mfma_f32_16x16x32_bf16 v[164:167], v[76:79], a[28:31], v[164:167]
 s_waitcnt lgkmcnt(8)
 v_mfma_f32_16x16x32_bf16 v[96:99], v[32:35], a[32:35], v[96:99]
 ds_read_b64_tr_b16 v[64:65], v6 offset:64
 s_waitcnt vmcnt(28)
 v_mfma_f32_16x16x32_bf16 v[96:99], v[36:39], a[40:43], v[96:99]
 s_add_u32 s57, s52, 0
 ds_read_b64_tr_b16 v[66:67], v6 offset:4672
 s_waitcnt vmcnt(24)
 v_mfma_f32_16x16x32_bf16 v[96:99], v[40:43], a[48:51], v[96:99]
 s_add_u32 m0, s53, 36864
 ds_read_b64_tr_b16 v[68:69], v6 offset:9280
 v_lshl_add_u32 v226, v226, 1, v229
 s_waitcnt vmcnt(19)
 v_mfma_f32_16x16x32_bf16 v[96:99], v[44:47], a[56:59], v[96:99]
 ds_read_b64_tr_b16 v[70:71], v6 offset:13888
 buffer_load_dwordx4 v2, s[16:19], s57 offen lds
 v_add_u32 v183, 10240, v226
 v_mfma_f32_16x16x32_bf16 v[100:103], v[32:35], a[36:39], v[100:103]
 s_add_u32 s58, s54, 21504
 ds_read_b64_tr_b16 v[72:73], v6 offset:18496
 v_lshl_add_u32 v227, v227, 1, v229
 v_mfma_f32_16x16x32_bf16 v[100:103], v[36:39], a[44:47], v[100:103]
 ds_read_b64_tr_b16 v[74:75], v6 offset:23104
 buffer_load_dwordx4 a[96:99], v1, s[12:15], s58 offen sc1
 v_add_u32 v188, 10240, v227
 v_mfma_f32_16x16x32_bf16 v[100:103], v[40:43], a[52:55], v[100:103]
 ds_read_b64_tr_b16 v[76:77], v6 offset:27712
 v_mov_b32 v193, -1
 s_waitcnt vmcnt(19)
 v_mfma_f32_16x16x32_bf16 v[100:103], v[44:47], a[60:63], v[100:103]
 ds_read_b64_tr_b16 v[78:79], v6 offset:32320
 s_waitcnt lgkmcnt(8)
 v_mov_b32 v228, s50
 v_mfma_f32_16x16x32_bf16 v[104:107], v[48:51], a[32:35], v[104:107]
 s_add_u32 m0, s53, 37888
 ds_read_b64_tr_b16 v[32:33], v6 offset:96
 v_cmp_eq_u32 vcc, 0, v224
 v_mfma_f32_16x16x32_bf16 v[104:107], v[52:55], a[40:43], v[104:107]
 ds_read_b64_tr_b16 v[34:35], v6 offset:4704
 buffer_load_dwordx4 v3, s[16:19], s57 offen lds
 v_cndmask_b32 v193, v193, v228, vcc
 v_mfma_f32_16x16x32_bf16 v[104:107], v[56:59], a[48:51], v[104:107]
 s_add_u32 s58, s54, 168960
 ds_read_b64_tr_b16 v[36:37], v6 offset:9312
 v_cmp_eq_u32 vcc, 288, v224
 v_mfma_f32_16x16x32_bf16 v[104:107], v[60:63], a[56:59], v[104:107]
 ds_read_b64_tr_b16 v[38:39], v6 offset:13920
 buffer_load_dwordx4 a[100:103], v1, s[12:15], s58 offen sc1
 v_cndmask_b32 v193, v193, v228, vcc
 v_mfma_f32_16x16x32_bf16 v[108:111], v[48:51], a[36:39], v[108:111]
 ds_read_b64_tr_b16 v[40:41], v6 offset:18528
 v_min_u32 v224, 2, v213
 v_mfma_f32_16x16x32_bf16 v[108:111], v[52:55], a[44:47], v[108:111]
 s_add_u32 m0, s53, 38912
 ds_read_b64_tr_b16 v[42:43], v6 offset:23136
 v_mfma_f32_16x16x32_bf16 v[108:111], v[56:59], a[52:55], v[108:111]
 ds_read_b64_tr_b16 v[44:45], v6 offset:27744
 buffer_load_dwordx4 v10, s[16:19], s57 offen lds
 v_lshrrev_b32 v225, 2, v212
 v_mfma_f32_16x16x32_bf16 v[108:111], v[60:63], a[60:63], v[108:111]
 ds_read_b64_tr_b16 v[46:47], v6 offset:32352
 s_waitcnt lgkmcnt(8)
 v_lshl_add_u32 v224, v224, 3, v225
 v_mfma_f32_16x16x32_bf16 v[112:115], v[64:67], a[32:35], v[112:115]
 ds_read_b64_tr_b16 v[48:49], v6 offset:128
 v_mul_u32_u24 v224, 48, v224
 v_mfma_f32_16x16x32_bf16 v[112:115], v[68:71], a[40:43], v[112:115]
 s_add_u32 s58, s54, 25600
 ds_read_b64_tr_b16 v[50:51], v6 offset:4736
 v_and_b32 v225, 3, v0
 v_mfma_f32_16x16x32_bf16 v[112:115], v[72:75], a[48:51], v[112:115]
 ds_read_b64_tr_b16 v[52:53], v6 offset:9344
 buffer_load_dwordx4 a[104:107], v1, s[12:15], s58 offen sc1
 v_lshl_add_u32 v224, v225, 3, v224
 v_mfma_f32_16x16x32_bf16 v[112:115], v[76:79], a[56:59], v[112:115]
 s_add_u32 m0, s53, 39936
 ds_read_b64_tr_b16 v[54:55], v6 offset:13952
 s_mul_i32 s46, s20, 3072
 v_mfma_f32_16x16x32_bf16 v[116:119], v[64:67], a[36:39], v[116:119]
 ds_read_b64_tr_b16 v[56:57], v6 offset:18560
 buffer_load_dwordx4 v11, s[16:19], s57 offen lds
 s_add_u32 s46, s46, 10240
 v_mfma_f32_16x16x32_bf16 v[116:119], v[68:71], a[44:47], v[116:119]
 ds_read_b64_tr_b16 v[58:59], v6 offset:23168
 v_add_u32 v194, s46, v224
 v_mfma_f32_16x16x32_bf16 v[116:119], v[72:75], a[52:55], v[116:119]
 ds_read_b64_tr_b16 v[60:61], v6 offset:27776
 v_lshl_add_u32 v224, v213, 2, 0
 v_mfma_f32_16x16x32_bf16 v[116:119], v[76:79], a[60:63], v[116:119]
 ds_read_b64_tr_b16 v[62:63], v6 offset:32384
 s_waitcnt lgkmcnt(8)
 v_mul_u32_u24 v225, 24, v224
 v_mfma_f32_16x16x32_bf16 v[120:123], v[32:35], a[32:35], v[120:123]
 s_add_u32 s58, s54, 173056
 ds_read_b64_tr_b16 v[64:65], v6 offset:160
 v_mfma_f32_16x16x32_bf16 v[120:123], v[36:39], a[40:43], v[120:123]
 ds_read_b64_tr_b16 v[66:67], v6 offset:4768
 buffer_load_dwordx4 a[108:111], v1, s[12:15], s58 offen sc1
 v_add_u32 v225, 0, v225
 v_mfma_f32_16x16x32_bf16 v[120:123], v[40:43], a[48:51], v[120:123]
 s_add_u32 m0, s53, 40960
 ds_read_b64_tr_b16 v[68:69], v6 offset:9376
 v_add_u32 v225, v225, v212
 v_mfma_f32_16x16x32_bf16 v[120:123], v[44:47], a[56:59], v[120:123]
 ds_read_b64_tr_b16 v[70:71], v6 offset:13984
 buffer_load_dwordx4 v12, s[16:19], s57 offen lds
 v_lshlrev_b32 v225, 2, v225
 v_mfma_f32_16x16x32_bf16 v[124:127], v[32:35], a[36:39], v[124:127]
 ds_read_b64_tr_b16 v[72:73], v6 offset:18592
 s_mul_i32 s46, s20, 4608
 v_mfma_f32_16x16x32_bf16 v[124:127], v[36:39], a[44:47], v[124:127]
 ds_read_b64_tr_b16 v[74:75], v6 offset:23200
 s_add_u32 s46, s46, 34816
 v_mfma_f32_16x16x32_bf16 v[124:127], v[40:43], a[52:55], v[124:127]
 ds_read_b64_tr_b16 v[76:77], v6 offset:27808
 v_add_u32 v195, s46, v225
 v_mfma_f32_16x16x32_bf16 v[124:127], v[44:47], a[60:63], v[124:127]
 ds_read_b64_tr_b16 v[78:79], v6 offset:32416
 s_waitcnt lgkmcnt(8)
 v_lshl_add_u32 v224, v213, 2, 0
 v_mfma_f32_16x16x32_bf16 v[128:131], v[48:51], a[32:35], v[128:131]
 s_add_u32 s58, s54, 29696
 ds_read_b64_tr_b16 v[32:33], v6 offset:192
 v_mul_u32_u24 v225, 24, v224
 v_mfma_f32_16x16x32_bf16 v[128:131], v[52:55], a[40:43], v[128:131]
 ds_read_b64_tr_b16 v[34:35], v6 offset:4800
 buffer_load_dwordx4 a[112:115], v1, s[12:15], s58 offen sc1
 v_add_u32 v225, 16, v225
 v_mfma_f32_16x16x32_bf16 v[128:131], v[56:59], a[48:51], v[128:131]
 s_add_u32 m0, s53, 41984
 ds_read_b64_tr_b16 v[36:37], v6 offset:9408
 v_add_u32 v225, v225, v212
 v_mfma_f32_16x16x32_bf16 v[128:131], v[60:63], a[56:59], v[128:131]
 ds_read_b64_tr_b16 v[38:39], v6 offset:14016
 buffer_load_dwordx4 v13, s[16:19], s57 offen lds
 v_mfma_f32_16x16x32_bf16 v[132:135], v[48:51], a[36:39], v[132:135]
 ds_read_b64_tr_b16 v[40:41], v6 offset:18624
 v_lshlrev_b32 v225, 2, v225
 v_mfma_f32_16x16x32_bf16 v[132:135], v[52:55], a[44:47], v[132:135]
 ds_read_b64_tr_b16 v[42:43], v6 offset:23232
 s_mul_i32 s46, s20, 4608
 v_mfma_f32_16x16x32_bf16 v[132:135], v[56:59], a[52:55], v[132:135]
 s_add_u32 m0, s53, 43008
 ds_read_b64_tr_b16 v[44:45], v6 offset:27840
 s_add_u32 s46, s46, 34816
 v_mfma_f32_16x16x32_bf16 v[132:135], v[60:63], a[60:63], v[132:135]
 ds_read_b64_tr_b16 v[46:47], v6 offset:32448
 s_waitcnt lgkmcnt(8)
 v_add_u32 v196, s46, v225
 v_mfma_f32_16x16x32_bf16 v[136:139], v[64:67], a[32:35], v[136:139]
 ds_read_b64_tr_b16 v[48:49], v6 offset:224
 buffer_load_dwordx4 v14, s[16:19], s57 offen lds
 v_mov_b32 v226, 53248
 v_mfma_f32_16x16x32_bf16 v[136:139], v[68:71], a[40:43], v[136:139]
 s_add_u32 s58, s54, 177152
 ds_read_b64_tr_b16 v[50:51], v6 offset:4832
 v_cmp_lt_u32 vcc, 7, v212
 v_mfma_f32_16x16x32_bf16 v[136:139], v[72:75], a[48:51], v[136:139]
 ds_read_b64_tr_b16 v[52:53], v6 offset:9440
 buffer_load_dwordx4 a[116:119], v1, s[12:15], s58 offen sc1
 v_cndmask_b32 v196, v196, v226, vcc
 v_mfma_f32_16x16x32_bf16 v[136:139], v[76:79], a[56:59], v[136:139]
 ds_read_b64_tr_b16 v[54:55], v6 offset:14048
 v_lshl_add_u32 v224, v213, 2, 16
 v_mfma_f32_16x16x32_bf16 v[140:143], v[64:67], a[36:39], v[140:143]
 s_add_u32 m0, s53, 44032
 ds_read_b64_tr_b16 v[56:57], v6 offset:18656
 v_mul_u32_u24 v225, 24, v224
 v_mfma_f32_16x16x32_bf16 v[140:143], v[68:71], a[44:47], v[140:143]
 ds_read_b64_tr_b16 v[58:59], v6 offset:23264
 buffer_load_dwordx4 v15, s[16:19], s57 offen lds
 v_add_u32 v225, 0, v225
 v_mfma_f32_16x16x32_bf16 v[140:143], v[72:75], a[52:55], v[140:143]
 s_add_u32 s58, s54, 33792
 ds_read_b64_tr_b16 v[60:61], v6 offset:27872
 v_add_u32 v225, v225, v212
 v_mfma_f32_16x16x32_bf16 v[140:143], v[76:79], a[60:63], v[140:143]
 ds_read_b64_tr_b16 v[62:63], v6 offset:32480
 s_waitcnt lgkmcnt(8)
 v_mfma_f32_16x16x32_bf16 v[144:147], v[32:35], a[32:35], v[144:147]
 ds_read_b64_tr_b16 v[64:65], v6 offset:256
 buffer_load_dwordx4 a[120:123], v1, s[12:15], s58 offen sc1
 v_lshlrev_b32 v225, 2, v225
 v_mfma_f32_16x16x32_bf16 v[144:147], v[36:39], a[40:43], v[144:147]
 ds_read_b64_tr_b16 v[66:67], v6 offset:4864
 s_mul_i32 s46, s20, 4608
 v_mfma_f32_16x16x32_bf16 v[144:147], v[40:43], a[48:51], v[144:147]
 s_add_u32 m0, s53, 45056
 ds_read_b64_tr_b16 v[68:69], v6 offset:9472
 s_add_u32 s46, s46, 34816
 v_mfma_f32_16x16x32_bf16 v[144:147], v[44:47], a[56:59], v[144:147]
 ds_read_b64_tr_b16 v[70:71], v6 offset:14080
 buffer_load_dwordx4 v5, s[16:19], s57 offen lds
 v_add_u32 v197, s46, v225
 v_mfma_f32_16x16x32_bf16 v[148:151], v[32:35], a[36:39], v[148:151]
 s_add_u32 s58, s54, 181248
 ds_read_b64_tr_b16 v[72:73], v6 offset:18688
 v_mov_b32 v226, 53248
 v_mfma_f32_16x16x32_bf16 v[148:151], v[36:39], a[44:47], v[148:151]
 ds_read_b64_tr_b16 v[74:75], v6 offset:23296
 buffer_load_dwordx4 a[124:127], v1, s[12:15], s58 offen sc1
 v_cmp_lt_u32 vcc, 1, v213
 v_mfma_f32_16x16x32_bf16 v[148:151], v[40:43], a[52:55], v[148:151]
 ds_read_b64_tr_b16 v[76:77], v6 offset:27904
 v_cndmask_b32 v197, v197, v226, vcc
 v_mfma_f32_16x16x32_bf16 v[148:151], v[44:47], a[60:63], v[148:151]
 ds_read_b64_tr_b16 v[78:79], v6 offset:32512
 s_waitcnt lgkmcnt(8)
 v_lshl_add_u32 v224, v213, 2, 16
 v_mfma_f32_16x16x32_bf16 v[152:155], v[48:51], a[32:35], v[152:155]
 v_mul_u32_u24 v225, 24, v224
 v_mfma_f32_16x16x32_bf16 v[152:155], v[52:55], a[40:43], v[152:155]
 v_add_u32 v225, 16, v225
 v_mfma_f32_16x16x32_bf16 v[152:155], v[56:59], a[48:51], v[152:155]
 v_mfma_f32_16x16x32_bf16 v[152:155], v[60:63], a[56:59], v[152:155]
 v_add_u32 v225, v225, v212
 v_mfma_f32_16x16x32_bf16 v[156:159], v[48:51], a[36:39], v[156:159]
 v_add_u32 v6, 36864, v6
 v_lshlrev_b32 v225, 2, v225
 v_mfma_f32_16x16x32_bf16 v[156:159], v[52:55], a[44:47], v[156:159]
 s_waitcnt lgkmcnt(0)
 s_barrier
 s_mul_i32 s46, s20, 4608
 v_mfma_f32_16x16x32_bf16 v[156:159], v[56:59], a[52:55], v[156:159]
 ds_read_b64_tr_b16 v[32:33], v6 offset:0
 ds_read_b64_tr_b16 v[34:35], v6 offset:4608
 s_add_u32 s46, s46, 34816
 v_mfma_f32_16x16x32_bf16 v[156:159], v[60:63], a[60:63], v[156:159]
 ds_read_b64_tr_b16 v[36:37], v6 offset:9216
 ds_read_b64_tr_b16 v[38:39], v6 offset:13824
 v_add_u32 v198, s46, v225
 v_mfma_f32_16x16x32_bf16 v[160:163], v[64:67], a[32:35], v[160:163]
 ds_read_b64_tr_b16 v[40:41], v6 offset:18432
 ds_read_b64_tr_b16 v[42:43], v6 offset:23040
 v_mov_b32 v226, 53248
 v_mfma_f32_16x16x32_bf16 v[160:163], v[68:71], a[40:43], v[160:163]
 ds_read_b64_tr_b16 v[44:45], v6 offset:27648
 ds_read_b64_tr_b16 v[46:47], v6 offset:32256
 v_cmp_lt_u32 vcc, 1, v213
 v_mfma_f32_16x16x32_bf16 v[160:163], v[72:75], a[48:51], v[160:163]
 ds_read_b64_tr_b16 v[48:49], v6 offset:32
 ds_read_b64_tr_b16 v[50:51], v6 offset:4640
 v_cndmask_b32 v198, v198, v226, vcc
 v_mfma_f32_16x16x32_bf16 v[160:163], v[76:79], a[56:59], v[160:163]
 ds_read_b64_tr_b16 v[52:53], v6 offset:9248
 ds_read_b64_tr_b16 v[54:55], v6 offset:13856
 v_cmp_lt_u32 vcc, 7, v212
 v_mfma_f32_16x16x32_bf16 v[164:167], v[64:67], a[36:39], v[164:167]
 ds_read_b64_tr_b16 v[56:57], v6 offset:18464
 ds_read_b64_tr_b16 v[58:59], v6 offset:23072
 v_cndmask_b32 v198, v198, v226, vcc
 v_mfma_f32_16x16x32_bf16 v[164:167], v[68:71], a[44:47], v[164:167]
 ds_read_b64_tr_b16 v[60:61], v6 offset:27680
 ds_read_b64_tr_b16 v[62:63], v6 offset:32288
 v_mfma_f32_16x16x32_bf16 v[164:167], v[72:75], a[52:55], v[164:167]
 v_mfma_f32_16x16x32_bf16 v[164:167], v[76:79], a[60:63], v[164:167]
 s_waitcnt lgkmcnt(8)
 s_waitcnt vmcnt(32)
 v_mfma_f32_16x16x32_bf16 v[96:99], v[32:35], a[64:67], v[96:99]
 ds_read_b64_tr_b16 v[64:65], v6 offset:64
 v_min_u32 v82, 49, v0
 s_waitcnt vmcnt(28)
 v_mfma_f32_16x16x32_bf16 v[96:99], v[36:39], a[72:75], v[96:99]
 ds_read_b64_tr_b16 v[66:67], v6 offset:4672
 v_lshlrev_b32 v82, 4, v82
 s_waitcnt vmcnt(23)
 v_mfma_f32_16x16x32_bf16 v[96:99], v[40:43], a[80:83], v[96:99]
 ds_read_b64_tr_b16 v[68:69], v6 offset:9280
 s_and_b32 s43, s20, 1
 s_waitcnt vmcnt(19)
 v_mfma_f32_16x16x32_bf16 v[96:99], v[44:47], a[88:91], v[96:99]
 s_add_u32 s58, s55, 0
 ds_read_b64_tr_b16 v[70:71], v6 offset:13888
 v_mfma_f32_16x16x32_bf16 v[100:103], v[32:35], a[68:71], v[100:103]
 ds_read_b64_tr_b16 v[72:73], v6 offset:18496
 buffer_load_dwordx2 a[0:1], v8, s[12:15], s58 offen sc1
 v_mfma_f32_16x16x32_bf16 v[100:103], v[36:39], a[76:79], v[100:103]
 ds_read_b64_tr_b16 v[74:75], v6 offset:23104
 buffer_load_dwordx2 a[2:3], v8, s[12:15], s58 offen offset:512 sc1
 s_mul_i32 s43, s43, 10752
 v_mfma_f32_16x16x32_bf16 v[100:103], v[40:43], a[84:87], v[100:103]
 s_mov_b32 s42, 42611328
 ds_read_b64_tr_b16 v[76:77], v6 offset:27712
 s_waitcnt vmcnt(19)
 v_mfma_f32_16x16x32_bf16 v[100:103], v[44:47], a[92:95], v[100:103]
 ds_read_b64_tr_b16 v[78:79], v6 offset:32320
 s_waitcnt lgkmcnt(8)
 v_mfma_f32_16x16x32_bf16 v[104:107], v[48:51], a[64:67], v[104:107]
 ds_read_b64_tr_b16 v[32:33], v6 offset:96
 buffer_load_dwordx4 v[84:87], v82, s[12:15], s42 offen offset:0 sc1
 s_cmp_ge_u32 s20, 2
 s_cselect_b32 s59, 4294930432, 0
 v_mfma_f32_16x16x32_bf16 v[104:107], v[52:55], a[72:75], v[104:107]
 ds_read_b64_tr_b16 v[34:35], v6 offset:4704
 v_mfma_f32_16x16x32_bf16 v[104:107], v[56:59], a[80:83], v[104:107]
 s_add_u32 s58, s55, 16384
 ds_read_b64_tr_b16 v[36:37], v6 offset:9312
 v_mfma_f32_16x16x32_bf16 v[104:107], v[60:63], a[88:91], v[104:107]
 ds_read_b64_tr_b16 v[38:39], v6 offset:13920
 buffer_load_dwordx2 a[4:5], v8, s[12:15], s58 offen sc1
 s_add_u32 s43, s43, s59
 v_mfma_f32_16x16x32_bf16 v[108:111], v[48:51], a[68:71], v[108:111]
 ds_read_b64_tr_b16 v[40:41], v6 offset:18528
 buffer_load_dwordx2 a[6:7], v8, s[12:15], s58 offen offset:512 sc1
 v_mfma_f32_16x16x32_bf16 v[108:111], v[52:55], a[76:79], v[108:111]
 ds_read_b64_tr_b16 v[42:43], v6 offset:23136
 v_mfma_f32_16x16x32_bf16 v[108:111], v[56:59], a[84:87], v[108:111]
 ds_read_b64_tr_b16 v[44:45], v6 offset:27744
 s_add_u32 s43, s43, 110592
 v_mfma_f32_16x16x32_bf16 v[108:111], v[60:63], a[92:95], v[108:111]
 ds_read_b64_tr_b16 v[46:47], v6 offset:32352
 s_waitcnt lgkmcnt(8)
 v_mfma_f32_16x16x32_bf16 v[112:115], v[64:67], a[64:67], v[112:115]
 ds_read_b64_tr_b16 v[48:49], v6 offset:128
 v_mfma_f32_16x16x32_bf16 v[112:115], v[68:71], a[72:75], v[112:115]
 s_add_u32 s58, s55, 1024
 ds_read_b64_tr_b16 v[50:51], v6 offset:4736
 v_and_b32 v88, 15, v0
 v_mfma_f32_16x16x32_bf16 v[112:115], v[72:75], a[80:83], v[112:115]
 ds_read_b64_tr_b16 v[52:53], v6 offset:9344
 buffer_load_dwordx2 a[8:9], v8, s[12:15], s58 offen sc1
 v_mfma_f32_16x16x32_bf16 v[112:115], v[76:79], a[88:91], v[112:115]
 ds_read_b64_tr_b16 v[54:55], v6 offset:13952
 buffer_load_dwordx2 a[10:11], v8, s[12:15], s58 offen offset:512 sc1
 v_mfma_f32_16x16x32_bf16 v[116:119], v[64:67], a[68:71], v[116:119]
 ds_read_b64_tr_b16 v[56:57], v6 offset:18560
 v_lshrrev_b32 v89, 4, v0
 v_mfma_f32_16x16x32_bf16 v[116:119], v[68:71], a[76:79], v[116:119]
 ds_read_b64_tr_b16 v[58:59], v6 offset:23168
 v_mfma_f32_16x16x32_bf16 v[116:119], v[72:75], a[84:87], v[116:119]
 ds_read_b64_tr_b16 v[60:61], v6 offset:27776
 v_mfma_f32_16x16x32_bf16 v[116:119], v[76:79], a[92:95], v[116:119]
 ds_read_b64_tr_b16 v[62:63], v6 offset:32384
 s_waitcnt lgkmcnt(8)
 v_mul_u32_u24 v7, 144, v88
 v_mfma_f32_16x16x32_bf16 v[120:123], v[32:35], a[64:67], v[120:123]
 s_add_u32 s58, s55, 17408
 ds_read_b64_tr_b16 v[64:65], v6 offset:160
 v_mfma_f32_16x16x32_bf16 v[120:123], v[36:39], a[72:75], v[120:123]
 ds_read_b64_tr_b16 v[66:67], v6 offset:4768
 buffer_load_dwordx2 a[12:13], v8, s[12:15], s58 offen sc1
 v_mfma_f32_16x16x32_bf16 v[120:123], v[40:43], a[80:83], v[120:123]
 ds_read_b64_tr_b16 v[68:69], v6 offset:9376
 buffer_load_dwordx2 a[14:15], v8, s[12:15], s58 offen offset:512 sc1
 v_lshl_add_u32 v7, v89, 3, v7
 v_mfma_f32_16x16x32_bf16 v[120:123], v[44:47], a[88:91], v[120:123]
 ds_read_b64_tr_b16 v[70:71], v6 offset:13984
 v_mfma_f32_16x16x32_bf16 v[124:127], v[32:35], a[68:71], v[124:127]
 ds_read_b64_tr_b16 v[72:73], v6 offset:18592
 v_mfma_f32_16x16x32_bf16 v[124:127], v[36:39], a[76:79], v[124:127]
 ds_read_b64_tr_b16 v[74:75], v6 offset:23200
 v_add_u32 v7, s43, v7
 v_mfma_f32_16x16x32_bf16 v[124:127], v[40:43], a[84:87], v[124:127]
 ds_read_b64_tr_b16 v[76:77], v6 offset:27808
 v_mfma_f32_16x16x32_bf16 v[124:127], v[44:47], a[92:95], v[124:127]
 ds_read_b64_tr_b16 v[78:79], v6 offset:32416
 s_waitcnt lgkmcnt(8)
 v_mfma_f32_16x16x32_bf16 v[128:131], v[48:51], a[64:67], v[128:131]
 s_add_u32 s58, s55, 2048
 ds_read_b64_tr_b16 v[32:33], v6 offset:192
 v_mul_u32_u24 v168, 48, v88
 v_mfma_f32_16x16x32_bf16 v[128:131], v[52:55], a[72:75], v[128:131]
 ds_read_b64_tr_b16 v[34:35], v6 offset:4800
 buffer_load_dwordx2 a[16:17], v8, s[12:15], s58 offen sc1
 v_mfma_f32_16x16x32_bf16 v[128:131], v[56:59], a[80:83], v[128:131]
 ds_read_b64_tr_b16 v[36:37], v6 offset:9408
 buffer_load_dwordx2 a[18:19], v8, s[12:15], s58 offen offset:512 sc1
 v_mfma_f32_16x16x32_bf16 v[128:131], v[60:63], a[88:91], v[128:131]
 ds_read_b64_tr_b16 v[38:39], v6 offset:14016
 v_lshl_add_u32 v168, v89, 3, v168
 v_mfma_f32_16x16x32_bf16 v[132:135], v[48:51], a[68:71], v[132:135]
 ds_read_b64_tr_b16 v[40:41], v6 offset:18624
 v_mfma_f32_16x16x32_bf16 v[132:135], v[52:55], a[76:79], v[132:135]
 ds_read_b64_tr_b16 v[42:43], v6 offset:23232
 v_mfma_f32_16x16x32_bf16 v[132:135], v[56:59], a[84:87], v[132:135]
 s_add_u32 s58, s55, 18432
 ds_read_b64_tr_b16 v[44:45], v6 offset:27840
 v_add_u32 v168, s43, v168
 v_mfma_f32_16x16x32_bf16 v[132:135], v[60:63], a[92:95], v[132:135]
 ds_read_b64_tr_b16 v[46:47], v6 offset:32448
 s_waitcnt lgkmcnt(8)
 v_mfma_f32_16x16x32_bf16 v[136:139], v[64:67], a[64:67], v[136:139]
 ds_read_b64_tr_b16 v[48:49], v6 offset:224
 buffer_load_dwordx2 a[20:21], v8, s[12:15], s58 offen sc1
 v_mfma_f32_16x16x32_bf16 v[136:139], v[68:71], a[72:75], v[136:139]
 ds_read_b64_tr_b16 v[50:51], v6 offset:4832
 buffer_load_dwordx2 a[22:23], v8, s[12:15], s58 offen offset:512 sc1
 v_lshrrev_b32 v88, 3, v0
 v_mfma_f32_16x16x32_bf16 v[136:139], v[72:75], a[80:83], v[136:139]
 ds_read_b64_tr_b16 v[52:53], v6 offset:9440
 v_mfma_f32_16x16x32_bf16 v[136:139], v[76:79], a[88:91], v[136:139]
 ds_read_b64_tr_b16 v[54:55], v6 offset:14048
 v_mfma_f32_16x16x32_bf16 v[140:143], v[64:67], a[68:71], v[140:143]
 ds_read_b64_tr_b16 v[56:57], v6 offset:18656
 v_mul_u32_u24 v169, 144, v88
 v_mfma_f32_16x16x32_bf16 v[140:143], v[68:71], a[76:79], v[140:143]
 s_add_u32 s58, s55, 3072
 ds_read_b64_tr_b16 v[58:59], v6 offset:23264
 v_mfma_f32_16x16x32_bf16 v[140:143], v[72:75], a[84:87], v[140:143]
 ds_read_b64_tr_b16 v[60:61], v6 offset:27872
 buffer_load_dwordx2 a[24:25], v8, s[12:15], s58 offen sc1
 v_mfma_f32_16x16x32_bf16 v[140:143], v[76:79], a[92:95], v[140:143]
 ds_read_b64_tr_b16 v[62:63], v6 offset:32480
 s_waitcnt lgkmcnt(8)
 v_and_b32 v88, 7, v0
 v_mfma_f32_16x16x32_bf16 v[144:147], v[32:35], a[64:67], v[144:147]
 ds_read_b64_tr_b16 v[64:65], v6 offset:256
 buffer_load_dwordx2 a[26:27], v8, s[12:15], s58 offen offset:512 sc1
 v_mfma_f32_16x16x32_bf16 v[144:147], v[36:39], a[72:75], v[144:147]
 ds_read_b64_tr_b16 v[66:67], v6 offset:4864
 v_mfma_f32_16x16x32_bf16 v[144:147], v[40:43], a[80:83], v[144:147]
 ds_read_b64_tr_b16 v[68:69], v6 offset:9472
 v_lshl_add_u32 v169, v88, 4, v169
 v_mfma_f32_16x16x32_bf16 v[144:147], v[44:47], a[88:91], v[144:147]
 ds_read_b64_tr_b16 v[70:71], v6 offset:14080
 v_mfma_f32_16x16x32_bf16 v[148:151], v[32:35], a[68:71], v[148:151]
 s_add_u32 s58, s55, 19456
 ds_read_b64_tr_b16 v[72:73], v6 offset:18688
 v_mfma_f32_16x16x32_bf16 v[148:151], v[36:39], a[76:79], v[148:151]
 ds_read_b64_tr_b16 v[74:75], v6 offset:23296
 buffer_load_dwordx2 a[28:29], v8, s[12:15], s58 offen sc1
 v_add_u32 v169, s43, v169
 v_mfma_f32_16x16x32_bf16 v[148:151], v[40:43], a[84:87], v[148:151]
 ds_read_b64_tr_b16 v[76:77], v6 offset:27904
 buffer_load_dwordx2 a[30:31], v8, s[12:15], s58 offen offset:512 sc1
 v_mfma_f32_16x16x32_bf16 v[148:151], v[44:47], a[92:95], v[148:151]
 ds_read_b64_tr_b16 v[78:79], v6 offset:32512
 s_waitcnt lgkmcnt(8)
 v_mfma_f32_16x16x32_bf16 v[152:155], v[48:51], a[64:67], v[152:155]
 v_lshrrev_b32 v88, 1, v0
 v_mfma_f32_16x16x32_bf16 v[152:155], v[52:55], a[72:75], v[152:155]
 v_mfma_f32_16x16x32_bf16 v[152:155], v[56:59], a[80:83], v[152:155]
 v_mfma_f32_16x16x32_bf16 v[152:155], v[60:63], a[88:91], v[152:155]
 v_mul_u32_u24 v170, 48, v88
 v_mfma_f32_16x16x32_bf16 v[156:159], v[48:51], a[68:71], v[156:159]
 v_subrev_u32 v6, 110592, v6
 v_mfma_f32_16x16x32_bf16 v[156:159], v[52:55], a[76:79], v[156:159]
 s_waitcnt lgkmcnt(0)
 s_barrier
 v_mfma_f32_16x16x32_bf16 v[156:159], v[56:59], a[84:87], v[156:159]
 ds_read_b64_tr_b16 v[32:33], v6 offset:0
 ds_read_b64_tr_b16 v[34:35], v6 offset:4608
 v_and_b32 v88, 1, v0
 v_mfma_f32_16x16x32_bf16 v[156:159], v[60:63], a[92:95], v[156:159]
 ds_read_b64_tr_b16 v[36:37], v6 offset:9216
 ds_read_b64_tr_b16 v[38:39], v6 offset:13824
 v_mfma_f32_16x16x32_bf16 v[160:163], v[64:67], a[64:67], v[160:163]
 ds_read_b64_tr_b16 v[40:41], v6 offset:18432
 ds_read_b64_tr_b16 v[42:43], v6 offset:23040
 v_mfma_f32_16x16x32_bf16 v[160:163], v[68:71], a[72:75], v[160:163]
 ds_read_b64_tr_b16 v[44:45], v6 offset:27648
 ds_read_b64_tr_b16 v[46:47], v6 offset:32256
 v_lshl_add_u32 v170, v88, 4, v170
 v_mfma_f32_16x16x32_bf16 v[160:163], v[72:75], a[80:83], v[160:163]
 ds_read_b64_tr_b16 v[48:49], v6 offset:32
 ds_read_b64_tr_b16 v[50:51], v6 offset:4640
 v_mfma_f32_16x16x32_bf16 v[160:163], v[76:79], a[88:91], v[160:163]
 ds_read_b64_tr_b16 v[52:53], v6 offset:9248
 ds_read_b64_tr_b16 v[54:55], v6 offset:13856
 v_mfma_f32_16x16x32_bf16 v[164:167], v[64:67], a[68:71], v[164:167]
 ds_read_b64_tr_b16 v[56:57], v6 offset:18464
 ds_read_b64_tr_b16 v[58:59], v6 offset:23072
 v_add_u32 v170, s43, v170
 v_mfma_f32_16x16x32_bf16 v[164:167], v[68:71], a[76:79], v[164:167]
 ds_read_b64_tr_b16 v[60:61], v6 offset:27680
 ds_read_b64_tr_b16 v[62:63], v6 offset:32288
 v_mfma_f32_16x16x32_bf16 v[164:167], v[72:75], a[84:87], v[164:167]
 v_mfma_f32_16x16x32_bf16 v[164:167], v[76:79], a[92:95], v[164:167]
 s_waitcnt lgkmcnt(8)
 s_waitcnt vmcnt(32)
 v_mfma_f32_16x16x32_bf16 v[96:99], v[32:35], a[96:99], v[96:99]
 ds_read_b64_tr_b16 v[64:65], v6 offset:64
 s_waitcnt vmcnt(14)
 v_xor_b32 v84, s60, v84
 v_xor_b32 v85, s60, v85
 v_xor_b32 v86, s60, v86
 v_xor_b32 v87, s60, v87
 v_or3_b32 v84, v84, v85, v86
 v_or_b32 v84, v84, v87
 v_cmp_eq_u32_e64 s[62:63], 0, v84
 s_nop 0
 s_cmp_eq_u64 s[62:63], exec
 s_cbranch_scc0 L_poll5
L_back5:
 v_mfma_f32_16x16x32_bf16 v[96:99], v[36:39], a[104:107], v[96:99]
 ds_read_b64_tr_b16 v[66:67], v6 offset:4672
 s_lshl_b32 s44, s20, 6
 v_mfma_f32_16x16x32_bf16 v[96:99], v[40:43], a[112:115], v[96:99]
 ds_read_b64_tr_b16 v[68:69], v6 offset:9280
 v_add_u32 v88, s44, v0
 v_mfma_f32_16x16x32_bf16 v[96:99], v[44:47], a[120:123], v[96:99]
 ds_read_b64_tr_b16 v[70:71], v6 offset:13888
 v_and_b32 v89, 7, v88
 v_mfma_f32_16x16x32_bf16 v[100:103], v[32:35], a[100:103], v[100:103]
 ds_read_b64_tr_b16 v[72:73], v6 offset:18496
 v_lshrrev_b32 v90, 3, v88
 v_mfma_f32_16x16x32_bf16 v[100:103], v[36:39], a[108:111], v[100:103]
 ds_read_b64_tr_b16 v[74:75], v6 offset:23104
 v_mul_u32_u24 v91, 25, v89
 v_mfma_f32_16x16x32_bf16 v[100:103], v[40:43], a[116:119], v[100:103]
 ds_read_b64_tr_b16 v[76:77], v6 offset:27712
 v_add_u32 v91, v91, v90
 v_mfma_f32_16x16x32_bf16 v[100:103], v[44:47], a[124:127], v[100:103]
 ds_read_b64_tr_b16 v[78:79], v6 offset:32320
 s_waitcnt lgkmcnt(8)
 v_mul_u32_u24 v91, 12288, v91
 v_mfma_f32_16x16x32_bf16 v[104:107], v[48:51], a[96:99], v[104:107]
 ds_read_b64_tr_b16 v[32:33], v6 offset:96
 s_and_b32 s45, s3, 15
 v_mfma_f32_16x16x32_bf16 v[104:107], v[52:55], a[104:107], v[104:107]
 ds_read_b64_tr_b16 v[34:35], v6 offset:4704
 s_lshl_b32 s45, s45, 4
 v_mfma_f32_16x16x32_bf16 v[104:107], v[56:59], a[112:115], v[104:107]
 ds_read_b64_tr_b16 v[36:37], v6 offset:9312
 s_lshr_b32 s44, s3, 4
 v_mfma_f32_16x16x32_bf16 v[104:107], v[60:63], a[120:123], v[104:107]
 ds_read_b64_tr_b16 v[38:39], v6 offset:13920
 s_add_u32 s45, s45, s44
 v_mfma_f32_16x16x32_bf16 v[108:111], v[48:51], a[100:103], v[108:111]
 ds_read_b64_tr_b16 v[40:41], v6 offset:18528
 s_mul_i32 s45, s45, 48
 v_mfma_f32_16x16x32_bf16 v[108:111], v[52:55], a[108:111], v[108:111]
 ds_read_b64_tr_b16 v[42:43], v6 offset:23136
 s_add_u32 s45, s45, 40129152
 v_mfma_f32_16x16x32_bf16 v[108:111], v[56:59], a[116:119], v[108:111]
 ds_read_b64_tr_b16 v[44:45], v6 offset:27744
 v_cmp_gt_u32 vcc, 200, v88
 v_mfma_f32_16x16x32_bf16 v[108:111], v[60:63], a[124:127], v[108:111]
 ds_read_b64_tr_b16 v[46:47], v6 offset:32352
 s_waitcnt lgkmcnt(8)
 v_mov_b32 v92, 0x7ffffff0
 v_mfma_f32_16x16x32_bf16 v[112:115], v[64:67], a[96:99], v[112:115]
 ds_read_b64_tr_b16 v[48:49], v6 offset:128
 v_cndmask_b32 v91, v92, v91, vcc
 v_mfma_f32_16x16x32_bf16 v[112:115], v[68:71], a[104:107], v[112:115]
 ds_read_b64_tr_b16 v[50:51], v6 offset:4736
 v_mfma_f32_16x16x32_bf16 v[112:115], v[72:75], a[112:115], v[112:115]
 ds_read_b64_tr_b16 v[52:53], v6 offset:9344
 v_mfma_f32_16x16x32_bf16 v[112:115], v[76:79], a[120:123], v[112:115]
 ds_read_b64_tr_b16 v[54:55], v6 offset:13952
 buffer_load_dwordx4 v[240:243], v91, s[12:15], s45 offen offset:0 sc1
 v_mfma_f32_16x16x32_bf16 v[116:119], v[64:67], a[100:103], v[116:119]
 ds_read_b64_tr_b16 v[56:57], v6 offset:18560
 buffer_load_dwordx4 v[244:247], v91, s[12:15], s45 offen offset:16 sc1
 v_mfma_f32_16x16x32_bf16 v[116:119], v[68:71], a[108:111], v[116:119]
 ds_read_b64_tr_b16 v[58:59], v6 offset:23168
 buffer_load_dwordx4 v[248:251], v91, s[12:15], s45 offen offset:32 sc1
 v_mfma_f32_16x16x32_bf16 v[116:119], v[72:75], a[116:119], v[116:119]
 ds_read_b64_tr_b16 v[60:61], v6 offset:27776
 v_mfma_f32_16x16x32_bf16 v[116:119], v[76:79], a[124:127], v[116:119]
 ds_read_b64_tr_b16 v[62:63], v6 offset:32384
 s_waitcnt lgkmcnt(8)
 v_mfma_f32_16x16x32_bf16 v[120:123], v[32:35], a[96:99], v[120:123]
 ds_read_b64_tr_b16 v[64:65], v6 offset:160
 v_mfma_f32_16x16x32_bf16 v[120:123], v[36:39], a[104:107], v[120:123]
 ds_read_b64_tr_b16 v[66:67], v6 offset:4768
 v_mfma_f32_16x16x32_bf16 v[120:123], v[40:43], a[112:115], v[120:123]
 ds_read_b64_tr_b16 v[68:69], v6 offset:9376
 v_mfma_f32_16x16x32_bf16 v[120:123], v[44:47], a[120:123], v[120:123]
 ds_read_b64_tr_b16 v[70:71], v6 offset:13984
 v_mfma_f32_16x16x32_bf16 v[124:127], v[32:35], a[100:103], v[124:127]
 ds_read_b64_tr_b16 v[72:73], v6 offset:18592
 v_mfma_f32_16x16x32_bf16 v[124:127], v[36:39], a[108:111], v[124:127]
 ds_read_b64_tr_b16 v[74:75], v6 offset:23200
 v_mfma_f32_16x16x32_bf16 v[124:127], v[40:43], a[116:119], v[124:127]
 ds_read_b64_tr_b16 v[76:77], v6 offset:27808
 v_mfma_f32_16x16x32_bf16 v[124:127], v[44:47], a[124:127], v[124:127]
 ds_read_b64_tr_b16 v[78:79], v6 offset:32416
 s_waitcnt lgkmcnt(8)
 v_mfma_f32_16x16x32_bf16 v[128:131], v[48:51], a[96:99], v[128:131]
 ds_read_b64_tr_b16 v[32:33], v6 offset:192
 v_mfma_f32_16x16x32_bf16 v[128:131], v[52:55], a[104:107], v[128:131]
 ds_read_b64_tr_b16 v[34:35], v6 offset:4800
 v_mfma_f32_16x16x32_bf16 v[128:131], v[56:59], a[112:115], v[128:131]
 ds_read_b64_tr_b16 v[36:37], v6 offset:9408
 v_mfma_f32_16x16x32_bf16 v[128:131], v[60:63], a[120:123], v[128:131]
 ds_read_b64_tr_b16 v[38:39], v6 offset:14016
 v_mfma_f32_16x16x32_bf16 v[132:135], v[48:51], a[100:103], v[132:135]
 ds_read_b64_tr_b16 v[40:41], v6 offset:18624
 v_mfma_f32_16x16x32_bf16 v[132:135], v[52:55], a[108:111], v[132:135]
 ds_read_b64_tr_b16 v[42:43], v6 offset:23232
 v_mfma_f32_16x16x32_bf16 v[132:135], v[56:59], a[116:119], v[132:135]
 ds_read_b64_tr_b16 v[44:45], v6 offset:27840
 v_mfma_f32_16x16x32_bf16 v[132:135], v[60:63], a[124:127], v[132:135]
 ds_read_b64_tr_b16 v[46:47], v6 offset:32448
 s_waitcnt lgkmcnt(8)
 v_mfma_f32_16x16x32_bf16 v[136:139], v[64:67], a[96:99], v[136:139]
 ds_read_b64_tr_b16 v[48:49], v6 offset:224
 v_mfma_f32_16x16x32_bf16 v[136:139], v[68:71], a[104:107], v[136:139]
 ds_read_b64_tr_b16 v[50:51], v6 offset:4832
 v_mfma_f32_16x16x32_bf16 v[136:139], v[72:75], a[112:115], v[136:139]
 ds_read_b64_tr_b16 v[52:53], v6 offset:9440
 v_mfma_f32_16x16x32_bf16 v[136:139], v[76:79], a[120:123], v[136:139]
 ds_read_b64_tr_b16 v[54:55], v6 offset:14048
 v_mfma_f32_16x16x32_bf16 v[140:143], v[64:67], a[100:103], v[140:143]
 ds_read_b64_tr_b16 v[56:57], v6 offset:18656
 v_mfma_f32_16x16x32_bf16 v[140:143], v[68:71], a[108:111], v[140:143]
 ds_read_b64_tr_b16 v[58:59], v6 offset:23264
 v_mfma_f32_16x16x32_bf16 v[140:143], v[72:75], a[116:119], v[140:143]
 ds_read_b64_tr_b16 v[60:61], v6 offset:27872
 v_mfma_f32_16x16x32_bf16 v[140:143], v[76:79], a[124:127], v[140:143]
 ds_read_b64_tr_b16 v[62:63], v6 offset:32480
 s_waitcnt lgkmcnt(8)
 v_mfma_f32_16x16x32_bf16 v[144:147], v[32:35], a[96:99], v[144:147]
 ds_read_b64_tr_b16 v[64:65], v6 offset:256
 v_mfma_f32_16x16x32_bf16 v[144:147], v[36:39], a[104:107], v[144:147]
 ds_read_b64_tr_b16 v[66:67], v6 offset:4864
 v_mfma_f32_16x16x32_bf16 v[144:147], v[40:43], a[112:115], v[144:147]
 ds_read_b64_tr_b16 v[68:69], v6 offset:9472
 v_mfma_f32_16x16x32_bf16 v[144:147], v[44:47], a[120:123], v[144:147]
 ds_read_b64_tr_b16 v[70:71], v6 offset:14080
 v_mfma_f32_16x16x32_bf16 v[148:151], v[32:35], a[100:103], v[148:151]
 ds_read_b64_tr_b16 v[72:73], v6 offset:18688
 v_mfma_f32_16x16x32_bf16 v[148:151], v[36:39], a[108:111], v[148:151]
 ds_read_b64_tr_b16 v[74:75], v6 offset:23296
 v_mfma_f32_16x16x32_bf16 v[148:151], v[40:43], a[116:119], v[148:151]
 ds_read_b64_tr_b16 v[76:77], v6 offset:27904
 v_mfma_f32_16x16x32_bf16 v[148:151], v[44:47], a[124:127], v[148:151]
 ds_read_b64_tr_b16 v[78:79], v6 offset:32512
 s_waitcnt lgkmcnt(8)
 v_mfma_f32_16x16x32_bf16 v[152:155], v[48:51], a[96:99], v[152:155]
 v_mfma_f32_16x16x32_bf16 v[152:155], v[52:55], a[104:107], v[152:155]
 v_mfma_f32_16x16x32_bf16 v[152:155], v[56:59], a[112:115], v[152:155]
 v_mfma_f32_16x16x32_bf16 v[152:155], v[60:63], a[120:123], v[152:155]
 v_mfma_f32_16x16x32_bf16 v[156:159], v[48:51], a[100:103], v[156:159]
 v_add_u32 v6, 36864, v6
 v_mfma_f32_16x16x32_bf16 v[156:159], v[52:55], a[108:111], v[156:159]
 s_waitcnt lgkmcnt(0)
 s_barrier
 v_mfma_f32_16x16x32_bf16 v[156:159], v[56:59], a[116:119], v[156:159]
 ds_read_b64_tr_b16 v[32:33], v6 offset:0
 ds_read_b64_tr_b16 v[34:35], v6 offset:4608
 v_mfma_f32_16x16x32_bf16 v[156:159], v[60:63], a[124:127], v[156:159]
 ds_read_b64_tr_b16 v[36:37], v6 offset:9216
 ds_read_b64_tr_b16 v[38:39], v6 offset:13824
 v_mfma_f32_16x16x32_bf16 v[160:163], v[64:67], a[96:99], v[160:163]
 ds_read_b64_tr_b16 v[40:41], v6 offset:18432
 ds_read_b64_tr_b16 v[42:43], v6 offset:23040
 v_mfma_f32_16x16x32_bf16 v[160:163], v[68:71], a[104:107], v[160:163]
 ds_read_b64_tr_b16 v[44:45], v6 offset:27648
 ds_read_b64_tr_b16 v[46:47], v6 offset:32256
 v_mfma_f32_16x16x32_bf16 v[160:163], v[72:75], a[112:115], v[160:163]
 ds_read_b64_tr_b16 v[48:49], v6 offset:32
 ds_read_b64_tr_b16 v[50:51], v6 offset:4640
 v_mfma_f32_16x16x32_bf16 v[160:163], v[76:79], a[120:123], v[160:163]
 ds_read_b64_tr_b16 v[52:53], v6 offset:9248
 ds_read_b64_tr_b16 v[54:55], v6 offset:13856
 v_mfma_f32_16x16x32_bf16 v[164:167], v[64:67], a[100:103], v[164:167]
 ds_read_b64_tr_b16 v[56:57], v6 offset:18464
 ds_read_b64_tr_b16 v[58:59], v6 offset:23072
 v_mfma_f32_16x16x32_bf16 v[164:167], v[68:71], a[108:111], v[164:167]
 ds_read_b64_tr_b16 v[60:61], v6 offset:27680
 ds_read_b64_tr_b16 v[62:63], v6 offset:32288
 v_mfma_f32_16x16x32_bf16 v[164:167], v[72:75], a[116:119], v[164:167]
 v_mfma_f32_16x16x32_bf16 v[164:167], v[76:79], a[124:127], v[164:167]
 s_waitcnt lgkmcnt(8)
 v_mfma_f32_16x16x32_bf16 v[96:99], v[32:35], a[0:3], v[96:99]
 ds_read_b64_tr_b16 v[64:65], v6 offset:64
 v_lshlrev_b32 v12, 2, v0
 s_waitcnt vmcnt(13)
 v_mfma_f32_16x16x32_bf16 v[96:99], v[36:39], a[8:11], v[96:99]
 ds_read_b64_tr_b16 v[66:67], v6 offset:4672
 s_lshl_b32 s44, s20, 9
 s_waitcnt vmcnt(9)
 v_mfma_f32_16x16x32_bf16 v[96:99], v[40:43], a[16:19], v[96:99]
 ds_read_b64_tr_b16 v[68:69], v6 offset:9280
 s_add_u32 s44, s44, s3
 s_waitcnt vmcnt(5)
 v_mfma_f32_16x16x32_bf16 v[96:99], v[44:47], a[24:27], v[96:99]
 ds_read_b64_tr_b16 v[70:71], v6 offset:13888
 s_mul_i32 s44, s44, 1152
 v_mfma_f32_16x16x32_bf16 v[100:103], v[32:35], a[4:7], v[100:103]
 ds_read_b64_tr_b16 v[72:73], v6 offset:18496
 s_add_u32 s45, s44, 294912
 v_mfma_f32_16x16x32_bf16 v[100:103], v[36:39], a[12:15], v[100:103]
 ds_read_b64_tr_b16 v[74:75], v6 offset:23104
 v_mov_b32 v84, 0
 v_mfma_f32_16x16x32_bf16 v[100:103], v[40:43], a[20:23], v[100:103]
 ds_read_b64_tr_b16 v[76:77], v6 offset:27712
 v_mov_b32 v89, 0
 s_waitcnt vmcnt(3)
 v_mfma_f32_16x16x32_bf16 v[100:103], v[44:47], a[28:31], v[100:103]
 ds_read_b64_tr_b16 v[78:79], v6 offset:32320
 s_waitcnt lgkmcnt(8)
 v_mfma_f32_16x16x32_bf16 v[104:107], v[48:51], a[0:3], v[104:107]
 ds_read_b64_tr_b16 v[32:33], v6 offset:96
 buffer_load_dword v80, v12, s[8:11], s44 offen offset:0
 v_mfma_f32_16x16x32_bf16 v[104:107], v[52:55], a[8:11], v[104:107]
 ds_read_b64_tr_b16 v[34:35], v6 offset:4704
 buffer_load_dword v81, v12, s[8:11], s44 offen offset:256
 v_mfma_f32_16x16x32_bf16 v[104:107], v[56:59], a[16:19], v[104:107]
 ds_read_b64_tr_b16 v[36:37], v6 offset:9312
 buffer_load_dword v82, v12, s[8:11], s44 offen offset:512
 v_mfma_f32_16x16x32_bf16 v[104:107], v[60:63], a[24:27], v[104:107]
 ds_read_b64_tr_b16 v[38:39], v6 offset:13920
 buffer_load_dword v83, v12, s[8:11], s44 offen offset:768
 v_mfma_f32_16x16x32_bf16 v[108:111], v[48:51], a[4:7], v[108:111]
 ds_read_b64_tr_b16 v[40:41], v6 offset:18528
 s_mov_b32 exec_hi, 0
 buffer_load_dword v84, v12, s[8:11], s44 offen offset:1024
 s_mov_b64 exec, -1
 v_mfma_f32_16x16x32_bf16 v[108:111], v[52:55], a[12:15], v[108:111]
 ds_read_b64_tr_b16 v[42:43], v6 offset:23136
 buffer_load_dword v85, v12, s[8:11], s45 offen offset:0
 v_mfma_f32_16x16x32_bf16 v[108:111], v[56:59], a[20:23], v[108:111]
 ds_read_b64_tr_b16 v[44:45], v6 offset:27744
 buffer_load_dword v86, v12, s[8:11], s45 offen offset:256
 v_mfma_f32_16x16x32_bf16 v[108:111], v[60:63], a[28:31], v[108:111]
 ds_read_b64_tr_b16 v[46:47], v6 offset:32352
 s_waitcnt lgkmcnt(8)
 v_mfma_f32_16x16x32_bf16 v[112:115], v[64:67], a[0:3], v[112:115]
 ds_read_b64_tr_b16 v[48:49], v6 offset:128
 buffer_load_dword v87, v12, s[8:11], s45 offen offset:512
 v_mfma_f32_16x16x32_bf16 v[112:115], v[68:71], a[8:11], v[112:115]
 ds_read_b64_tr_b16 v[50:51], v6 offset:4736
 buffer_load_dword v88, v12, s[8:11], s45 offen offset:768
 v_mfma_f32_16x16x32_bf16 v[112:115], v[72:75], a[16:19], v[112:115]
 ds_read_b64_tr_b16 v[52:53], v6 offset:9344
 s_mov_b32 exec_hi, 0
 buffer_load_dword v89, v12, s[8:11], s45 offen offset:1024
 s_mov_b64 exec, -1
 v_mfma_f32_16x16x32_bf16 v[112:115], v[76:79], a[24:27], v[112:115]
 ds_read_b64_tr_b16 v[54:55], v6 offset:13952
 buffer_load_dword v90, v12, s[64:67], 0 offen offset:0
 v_mfma_f32_16x16x32_bf16 v[116:119], v[64:67], a[4:7], v[116:119]
 ds_read_b64_tr_b16 v[56:57], v6 offset:18560
 buffer_load_dword v91, v12, s[64:67], 0 offen offset:256
 v_mfma_f32_16x16x32_bf16 v[116:119], v[68:71], a[12:15], v[116:119]
 ds_read_b64_tr_b16 v[58:59], v6 offset:23168
 buffer_load_dword v92, v12, s[64:67], 0 offen offset:512
 v_mfma_f32_16x16x32_bf16 v[116:119], v[72:75], a[20:23], v[116:119]
 ds_read_b64_tr_b16 v[60:61], v6 offset:27776
 buffer_load_dword v93, v12, s[64:67], 0 offen offset:768
 v_mfma_f32_16x16x32_bf16 v[116:119], v[76:79], a[28:31], v[116:119]
 ds_read_b64_tr_b16 v[62:63], v6 offset:32384
 s_waitcnt lgkmcnt(8)
 v_mfma_f32_16x16x32_bf16 v[120:123], v[32:35], a[0:3], v[120:123]
 ds_read_b64_tr_b16 v[64:65], v6 offset:160
 buffer_load_dword v94, v12, s[64:67], 0 offen offset:1024
 v_mfma_f32_16x16x32_bf16 v[120:123], v[36:39], a[8:11], v[120:123]
 ds_read_b64_tr_b16 v[66:67], v6 offset:4768
 v_mfma_f32_16x16x32_bf16 v[120:123], v[40:43], a[16:19], v[120:123]
 ds_read_b64_tr_b16 v[68:69], v6 offset:9376
 v_mfma_f32_16x16x32_bf16 v[120:123], v[44:47], a[24:27], v[120:123]
 ds_read_b64_tr_b16 v[70:71], v6 offset:13984
 v_mfma_f32_16x16x32_bf16 v[124:127], v[32:35], a[4:7], v[124:127]
 ds_read_b64_tr_b16 v[72:73], v6 offset:18592
 v_mfma_f32_16x16x32_bf16 v[124:127], v[36:39], a[12:15], v[124:127]
 ds_read_b64_tr_b16 v[74:75], v6 offset:23200
 v_mfma_f32_16x16x32_bf16 v[124:127], v[40:43], a[20:23], v[124:127]
 ds_read_b64_tr_b16 v[76:77], v6 offset:27808
 v_mfma_f32_16x16x32_bf16 v[124:127], v[44:47], a[28:31], v[124:127]
 ds_read_b64_tr_b16 v[78:79], v6 offset:32416
 s_waitcnt lgkmcnt(8)
 v_mfma_f32_16x16x32_bf16 v[128:131], v[48:51], a[0:3], v[128:131]
 ds_read_b64_tr_b16 v[32:33], v6 offset:192
 v_mfma_f32_16x16x32_bf16 v[128:131], v[52:55], a[8:11], v[128:131]
 ds_read_b64_tr_b16 v[34:35], v6 offset:4800
 v_mfma_f32_16x16x32_bf16 v[128:131], v[56:59], a[16:19], v[128:131]
 ds_read_b64_tr_b16 v[36:37], v6 offset:9408
 v_cvt_pk_bf16_f32 v16, v96, v97
 v_mfma_f32_16x16x32_bf16 v[128:131], v[60:63], a[24:27], v[128:131]
 ds_read_b64_tr_b16 v[38:39], v6 offset:14016
 v_cvt_pk_bf16_f32 v17, v98, v99
 v_mfma_f32_16x16x32_bf16 v[132:135], v[48:51], a[4:7], v[132:135]
 ds_read_b64_tr_b16 v[40:41], v6 offset:18624
 ds_write_b64 v7, v[16:17] offset:0
 v_mfma_f32_16x16x32_bf16 v[132:135], v[52:55], a[12:15], v[132:135]
 ds_read_b64_tr_b16 v[42:43], v6 offset:23232
 v_cvt_pk_bf16_f32 v18, v100, v101
 v_mfma_f32_16x16x32_bf16 v[132:135], v[56:59], a[20:23], v[132:135]
 ds_read_b64_tr_b16 v[44:45], v6 offset:27840
 v_cvt_pk_bf16_f32 v19, v102, v103
 v_mfma_f32_16x16x32_bf16 v[132:135], v[60:63], a[28:31], v[132:135]
 ds_read_b64_tr_b16 v[46:47], v6 offset:32448
 s_waitcnt lgkmcnt(9)
 ds_write_b64 v7, v[18:19] offset:2304
 v_mfma_f32_16x16x32_bf16 v[136:139], v[64:67], a[0:3], v[136:139]
 ds_read_b64_tr_b16 v[48:49], v6 offset:224
 v_cvt_pk_bf16_f32 v20, v104, v105
 v_mfma_f32_16x16x32_bf16 v[136:139], v[68:71], a[8:11], v[136:139]
 ds_read_b64_tr_b16 v[50:51], v6 offset:4832
 v_cvt_pk_bf16_f32 v21, v106, v107
 v_mfma_f32_16x16x32_bf16 v[136:139], v[72:75], a[16:19], v[136:139]
 ds_read_b64_tr_b16 v[52:53], v6 offset:9440
 ds_write_b64 v7, v[20:21] offset:32
 v_mfma_f32_16x16x32_bf16 v[136:139], v[76:79], a[24:27], v[136:139]
 ds_read_b64_tr_b16 v[54:55], v6 offset:14048
 v_cvt_pk_bf16_f32 v22, v108, v109
 v_mfma_f32_16x16x32_bf16 v[140:143], v[64:67], a[4:7], v[140:143]
 ds_read_b64_tr_b16 v[56:57], v6 offset:18656
 v_cvt_pk_bf16_f32 v23, v110, v111
 v_mfma_f32_16x16x32_bf16 v[140:143], v[68:71], a[12:15], v[140:143]
 ds_read_b64_tr_b16 v[58:59], v6 offset:23264
 ds_write_b64 v7, v[22:23] offset:2336
 v_mfma_f32_16x16x32_bf16 v[140:143], v[72:75], a[20:23], v[140:143]
 ds_read_b64_tr_b16 v[60:61], v6 offset:27872
 v_cvt_pk_bf16_f32 v24, v112, v113
 v_mfma_f32_16x16x32_bf16 v[140:143], v[76:79], a[28:31], v[140:143]
 ds_read_b64_tr_b16 v[62:63], v6 offset:32480
 s_waitcnt lgkmcnt(11)
 v_cvt_pk_bf16_f32 v25, v114, v115
 v_mfma_f32_16x16x32_bf16 v[144:147], v[32:35], a[0:3], v[144:147]
 ds_read_b64_tr_b16 v[64:65], v6 offset:256
 ds_write_b64 v7, v[24:25] offset:64
 v_mfma_f32_16x16x32_bf16 v[144:147], v[36:39], a[8:11], v[144:147]
 ds_read_b64_tr_b16 v[66:67], v6 offset:4864
 v_cvt_pk_bf16_f32 v26, v116, v117
 v_mfma_f32_16x16x32_bf16 v[144:147], v[40:43], a[16:19], v[144:147]
 ds_read_b64_tr_b16 v[68:69], v6 offset:9472
 v_cvt_pk_bf16_f32 v27, v118, v119
 v_mfma_f32_16x16x32_bf16 v[144:147], v[44:47], a[24:27], v[144:147]
 ds_read_b64_tr_b16 v[70:71], v6 offset:14080
 ds_write_b64 v7, v[26:27] offset:2368
 v_mfma_f32_16x16x32_bf16 v[148:151], v[32:35], a[4:7], v[148:151]
 ds_read_b64_tr_b16 v[72:73], v6 offset:18688
 v_cvt_pk_bf16_f32 v28, v120, v121
 v_mfma_f32_16x16x32_bf16 v[148:151], v[36:39], a[12:15], v[148:151]
 ds_read_b64_tr_b16 v[74:75], v6 offset:23296
 v_cvt_pk_bf16_f32 v29, v122, v123
 v_mfma_f32_16x16x32_bf16 v[148:151], v[40:43], a[20:23], v[148:151]
 ds_read_b64_tr_b16 v[76:77], v6 offset:27904
 ds_write_b64 v7, v[28:29] offset:96
 v_mfma_f32_16x16x32_bf16 v[148:151], v[44:47], a[28:31], v[148:151]
 ds_read_b64_tr_b16 v[78:79], v6 offset:32512
 s_waitcnt lgkmcnt(11)
 v_cvt_pk_bf16_f32 v30, v124, v125
 v_mfma_f32_16x16x32_bf16 v[152:155], v[48:51], a[0:3], v[152:155]
 v_cvt_pk_bf16_f32 v31, v126, v127
 v_mfma_f32_16x16x32_bf16 v[152:155], v[52:55], a[8:11], v[152:155]
 ds_write_b64 v7, v[30:31] offset:2400
 v_mfma_f32_16x16x32_bf16 v[152:155], v[56:59], a[16:19], v[152:155]
 s_waitcnt lgkmcnt(0)
 v_mfma_f32_16x16x32_bf16 v[152:155], v[60:63], a[24:27], v[152:155]
 ds_read_b128 v[212:215], v169 offset:0
 v_mfma_f32_16x16x32_bf16 v[156:159], v[48:51], a[4:7], v[156:159]
 ds_read_b128 v[216:219], v169 offset:1152
 v_mfma_f32_16x16x32_bf16 v[156:159], v[52:55], a[12:15], v[156:159]
 ds_read_b128 v[220:223], v169 offset:2304
 v_mfma_f32_16x16x32_bf16 v[156:159], v[56:59], a[20:23], v[156:159]
 ds_read_b128 v[224:227], v169 offset:3456
 v_mfma_f32_16x16x32_bf16 v[156:159], v[60:63], a[28:31], v[156:159]
 s_add_u32 s57, s56, 0
 v_mfma_f32_16x16x32_bf16 v[160:163], v[64:67], a[0:3], v[160:163]
 s_waitcnt lgkmcnt(3)
 buffer_store_dwordx4 v[212:215], v1, s[12:15], s57 offen sc1
 v_mfma_f32_16x16x32_bf16 v[160:163], v[68:71], a[8:11], v[160:163]
 s_add_u32 s57, s56, 1024
 v_mfma_f32_16x16x32_bf16 v[160:163], v[72:75], a[16:19], v[160:163]
 s_waitcnt lgkmcnt(2)
 buffer_store_dwordx4 v[216:219], v1, s[12:15], s57 offen sc1
 v_mfma_f32_16x16x32_bf16 v[160:163], v[76:79], a[24:27], v[160:163]
 s_add_u32 s57, s56, 2048
 v_mfma_f32_16x16x32_bf16 v[164:167], v[64:67], a[4:7], v[164:167]
 s_waitcnt lgkmcnt(1)
 buffer_store_dwordx4 v[220:223], v1, s[12:15], s57 offen sc1
 v_mfma_f32_16x16x32_bf16 v[164:167], v[68:71], a[12:15], v[164:167]
 s_add_u32 s57, s56, 3072
 v_mfma_f32_16x16x32_bf16 v[164:167], v[72:75], a[20:23], v[164:167]
 s_waitcnt lgkmcnt(0)
 buffer_store_dwordx4 v[224:227], v1, s[12:15], s57 offen sc1
 v_mfma_f32_16x16x32_bf16 v[164:167], v[76:79], a[28:31], v[164:167]
 v_cvt_pk_bf16_f32 v16, v128, v129
 v_cvt_pk_bf16_f32 v17, v130, v131
 ds_write_b64 v7, v[16:17] offset:4608
 v_cvt_pk_bf16_f32 v18, v132, v133
 v_cvt_pk_bf16_f32 v19, v134, v135
 ds_write_b64 v7, v[18:19] offset:6912
 v_cvt_pk_bf16_f32 v20, v136, v137
 v_cvt_pk_bf16_f32 v21, v138, v139
 ds_write_b64 v7, v[20:21] offset:4640
 v_cvt_pk_bf16_f32 v22, v140, v141
 v_cvt_pk_bf16_f32 v23, v142, v143
 ds_write_b64 v7, v[22:23] offset:6944
 v_cvt_pk_bf16_f32 v24, v144, v145
 v_cvt_pk_bf16_f32 v25, v146, v147
 ds_write_b64 v7, v[24:25] offset:4672
 v_cvt_pk_bf16_f32 v26, v148, v149
 v_cvt_pk_bf16_f32 v27, v150, v151
 ds_write_b64 v7, v[26:27] offset:6976
 v_cvt_pk_bf16_f32 v28, v152, v153
 v_cvt_pk_bf16_f32 v29, v154, v155
 ds_write_b64 v7, v[28:29] offset:4704
 v_cvt_pk_bf16_f32 v30, v156, v157
 v_cvt_pk_bf16_f32 v31, v158, v159
 ds_write_b64 v7, v[30:31] offset:7008
 s_waitcnt lgkmcnt(0)
 ds_read_b128 v[212:215], v169 offset:4608
 ds_read_b128 v[216:219], v169 offset:5760
 ds_read_b128 v[220:223], v169 offset:6912
 ds_read_b128 v[224:227], v169 offset:8064
 s_add_u32 s57, s56, 4201344
 s_waitcnt lgkmcnt(3)
 buffer_store_dwordx4 v[212:215], v1, s[12:15], s57 offen sc1
 s_add_u32 s57, s56, 4202368
 s_waitcnt lgkmcnt(2)
 buffer_store_dwordx4 v[216:219], v1, s[12:15], s57 offen sc1
 s_add_u32 s57, s56, 4203392
 s_waitcnt lgkmcnt(1)
 buffer_store_dwordx4 v[220:223], v1, s[12:15], s57 offen sc1
 s_add_u32 s57, s56, 4204416
 s_waitcnt lgkmcnt(0)
 buffer_store_dwordx4 v[224:227], v1, s[12:15], s57 offen sc1
 v_cvt_pk_bf16_f32 v16, v160, v161
 v_cvt_pk_bf16_f32 v17, v162, v163
 ds_write_b64 v168, v[16:17] offset:9216
 v_cvt_pk_bf16_f32 v18, v164, v165
 v_cvt_pk_bf16_f32 v19, v166, v167
 ds_write_b64 v168, v[18:19] offset:9984
 s_waitcnt lgkmcnt(0)
 ds_read_b128 v[228:231], v170 offset:9216
 s_mov_b32 s57, s83
 s_waitcnt lgkmcnt(0)
 buffer_store_dwordx4 v[228:231], v1, s[12:15], s57 offen sc1
 s_mov_b32 s68, s80
 s_mov_b32 s69, s81
 s_mov_b32 s70, 2359296
 s_mov_b32 s71, 0x20000
 v_mov_b32 v10, 0
 s_waitcnt vmcnt(13)
 v_dot2_f32_bf16 v10, v80, v90, v10
 s_waitcnt vmcnt(12)
 v_dot2_f32_bf16 v10, v81, v91, v10
 s_waitcnt vmcnt(11)
 v_dot2_f32_bf16 v10, v82, v92, v10
 s_waitcnt vmcnt(10)
 v_dot2_f32_bf16 v10, v83, v93, v10
 s_waitcnt vmcnt(9)
 v_dot2_f32_bf16 v10, v84, v94, v10
 v_mov_b32 v11, 0
 v_dot2_f32_bf16 v11, v85, v90, v11
 v_dot2_f32_bf16 v11, v86, v91, v11
 v_dot2_f32_bf16 v11, v87, v92, v11
 v_dot2_f32_bf16 v11, v88, v93, v11
 v_dot2_f32_bf16 v11, v89, v94, v11
 v_lshlrev_b32 v6, 4, v0
 v_add_u32 v6, 147456, v6
 ds_read_b128 v[64:67], v6 offset:4096
 ds_read_b128 v[68:71], v6 offset:5120
 ds_read_b128 v[72:75], v6 offset:6144
 ds_read_b128 v[84:87], v6 offset:7168
 ds_read_b128 v[80:83], v6 offset:8192
 ds_read_b128 v[92:95], v6 offset:9216
 ds_read_b128 v[96:99], v6 offset:10240
 ds_read_b128 v[100:103], v6 offset:11264
 ds_read_b128 v[104:107], v6 offset:12288
 ds_read_b128 v[108:111], v6 offset:13312
 ds_read_b128 v[112:115], v6 offset:14336
 s_waitcnt lgkmcnt(7)
 v_xor_b32 v76, 0x80008000, v84
 s_waitcnt lgkmcnt(6)
 v_xor_b32 v88, 0x80008000, v80
 v_xor_b32 v77, 0x80008000, v85
 v_xor_b32 v89, 0x80008000, v81
 v_xor_b32 v78, 0x80008000, v86
 v_xor_b32 v90, 0x80008000, v82
 v_xor_b32 v79, 0x80008000, v87
 v_xor_b32 v91, 0x80008000, v83
 s_barrier
 v_add_f32_dpp v10, v10, v10 row_ror:8 row_mask:0xf bank_mask:0xf
 v_add_f32_dpp v11, v11, v11 row_ror:8 row_mask:0xf bank_mask:0xf
 s_nop 0
 v_add_f32_dpp v10, v10, v10 row_ror:4 row_mask:0xf bank_mask:0xf
 v_add_f32_dpp v11, v11, v11 row_ror:4 row_mask:0xf bank_mask:0xf
 s_nop 0
 v_add_f32_dpp v10, v10, v10 row_ror:2 row_mask:0xf bank_mask:0xf
 v_add_f32_dpp v11, v11, v11 row_ror:2 row_mask:0xf bank_mask:0xf
 s_nop 0
 v_add_f32_dpp v10, v10, v10 row_ror:1 row_mask:0xf bank_mask:0xf
 v_add_f32_dpp v11, v11, v11 row_ror:1 row_mask:0xf bank_mask:0xf
 v_readlane_b32 s40, v10, 0
 v_readlane_b32 s41, v10, 16
 v_readlane_b32 s42, v10, 32
 v_readlane_b32 s43, v10, 48
 v_readlane_b32 s44, v11, 0
 v_readlane_b32 s45, v11, 16
 v_readlane_b32 s46, v11, 32
 v_readlane_b32 s47, v11, 48
 v_mov_b32 v10, s40
 v_add_f32 v10, s41, v10
 v_add_f32 v10, s42, v10
 v_add_f32 v10, s43, v10
 v_cvt_pk_bf16_f32 v10, v10, v10
 v_lshlrev_b32 v10, 16, v10
 v_mul_f32 v10, 0xbfb8aa3b, v10
 v_exp_f32 v10, v10
 s_nop 0
 v_add_f32 v10, 1.0, v10
 v_rcp_f32 v10, v10
 s_nop 0
 v_cvt_pk_bf16_f32 v10, v10, v10
 v_lshlrev_b32 v10, 16, v10
 v_mov_b32 v11, s44
 v_add_f32 v11, s45, v11
 v_add_f32 v11, s46, v11
 v_add_f32 v11, s47, v11
 v_cvt_pk_bf16_f32 v11, v11, v11
 v_lshlrev_b32 v11, 16, v11
 v_mul_f32 v11, 0xbfb8aa3b, v11
 v_exp_f32 v11, v11
 s_nop 0
 v_add_f32 v11, 1.0, v11
 v_rcp_f32 v11, v11
 s_nop 0
 v_cvt_pk_bf16_f32 v11, v11, v11
 v_lshlrev_b32 v11, 16, v11
 s_lshl_b32 s46, s20, 3
 s_add_u32 s46, s46, 60000
 v_mov_b32 v12, s46
 s_mov_b64 exec, 1
 ds_write_b64 v12, v[10:11]
 s_mov_b64 exec, -1
 ds_write_b32 v177, v240 offset:0
 ds_write_b32 v177, v241 offset:32
 ds_write_b32 v177, v242 offset:64
 ds_write_b32 v177, v243 offset:96
 ds_write_b32 v177, v244 offset:128
 ds_write_b32 v177, v245 offset:160
 ds_write_b32 v177, v246 offset:192
 ds_write_b32 v177, v247 offset:224
 ds_write_b32 v177, v248 offset:256
 ds_write_b32 v177, v249 offset:288
 ds_write_b32 v177, v250 offset:320
 ds_write_b32 v177, v251 offset:352
 s_waitcnt lgkmcnt(0)
 s_barrier
 ds_read_b128 v[148:151], v178 offset:0
 s_waitcnt lgkmcnt(0)
 v_mfma_f32_16x16x32_bf16 v[116:119], v[64:67], v[148:151], 0
 ds_read_b128 v[152:155], v178 offset:2048
 s_waitcnt lgkmcnt(0)
 v_mfma_f32_16x16x32_bf16 v[120:123], v[64:67], v[152:155], 0
 ds_read_b128 v[156:159], v178 offset:4096
 s_waitcnt lgkmcnt(0)
 v_mfma_f32_16x16x32_bf16 v[124:127], v[64:67], v[156:159], 0
 ds_read_b128 v[160:163], v178 offset:6144
 s_waitcnt lgkmcnt(0)
 v_mfma_f32_16x16x32_bf16 v[128:131], v[64:67], v[160:163], 0
 ds_read_b128 v[148:151], v178 offset:8192
 s_waitcnt lgkmcnt(0)
 v_mfma_f32_16x16x32_bf16 v[132:135], v[64:67], v[148:151], 0
 v_cvt_pk_bf16_f32 v212, v116, v117
 v_and_b32 v212, v189, v212
 v_xor_b32 v213, 0x80000000, v212
 ds_write_b16 v179, v212 offset:0
 ds_write_b16_d16_hi v179, v212 offset:12288
 ds_write_b16 v184, v212 offset:0
 ds_write_b16_d16_hi v184, v213 offset:12288
 v_cvt_pk_bf16_f32 v214, v118, v119
 v_and_b32 v214, v189, v214
 v_xor_b32 v215, 0x80000000, v214
 ds_write_b16 v179, v214 offset:1536
 ds_write_b16_d16_hi v179, v214 offset:13824
 ds_write_b16 v184, v214 offset:1536
 ds_write_b16_d16_hi v184, v215 offset:13824
 v_cvt_pk_bf16_f32 v212, v120, v121
 v_and_b32 v212, v190, v212
 v_xor_b32 v213, 0x80000000, v212
 ds_write_b16 v180, v212 offset:0
 ds_write_b16_d16_hi v180, v212 offset:12288
 ds_write_b16 v185, v212 offset:0
 ds_write_b16_d16_hi v185, v213 offset:12288
 v_cvt_pk_bf16_f32 v214, v122, v123
 v_and_b32 v214, v190, v214
 v_xor_b32 v215, 0x80000000, v214
 ds_write_b16 v180, v214 offset:1536
 ds_write_b16_d16_hi v180, v214 offset:13824
 ds_write_b16 v185, v214 offset:1536
 ds_write_b16_d16_hi v185, v215 offset:13824
 v_cvt_pk_bf16_f32 v212, v124, v125
 v_and_b32 v212, v191, v212
 v_xor_b32 v213, 0x80000000, v212
 ds_write_b16 v181, v212 offset:0
 ds_write_b16_d16_hi v181, v212 offset:12288
 ds_write_b16 v186, v212 offset:0
 ds_write_b16_d16_hi v186, v213 offset:12288
 v_cvt_pk_bf16_f32 v214, v126, v127
 v_and_b32 v214, v191, v214
 v_xor_b32 v215, 0x80000000, v214
 ds_write_b16 v181, v214 offset:1536
 ds_write_b16_d16_hi v181, v214 offset:13824
 ds_write_b16 v186, v214 offset:1536
 ds_write_b16_d16_hi v186, v215 offset:13824
 v_cvt_pk_bf16_f32 v212, v128, v129
 v_and_b32 v212, v192, v212
 v_xor_b32 v213, 0x80000000, v212
 ds_write_b16 v182, v212 offset:0
 ds_write_b16_d16_hi v182, v212 offset:12288
 ds_write_b16 v187, v212 offset:0
 ds_write_b16_d16_hi v187, v213 offset:12288
 v_cvt_pk_bf16_f32 v214, v130, v131
 v_and_b32 v214, v192, v214
 v_xor_b32 v215, 0x80000000, v214
 ds_write_b16 v182, v214 offset:1536
 ds_write_b16_d16_hi v182, v214 offset:13824
 ds_write_b16 v187, v214 offset:1536
 ds_write_b16_d16_hi v187, v215 offset:13824
 v_cvt_pk_bf16_f32 v212, v132, v133
 v_and_b32 v212, v193, v212
 v_xor_b32 v213, 0x80000000, v212
 ds_write_b16 v183, v212 offset:0
 ds_write_b16_d16_hi v183, v212 offset:12288
 ds_write_b16 v188, v212 offset:0
 ds_write_b16_d16_hi v188, v213 offset:12288
 v_cvt_pk_bf16_f32 v214, v134, v135
 v_and_b32 v214, v193, v214
 v_xor_b32 v215, 0x80000000, v214
 ds_write_b16 v183, v214 offset:1536
 ds_write_b16_d16_hi v183, v214 offset:13824
 ds_write_b16 v188, v214 offset:1536
 ds_write_b16_d16_hi v188, v215 offset:13824
 s_waitcnt lgkmcnt(0)
 s_waitcnt vmcnt(0)
 s_barrier
 v_mov_b32 v252, s60
 s_cmp_eq_u32 s20, 0
 s_cselect_b32 s77, s34, 0x7ff00000
 s_mov_b64 exec, 1
 buffer_store_dword v252, v1, s[12:15], s77 offen offset:0 sc1
 s_mov_b64 exec, -1
 ds_read_b64_tr_b16 v[148:149], v194 offset:0
 ds_read_b64_tr_b16 v[150:151], v194 offset:192
 ds_read_b64_tr_b16 v[152:153], v194 offset:12288
 ds_read_b64_tr_b16 v[154:155], v194 offset:12480
 ds_read_b64_tr_b16 v[156:157], v194 offset:1536
 ds_read_b64_tr_b16 v[158:159], v194 offset:1728
 ds_read_b64_tr_b16 v[160:161], v194 offset:13824
 ds_read_b64_tr_b16 v[162:163], v194 offset:14016
 s_waitcnt lgkmcnt(6)
 v_mfma_f32_16x16x32_bf16 v[116:119], v[148:151], v[68:71], 0
 v_mfma_f32_16x16x32_bf16 v[120:123], v[148:151], v[76:79], 0
 s_waitcnt lgkmcnt(4)
 v_mfma_f32_16x16x32_bf16 v[116:119], v[152:155], v[84:87], v[116:119]
 v_mfma_f32_16x16x32_bf16 v[120:123], v[152:155], v[68:71], v[120:123]
 v_mfma_f32_16x16x32_bf16 v[124:127], v[148:151], v[72:75], 0
 v_mfma_f32_16x16x32_bf16 v[128:131], v[148:151], v[80:83], 0
 v_mfma_f32_16x16x32_bf16 v[124:127], v[152:155], v[88:91], v[124:127]
 v_mfma_f32_16x16x32_bf16 v[128:131], v[152:155], v[72:75], v[128:131]
 s_waitcnt lgkmcnt(2)
 v_mfma_f32_16x16x32_bf16 v[132:135], v[156:159], v[68:71], 0
 v_mfma_f32_16x16x32_bf16 v[136:139], v[156:159], v[76:79], 0
 s_waitcnt lgkmcnt(0)
 v_mfma_f32_16x16x32_bf16 v[132:135], v[160:163], v[84:87], v[132:135]
 v_mfma_f32_16x16x32_bf16 v[136:139], v[160:163], v[68:71], v[136:139]
 v_mfma_f32_16x16x32_bf16 v[140:143], v[156:159], v[72:75], 0
 v_mfma_f32_16x16x32_bf16 v[144:147], v[156:159], v[80:83], 0
 v_mfma_f32_16x16x32_bf16 v[140:143], v[160:163], v[88:91], v[140:143]
 v_mfma_f32_16x16x32_bf16 v[144:147], v[160:163], v[72:75], v[144:147]
 v_mul_f32 v212, v120, v100
 v_mul_f32 v120, v120, v92
 v_fma_f32 v120, v116, v100, v120
 v_fma_f32 v116, v116, v92, -v212
 v_mul_f32 v213, v121, v101
 v_mul_f32 v121, v121, v93
 v_fma_f32 v121, v117, v101, v121
 v_fma_f32 v117, v117, v93, -v213
 v_mul_f32 v214, v122, v102
 v_mul_f32 v122, v122, v94
 v_fma_f32 v122, v118, v102, v122
 v_fma_f32 v118, v118, v94, -v214
 v_mul_f32 v215, v123, v103
 v_mul_f32 v123, v123, v95
 v_fma_f32 v123, v119, v103, v123
 v_fma_f32 v119, v119, v95, -v215
 v_cvt_pk_bf16_f32 v148, v116, v117
 v_cvt_pk_bf16_f32 v149, v118, v119
 v_cvt_pk_bf16_f32 v150, v120, v121
 v_cvt_pk_bf16_f32 v151, v122, v123
 v_mul_f32 v212, v128, v104
 v_mul_f32 v128, v128, v96
 v_fma_f32 v128, v124, v104, v128
 v_fma_f32 v124, v124, v96, -v212
 v_mul_f32 v213, v129, v105
 v_mul_f32 v129, v129, v97
 v_fma_f32 v129, v125, v105, v129
 v_fma_f32 v125, v125, v97, -v213
 v_mul_f32 v214, v130, v106
 v_mul_f32 v130, v130, v98
 v_fma_f32 v130, v126, v106, v130
 v_fma_f32 v126, v126, v98, -v214
 v_mul_f32 v215, v131, v107
 v_mul_f32 v131, v131, v99
 v_fma_f32 v131, v127, v107, v131
 v_fma_f32 v127, v127, v99, -v215
 v_cvt_pk_bf16_f32 v152, v124, v125
 v_cvt_pk_bf16_f32 v153, v126, v127
 v_cvt_pk_bf16_f32 v154, v128, v129
 v_cvt_pk_bf16_f32 v155, v130, v131
 v_mul_f32 v212, v136, v100
 v_mul_f32 v136, v136, v92
 v_fma_f32 v136, v132, v100, v136
 v_fma_f32 v132, v132, v92, -v212
 v_mul_f32 v213, v137, v101
 v_mul_f32 v137, v137, v93
 v_fma_f32 v137, v133, v101, v137
 v_fma_f32 v133, v133, v93, -v213
 v_mul_f32 v214, v138, v102
 v_mul_f32 v138, v138, v94
 v_fma_f32 v138, v134, v102, v138
 v_fma_f32 v134, v134, v94, -v214
 v_mul_f32 v215, v139, v103
 v_mul_f32 v139, v139, v95
 v_fma_f32 v139, v135, v103, v139
 v_fma_f32 v135, v135, v95, -v215
 v_cvt_pk_bf16_f32 v156, v132, v133
 v_cvt_pk_bf16_f32 v157, v134, v135
 v_cvt_pk_bf16_f32 v158, v136, v137
 v_cvt_pk_bf16_f32 v159, v138, v139
 v_mul_f32 v212, v144, v104
 v_mul_f32 v144, v144, v96
 v_fma_f32 v144, v140, v104, v144
 v_fma_f32 v140, v140, v96, -v212
 v_mul_f32 v213, v145, v105
 v_mul_f32 v145, v145, v97
 v_fma_f32 v145, v141, v105, v145
 v_fma_f32 v141, v141, v97, -v213
 v_mul_f32 v214, v146, v106
 v_mul_f32 v146, v146, v98
 v_fma_f32 v146, v142, v106, v146
 v_fma_f32 v142, v142, v98, -v214
 v_mul_f32 v215, v147, v107
 v_mul_f32 v147, v147, v99
 v_fma_f32 v147, v143, v107, v147
 v_fma_f32 v143, v143, v99, -v215
 v_cvt_pk_bf16_f32 v160, v140, v141
 v_cvt_pk_bf16_f32 v161, v142, v143
 v_cvt_pk_bf16_f32 v162, v144, v145
 v_cvt_pk_bf16_f32 v163, v146, v147
 v_mfma_f32_16x16x32_bf16 v[116:119], v[108:111], v[148:151], 0
 v_mfma_f32_16x16x32_bf16 v[120:123], v[112:115], v[148:151], 0
 v_mfma_f32_16x16x32_bf16 v[124:127], v[108:111], v[152:155], 0
 v_mfma_f32_16x16x32_bf16 v[128:131], v[112:115], v[152:155], 0
 v_mfma_f32_16x16x32_bf16 v[132:135], v[108:111], v[156:159], 0
 v_mfma_f32_16x16x32_bf16 v[136:139], v[112:115], v[156:159], 0
 v_mfma_f32_16x16x32_bf16 v[140:143], v[108:111], v[160:163], 0
 v_mfma_f32_16x16x32_bf16 v[144:147], v[112:115], v[160:163], 0
 s_nop 0
 ds_write_b32 v195, v116 offset:0
 ds_write_b32 v195, v117 offset:96
 ds_write_b32 v195, v118 offset:192
 ds_write_b32 v195, v119 offset:288
 ds_write_b32 v197, v120 offset:0
 ds_write_b32 v197, v121 offset:96
 ds_write_b32 v197, v122 offset:192
 ds_write_b32 v197, v123 offset:288
 ds_write_b32 v196, v124 offset:0
 ds_write_b32 v196, v125 offset:96
 ds_write_b32 v196, v126 offset:192
 ds_write_b32 v196, v127 offset:288
 ds_write_b32 v198, v128 offset:0
 ds_write_b32 v198, v129 offset:96
 ds_write_b32 v198, v130 offset:192
 ds_write_b32 v198, v131 offset:288
 ds_write_b32 v195, v132 offset:2304
 ds_write_b32 v195, v133 offset:2400
 ds_write_b32 v195, v134 offset:2496
 ds_write_b32 v195, v135 offset:2592
 ds_write_b32 v197, v136 offset:2304
 ds_write_b32 v197, v137 offset:2400
 ds_write_b32 v197, v138 offset:2496
 ds_write_b32 v197, v139 offset:2592
 ds_write_b32 v196, v140 offset:2304
 ds_write_b32 v196, v141 offset:2400
 ds_write_b32 v196, v142 offset:2496
 ds_write_b32 v196, v143 offset:2592
 ds_write_b32 v198, v144 offset:2304
 ds_write_b32 v198, v145 offset:2400
 ds_write_b32 v198, v146 offset:2496
 ds_write_b32 v198, v147 offset:2592
 s_waitcnt lgkmcnt(0)
 s_barrier
 ds_read_b128 v[116:119], v205
 ds_read_b128 v[120:123], v205 offset:16
 ds_read_b32 v148, v208
 ds_read_b128 v[124:127], v206
 ds_read_b128 v[128:131], v206 offset:16
 ds_read_b32 v150, v209
 ds_read_b128 v[132:135], v207
 ds_read_b128 v[136:139], v207 offset:16
 ds_read_b32 v152, v210
 s_waitcnt lgkmcnt(6)
 v_sub_f32 v156, 1.0, v148
 v_cvt_pk_bf16_f32 v156, v156, v156
 v_lshlrev_b32 v156, 16, v156
 v_mov_b32 v157, v156
 v_mul_f32 v116, v116, v148
 v_mul_f32 v117, v117, v148
 v_mul_f32 v118, v118, v148
 v_mul_f32 v119, v119, v148
 v_mul_f32 v120, v120, v148
 v_mul_f32 v121, v121, v148
 v_mul_f32 v122, v122, v148
 v_mul_f32 v123, v123, v148
 s_waitcnt lgkmcnt(3)
 v_sub_f32 v158, 1.0, v150
 v_cvt_pk_bf16_f32 v158, v158, v158
 v_lshlrev_b32 v158, 16, v158
 v_mov_b32 v159, v158
 v_mul_f32 v124, v124, v150
 v_mul_f32 v125, v125, v150
 v_mul_f32 v126, v126, v150
 v_mul_f32 v127, v127, v150
 v_mul_f32 v128, v128, v150
 v_mul_f32 v129, v129, v150
 v_mul_f32 v130, v130, v150
 v_mul_f32 v131, v131, v150
 s_waitcnt lgkmcnt(0)
 v_sub_f32 v160, 1.0, v152
 v_cvt_pk_bf16_f32 v160, v160, v160
 v_lshlrev_b32 v160, 16, v160
 v_mov_b32 v161, v160
 v_mul_f32 v132, v132, v152
 v_mul_f32 v133, v133, v152
 v_mul_f32 v134, v134, v152
 v_mul_f32 v135, v135, v152
 v_mul_f32 v136, v136, v152
 v_mul_f32 v137, v137, v152
 v_mul_f32 v138, v138, v152
 v_mul_f32 v139, v139, v152
 s_cmp_lg_u32 s20, 0
 s_cbranch_scc1 L_nopoll
 v_and_b32 v5, 15, v0
 v_lshlrev_b32 v5, 7, v5
 buffer_load_dword v4, v5, s[12:15], s35 offen offset:0 sc1
 s_waitcnt vmcnt(0)
 v_cmp_eq_u32_e64 s[62:63], s60, v4
 s_nop 0
 s_cmp_eq_u64 s[62:63], exec
 s_cbranch_scc0 L_poll6
L_back6:
L_nopoll:
 s_barrier
 s_mov_b32 s46, 20971520
 buffer_load_dwordx4 v[16:19], v199, s[12:15], s46 offen sc1
 s_mov_b32 s46, 22021248
 buffer_load_dwordx4 v[20:23], v199, s[12:15], s46 offen sc1
 s_mov_b32 s46, 23070976
 buffer_load_dwordx4 v[24:27], v199, s[12:15], s46 offen sc1
 s_mov_b32 s46, 24120704
 buffer_load_dwordx4 v[28:31], v199, s[12:15], s46 offen sc1
 s_mov_b32 s46, 20971520
 buffer_load_dwordx4 v[32:35], v200, s[12:15], s46 offen sc1
 s_mov_b32 s46, 22021248
 buffer_load_dwordx4 v[36:39], v200, s[12:15], s46 offen sc1
 s_mov_b32 s46, 23070976
 buffer_load_dwordx4 v[40:43], v200, s[12:15], s46 offen sc1
 s_mov_b32 s46, 24120704
 buffer_load_dwordx4 v[44:47], v200, s[12:15], s46 offen sc1
 s_mov_b32 s46, 20971520
 buffer_load_dwordx4 v[48:51], v201, s[12:15], s46 offen sc1
 s_mov_b32 s46, 22021248
 buffer_load_dwordx4 v[52:55], v201, s[12:15], s46 offen sc1
 s_mov_b32 s46, 23070976
 buffer_load_dwordx4 v[56:59], v201, s[12:15], s46 offen sc1
 s_mov_b32 s46, 24120704
 buffer_load_dwordx4 v[60:63], v201, s[12:15], s46 offen sc1
 s_waitcnt vmcnt(11)
 v_lshlrev_b32 v212, 16, v16
 v_and_b32 v213, 0xffff0000, v16
 s_waitcnt vmcnt(10)
 v_lshlrev_b32 v220, 16, v20
 v_and_b32 v221, 0xffff0000, v20
 v_pk_add_f32 v[212:213], v[212:213], v[220:221]
 s_waitcnt vmcnt(9)
 v_lshlrev_b32 v220, 16, v24
 v_and_b32 v221, 0xffff0000, v24
 v_pk_add_f32 v[212:213], v[212:213], v[220:221]
 s_waitcnt vmcnt(8)
 v_lshlrev_b32 v220, 16, v28
 v_and_b32 v221, 0xffff0000, v28
 v_pk_add_f32 v[212:213], v[212:213], v[220:221]
 v_lshlrev_b32 v214, 16, v17
 v_and_b32 v215, 0xffff0000, v17
 v_lshlrev_b32 v222, 16, v21
 v_and_b32 v223, 0xffff0000, v21
 v_pk_add_f32 v[214:215], v[214:215], v[222:223]
 v_lshlrev_b32 v222, 16, v25
 v_and_b32 v223, 0xffff0000, v25
 v_pk_add_f32 v[214:215], v[214:215], v[222:223]
 v_lshlrev_b32 v222, 16, v29
 v_and_b32 v223, 0xffff0000, v29
 v_pk_add_f32 v[214:215], v[214:215], v[222:223]
 v_lshlrev_b32 v216, 16, v18
 v_and_b32 v217, 0xffff0000, v18
 v_lshlrev_b32 v220, 16, v22
 v_and_b32 v221, 0xffff0000, v22
 v_pk_add_f32 v[216:217], v[216:217], v[220:221]
 v_lshlrev_b32 v220, 16, v26
 v_and_b32 v221, 0xffff0000, v26
 v_pk_add_f32 v[216:217], v[216:217], v[220:221]
 v_lshlrev_b32 v220, 16, v30
 v_and_b32 v221, 0xffff0000, v30
 v_pk_add_f32 v[216:217], v[216:217], v[220:221]
 v_lshlrev_b32 v218, 16, v19
 v_and_b32 v219, 0xffff0000, v19
 v_lshlrev_b32 v222, 16, v23
 v_and_b32 v223, 0xffff0000, v23
 v_pk_add_f32 v[218:219], v[218:219], v[222:223]
 v_lshlrev_b32 v222, 16, v27
 v_and_b32 v223, 0xffff0000, v27
 v_pk_add_f32 v[218:219], v[218:219], v[222:223]
 v_lshlrev_b32 v222, 16, v31
 v_and_b32 v223, 0xffff0000, v31
 v_pk_add_f32 v[218:219], v[218:219], v[222:223]
 v_pk_fma_f32 v[212:213], v[212:213], v[156:157], v[116:117]
 v_pk_fma_f32 v[214:215], v[214:215], v[156:157], v[118:119]
 v_pk_fma_f32 v[216:217], v[216:217], v[156:157], v[120:121]
 v_pk_fma_f32 v[218:219], v[218:219], v[156:157], v[122:123]
 v_cvt_pk_bf16_f32 v224, v212, v213
 v_cvt_pk_bf16_f32 v225, v214, v215
 v_cvt_pk_bf16_f32 v226, v216, v217
 v_cvt_pk_bf16_f32 v227, v218, v219
 buffer_store_dwordx4 v[224:227], v202, s[68:71], 0 offen
 s_waitcnt vmcnt(8)
 v_lshlrev_b32 v212, 16, v32
 v_and_b32 v213, 0xffff0000, v32
 s_waitcnt vmcnt(7)
 v_lshlrev_b32 v220, 16, v36
 v_and_b32 v221, 0xffff0000, v36
 v_pk_add_f32 v[212:213], v[212:213], v[220:221]
 s_waitcnt vmcnt(6)
 v_lshlrev_b32 v220, 16, v40
 v_and_b32 v221, 0xffff0000, v40
 v_pk_add_f32 v[212:213], v[212:213], v[220:221]
 s_waitcnt vmcnt(5)
 v_lshlrev_b32 v220, 16, v44
 v_and_b32 v221, 0xffff0000, v44
 v_pk_add_f32 v[212:213], v[212:213], v[220:221]
 v_lshlrev_b32 v214, 16, v33
 v_and_b32 v215, 0xffff0000, v33
 v_lshlrev_b32 v222, 16, v37
 v_and_b32 v223, 0xffff0000, v37
 v_pk_add_f32 v[214:215], v[214:215], v[222:223]
 v_lshlrev_b32 v222, 16, v41
 v_and_b32 v223, 0xffff0000, v41
 v_pk_add_f32 v[214:215], v[214:215], v[222:223]
 v_lshlrev_b32 v222, 16, v45
 v_and_b32 v223, 0xffff0000, v45
 v_pk_add_f32 v[214:215], v[214:215], v[222:223]
 v_lshlrev_b32 v216, 16, v34
 v_and_b32 v217, 0xffff0000, v34
 v_lshlrev_b32 v220, 16, v38
 v_and_b32 v221, 0xffff0000, v38
 v_pk_add_f32 v[216:217], v[216:217], v[220:221]
 v_lshlrev_b32 v220, 16, v42
 v_and_b32 v221, 0xffff0000, v42
 v_pk_add_f32 v[216:217], v[216:217], v[220:221]
 v_lshlrev_b32 v220, 16, v46
 v_and_b32 v221, 0xffff0000, v46
 v_pk_add_f32 v[216:217], v[216:217], v[220:221]
 v_lshlrev_b32 v218, 16, v35
 v_and_b32 v219, 0xffff0000, v35
 v_lshlrev_b32 v222, 16, v39
 v_and_b32 v223, 0xffff0000, v39
 v_pk_add_f32 v[218:219], v[218:219], v[222:223]
 v_lshlrev_b32 v222, 16, v43
 v_and_b32 v223, 0xffff0000, v43
 v_pk_add_f32 v[218:219], v[218:219], v[222:223]
 v_lshlrev_b32 v222, 16, v47
 v_and_b32 v223, 0xffff0000, v47
 v_pk_add_f32 v[218:219], v[218:219], v[222:223]
 v_pk_fma_f32 v[212:213], v[212:213], v[158:159], v[124:125]
 v_pk_fma_f32 v[214:215], v[214:215], v[158:159], v[126:127]
 v_pk_fma_f32 v[216:217], v[216:217], v[158:159], v[128:129]
 v_pk_fma_f32 v[218:219], v[218:219], v[158:159], v[130:131]
 v_cvt_pk_bf16_f32 v228, v212, v213
 v_cvt_pk_bf16_f32 v229, v214, v215
 v_cvt_pk_bf16_f32 v230, v216, v217
 v_cvt_pk_bf16_f32 v231, v218, v219
 buffer_store_dwordx4 v[228:231], v203, s[68:71], 0 offen
 s_waitcnt vmcnt(5)
 v_lshlrev_b32 v212, 16, v48
 v_and_b32 v213, 0xffff0000, v48
 s_waitcnt vmcnt(4)
 v_lshlrev_b32 v220, 16, v52
 v_and_b32 v221, 0xffff0000, v52
 v_pk_add_f32 v[212:213], v[212:213], v[220:221]
 s_waitcnt vmcnt(3)
 v_lshlrev_b32 v220, 16, v56
 v_and_b32 v221, 0xffff0000, v56
 v_pk_add_f32 v[212:213], v[212:213], v[220:221]
 s_waitcnt vmcnt(2)
 v_lshlrev_b32 v220, 16, v60
 v_and_b32 v221, 0xffff0000, v60
 v_pk_add_f32 v[212:213], v[212:213], v[220:221]
 v_lshlrev_b32 v214, 16, v49
 v_and_b32 v215, 0xffff0000, v49
 v_lshlrev_b32 v222, 16, v53
 v_and_b32 v223, 0xffff0000, v53
 v_pk_add_f32 v[214:215], v[214:215], v[222:223]
 v_lshlrev_b32 v222, 16, v57
 v_and_b32 v223, 0xffff0000, v57
 v_pk_add_f32 v[214:215], v[214:215], v[222:223]
 v_lshlrev_b32 v222, 16, v61
 v_and_b32 v223, 0xffff0000, v61
 v_pk_add_f32 v[214:215], v[214:215], v[222:223]
 v_lshlrev_b32 v216, 16, v50
 v_and_b32 v217, 0xffff0000, v50
 v_lshlrev_b32 v220, 16, v54
 v_and_b32 v221, 0xffff0000, v54
 v_pk_add_f32 v[216:217], v[216:217], v[220:221]
 v_lshlrev_b32 v220, 16, v58
 v_and_b32 v221, 0xffff0000, v58
 v_pk_add_f32 v[216:217], v[216:217], v[220:221]
 v_lshlrev_b32 v220, 16, v62
 v_and_b32 v221, 0xffff0000, v62
 v_pk_add_f32 v[216:217], v[216:217], v[220:221]
 v_lshlrev_b32 v218, 16, v51
 v_and_b32 v219, 0xffff0000, v51
 v_lshlrev_b32 v222, 16, v55
 v_and_b32 v223, 0xffff0000, v55
 v_pk_add_f32 v[218:219], v[218:219], v[222:223]
 v_lshlrev_b32 v222, 16, v59
 v_and_b32 v223, 0xffff0000, v59
 v_pk_add_f32 v[218:219], v[218:219], v[222:223]
 v_lshlrev_b32 v222, 16, v63
 v_and_b32 v223, 0xffff0000, v63
 v_pk_add_f32 v[218:219], v[218:219], v[222:223]
 v_pk_fma_f32 v[212:213], v[212:213], v[160:161], v[132:133]
 v_pk_fma_f32 v[214:215], v[214:215], v[160:161], v[134:135]
 v_pk_fma_f32 v[216:217], v[216:217], v[160:161], v[136:137]
 v_pk_fma_f32 v[218:219], v[218:219], v[160:161], v[138:139]
 v_cvt_pk_bf16_f32 v224, v212, v213
 v_cvt_pk_bf16_f32 v225, v214, v215
 v_cvt_pk_bf16_f32 v226, v216, v217
 v_cvt_pk_bf16_f32 v227, v218, v219
 buffer_store_dwordx4 v[224:227], v204, s[68:71], 0 offen
 s_cmp_lg_u32 s2, 0
 s_cbranch_scc1 L_fin
 s_mov_b32 s46, 42648192
 v_mov_b32 v252, s60
 s_cmp_eq_u32 s20, 0
 s_cselect_b32 s77, s46, 0x7ff00000
 s_mov_b64 exec, 1
 buffer_store_dword v252, v1, s[12:15], s77 offen offset:0 sc1
 s_mov_b64 exec, -1
L_fin:
 s_waitcnt vmcnt(0)
 s_endpgm
L_poll1:
 s_mov_b32 s61, 300000
L_poll1_loop:
 buffer_load_dwordx4 v[128:131], v1, s[12:15], s42 offen offset:0 sc1
 s_waitcnt vmcnt(0)
 v_xor_b32 v128, s60, v128
 v_xor_b32 v129, s60, v129
 v_xor_b32 v130, s60, v130
 v_xor_b32 v131, s60, v131
 v_or3_b32 v128, v128, v129, v130
 v_or_b32 v128, v128, v131
 v_cmp_eq_u32_e64 s[62:63], 0, v128
 s_nop 1
 s_cmp_eq_u64 s[62:63], exec
 s_cbranch_scc1 L_back1
 s_sleep 1
 s_sub_u32 s61, s61, 1
 s_cmp_lg_u32 s61, 0
 s_cbranch_scc1 L_poll1_loop
 s_branch L_back1
L_poll2:
 s_mov_b32 s61, 300000
L_poll2_loop:
 buffer_load_dword v224, v225, s[12:15], s32 offen offset:0 sc1
 s_waitcnt vmcnt(0)
 v_cmp_eq_u32_e64 s[62:63], s60, v224
 s_nop 1
 s_cmp_eq_u64 s[62:63], exec
 s_cbranch_scc1 L_back2
 s_sleep 1
 s_sub_u32 s61, s61, 1
 s_cmp_lg_u32 s61, 0
 s_cbranch_scc1 L_poll2_loop
 s_branch L_back2
L_poll3:
 s_mov_b32 s61, 300000
L_poll3_loop:
 buffer_load_dword v229, v225, s[12:15], s42 offen offset:0 sc1
 s_waitcnt vmcnt(0)
 v_cmp_eq_u32_e64 s[62:63], s60, v229
 s_nop 1
 s_cmp_eq_u64 s[62:63], exec
 s_cbranch_scc1 L_back3
 s_sleep 1
 s_sub_u32 s61, s61, 1
 s_cmp_lg_u32 s61, 0
 s_cbranch_scc1 L_poll3_loop
 s_branch L_back3
L_poll4:
 s_mov_b32 s61, 300000
L_poll4_loop:
 buffer_load_dword v80, v81, s[12:15], s42 offen offset:0 sc1
 s_waitcnt vmcnt(0)
 v_cmp_eq_u32_e64 s[62:63], s60, v80
 s_nop 1
 s_cmp_eq_u64 s[62:63], exec
 s_cbranch_scc1 L_back4
 s_sleep 1
 s_sub_u32 s61, s61, 1
 s_cmp_lg_u32 s61, 0
 s_cbranch_scc1 L_poll4_loop
 s_branch L_back4
L_poll5:
 s_mov_b32 s61, 300000
L_poll5_loop:
 buffer_load_dwordx4 v[84:87], v82, s[12:15], s42 offen offset:0 sc1
 s_waitcnt vmcnt(0)
 v_xor_b32 v84, s60, v84
 v_xor_b32 v85, s60, v85
 v_xor_b32 v86, s60, v86
 v_xor_b32 v87, s60, v87
 v_or3_b32 v84, v84, v85, v86
 v_or_b32 v84, v84, v87
 v_cmp_eq_u32_e64 s[62:63], 0, v84
 s_nop 1
 s_cmp_eq_u64 s[62:63], exec
 s_cbranch_scc1 L_back5
 s_sleep 1
 s_sub_u32 s61, s61, 1
 s_cmp_lg_u32 s61, 0
 s_cbranch_scc1 L_poll5_loop
 s_branch L_back5
L_poll6:
 s_mov_b32 s61, 300000
L_poll6_loop:
 buffer_load_dword v4, v5, s[12:15], s35 offen offset:0 sc1
 s_waitcnt vmcnt(0)
 v_cmp_eq_u32_e64 s[62:63], s60, v4
 s_nop 1
 s_cmp_eq_u64 s[62:63], exec
 s_cbranch_scc1 L_back6
 s_sleep 1
 s_sub_u32 s61, s61, 1
 s_cmp_lg_u32 s61, 0
 s_cbranch_scc1 L_poll6_loop
 s_branch L_back6
L_done:
 s_endpgm
.section .rodata,"a"
.p2align 6
.amdhsa_kernel gated_mix__spectral_gfnet__glu_gated_geglu__prompt_kernel
  .amdhsa_next_free_vgpr 512
  .amdhsa_next_free_sgpr 102
  .amdhsa_accum_offset 256
  .amdhsa_group_segment_fixed_size 0
  .amdhsa_kernarg_size 88
  .amdhsa_user_sgpr_count 2
  .amdhsa_user_sgpr_kernarg_segment_ptr 1
  .amdhsa_system_sgpr_workgroup_id_x 1
  .amdhsa_float_denorm_mode_32 3
.end_amdhsa_kernel
```
